```python
import torch

def _softmax(x, axis=-1):
    return torch.softmax(x, dim=axis)
def _gelu(x):
    return torch.nn.functional.gelu(x, approximate="tanh")
def _silu(x):
    return torch.nn.functional.silu(x)
def _sigmoid(x):
    return torch.sigmoid(x)
def _layernorm(x, axis=-1, eps=1e-5):
    m = x.mean(dim=axis, keepdim=True)
    v = x.var(dim=axis, keepdim=True, unbiased=False)
    return (x - m) / torch.sqrt(v + eps)
def _scatter_add(tgt, idx, src, axis=0):
    return tgt.clone().index_add_(axis, idx, src)
def _segment_sum(src, seg, n):
    out = torch.zeros((n,) + src.shape[1:], dtype=src.dtype)
    return out.index_add_(0, seg, src)
def _pad(x, pw):
    flat = tuple(v for pair in reversed(pw) for v in pair)
    return torch.nn.functional.pad(x, flat)

kernel_name = 'interleave_layers__sliding_local_dilated__dense_activation_mish__prompt'

def setup_inputs():

    _w = (lambda a: (lambda t: t.to(torch.bfloat16) if t.is_floating_point() else t)(torch.as_tensor(a)))
    def _A_setup():
        B, S, D = 1, 2048, 512
        return {
            "x": _w((lambda *s: torch.randn(*s, dtype=torch.bfloat16) * 0.05)(B, S, D)),
            "wqkv": _w((lambda *s: torch.randn(*s, dtype=torch.bfloat16) * 0.05)(D, 3 * D)),
            "wo": _w((lambda *s: torch.randn(*s, dtype=torch.bfloat16) * 0.05)(D, D)),
        }
    _A_in = _A_setup()

    def _B_setup():
        B, S, D, F = 1, 2048, 512, 1376
        return {
            "x": _w((lambda *s: torch.randn(*s, dtype=torch.bfloat16) * 0.05)(B, S, D)),
            "w1": _w((lambda *s: torch.randn(*s, dtype=torch.bfloat16) * 0.8)(D, F) * (D ** -0.5)),
            "b1": _w((lambda *s: torch.randn(*s, dtype=torch.bfloat16) * 0.8)(F)),
            "w2": _w((lambda *s: torch.randn(*s, dtype=torch.bfloat16) * 0.8)(F, D) * (F ** -0.5)),
        }
    _B_in = _B_setup()

    return {
        "A_x": _A_in["x"],
        "A_wqkv": _A_in["wqkv"],
        "A_wo": _A_in["wo"],
        "B_x": _B_in["x"],
        "B_w1": _B_in["w1"],
        "B_b1": _B_in["b1"],
        "B_w2": _B_in["w2"],
    }

def reference(A_x, A_wqkv, A_wo, B_x, B_w1, B_b1, B_w2):
    def _A_ref(x, wqkv, wo):
        B, S, D = x.shape
        H = 32; Dh = D // H
        W, dil = 8, 2
        qkv = (lambda x, *d: x.permute(*d))((x @ wqkv).reshape(B, S, 3, H, Dh), 2, 0, 3, 1, 4)
        q, k, v = qkv[0], qkv[1], qkv[2]
        scale = Dh ** -0.5
        pos = torch.arange(S)
        off = torch.arange(W) * dil
        idx = pos[:, None] - off[None, :]
        mask = idx >= 0
        idx_c = torch.where(mask, idx, 0).reshape(-1)
        kg = k[:, :, idx_c, :].reshape(B, H, S, W, Dh)
        vg = v[:, :, idx_c, :].reshape(B, H, S, W, Dh)
        logits = torch.einsum("bhsd,bhswd->bhsw", q, kg) * scale
        logits = torch.where(mask[None, None, :, :], logits, -1e9)
        attn = _softmax(logits, axis=-1)
        o = torch.einsum("bhsw,bhswd->bhsd", attn, vg)
        return (lambda x, *d: x.permute(*d))(o, 0, 2, 1, 3).reshape(B, S, D) @ wo

    def _B_ref(x, w1, b1, w2):
        h = torch.einsum("bsd,df->bsf", x, w1) + b1
        sp = torch.log1p(torch.exp(-torch.abs(h))) + torch.where(h > 0, h, torch.zeros_like(h))
        act = h * torch.tanh(sp)
        return torch.einsum("bsf,fd->bsd", act, w2)

    x = A_x
    x = x + _A_ref(_layernorm(x, axis=-1), A_wqkv, A_wo)
    x = x + _B_ref(_layernorm(x, axis=-1), B_w1, B_b1, B_w2)
    x = x + _A_ref(_layernorm(x, axis=-1), A_wqkv, A_wo)
    x = x + _B_ref(_layernorm(x, axis=-1), B_w1, B_b1, B_w2)
    return x
```

```asm
; @launch grid=(256,1,1) block=(256,1,1) lds=163840
.amdgcn_target "amdgcn-amd-amdhsa--gfx950"
.text
.p2align 12
.globl interleave_layers__sliding_local_dilated__dense_activation_mish__prompt_kernel
.p2align 8
.type interleave_layers__sliding_local_dilated__dense_activation_mish__prompt_kernel,@function
interleave_layers__sliding_local_dilated__dense_activation_mish__prompt_kernel:
    s_cmp_ge_u32 s2, 256
    s_cbranch_scc1 L_end
    s_load_dwordx2 s[8:9], s[0:1], 0
    s_load_dwordx2 s[12:13], s[0:1], 8
    s_getpc_b64 s[70:71]
L_pc:
    v_lshrrev_b32 v1, 6, v0
    v_and_b32 v0, 63, v0
    s_lshr_b32 s67, s2, 3
    s_mulk_i32 s67, 1536
    v_mad_u32_u24 v39, v1, 3, v0
    v_lshl_add_u32 v39, v39, 7, s67
    v_min_u32 v39, L_code_end-L_pc-4, v39
    s_mov_b64 exec, 7
    global_load_dword a239, v39, s[70:71]
    s_mov_b64 exec, -1
    s_load_dwordx2 s[40:41], s[0:1], 72
    s_load_dwordx2 s[16:17], s[0:1], 16
    s_load_dwordx2 s[20:21], s[0:1], 32
    s_load_dwordx2 s[24:25], s[0:1], 40
    s_load_dwordx2 s[28:29], s[0:1], 48
    s_load_dwordx2 s[32:33], s[0:1], 56
    s_load_dwordx2 s[36:37], s[0:1], 64
    v_readfirstlane_b32 s44, v1
    s_mov_b32 s10, 2097152
    s_mov_b32 s11, 0x20000
    s_mov_b32 s14, 1572864
    s_mov_b32 s15, 0x20000
    s_lshr_b32 s46, s2, 4
    s_and_b32 s64, s2, 7
    s_lshl_b32 s58, s64, 8
    s_bfe_u32 s65, s2, 0x10003
    s_add_u32 s58, s58, s65
    s_lshl_b32 s58, s58, 10
    s_lshl_b32 s74, s2, 2
    s_add_u32 s74, s74, s44
    s_lshr_b32 s72, s2, 3
    s_lshl_b32 s72, s72, 2
    s_add_u32 s72, s72, s44
    v_lshrrev_b32 v36, 3, v0
    v_lshlrev_b32 v38, 11, v36
    v_and_b32 v36, 7, v0
    v_lshl_or_b32 v233, v36, 7, v38
    v_lshlrev_b32 v41, 7, v0
    v_lshlrev_b32 v239, 10, v0
    s_waitcnt lgkmcnt(0)
    s_mov_b32 s0, 0
    s_mul_i32 s68, s74, 576
    s_add_u32 s68, s68, 196608
    s_mov_b64 exec, 0x1f
    buffer_load_dword a239, v41, s[12:15], s68 offen
    s_lshl_b32 s68, s46, 2
    s_add_u32 s68, s68, s44
    s_lshl_b32 s68, s68, 12
    s_add_u32 s68, s68, s58
    s_mov_b64 exec, 0xe0e
    buffer_load_dword a239, v233, s[8:11], s68 offen
    s_mov_b64 exec, -1
    v_lshrrev_b32 v37, 4, v0
    v_xor_b32 v36, v36, v37
    v_lshl_or_b32 v228, v36, 4, v38
    v_xor_b32_e64 v229, 64, v228
    v_add_u32 v229, 15360, v229
    v_add_u32 v230, 30720, v228
    v_add_u32 v231, 30720, v229
    s_cmp_lg_u32 s64, 0
    s_cselect_b32 s62, 1, 0
    s_mul_i32 s63, s44, 3072
    s_lshl_b32 s61, s63, 2
    s_add_u32 s61, s61, 98304
    s_lshl_b32 s64, s44, 16
    s_add_u32 s64, s64, s58
    s_lshr_b32 s66, s44, 1
    s_lshl_b32 s66, s66, 5
    s_and_b32 s67, s44, 1
    s_lshl_b32 s67, s67, 2
    s_add_u32 s66, s66, s67
    s_mul_i32 s82, s66, 3072
    s_lshl_b32 s67, s46, 6
    s_add_u32 s82, s82, s67
    s_mul_i32 s83, s66, 2752
    v_bfe_u32 v38, v0, 2, 2
    v_lshl_or_b32 v38, v37, 3, v38
    v_mul_u32_u24 v232, 3072, v38
    v_and_b32 v38, 1, v37
    v_lshlrev_b32 v38, 1, v38
    v_and_b32 v39, 3, v0
    v_xor_b32 v39, v38, v39
    v_lshl_add_u32 v232, v39, 4, v232
    s_add_u32 m0, s61, 0
    s_add_u32 s65, s64, 0
    buffer_load_dwordx4 v228, s[8:11], s65 offen offset:0  lds
    buffer_load_dwordx4 v229, s[8:11], s65 offen offset:1024  lds
    buffer_load_dwordx4 v230, s[8:11], s65 offen offset:2048  lds
    buffer_load_dwordx4 v231, s[8:11], s65 offen offset:3072  lds
    s_add_u32 m0, s63, 0
    s_add_u32 s80, s82, 0
    buffer_load_dwordx4 v232, s[12:15], s80 offen offset:0  lds
    buffer_load_dwordx4 v232, s[12:15], s80 offen offset:1024  lds
    buffer_load_dwordx4 v232, s[12:15], s80 offen offset:2048  lds
    s_mul_i32 s68, s72, 12288
    s_mov_b64 exec, 0xfff
    buffer_load_dword a239, v239, s[12:15], s68 offen offset:384
    s_mov_b64 exec, -1
    s_mov_b32 s18, 525312
    s_mov_b32 s19, 0x20000
    s_mov_b32 s22, 1409024
    s_mov_b32 s23, 0x20000
    s_mov_b32 s26, 2752
    s_mov_b32 s27, 0x20000
    s_mov_b32 s30, 1410048
    s_mov_b32 s31, 0x20000
    s_mov_b32 s34, 2097152
    s_mov_b32 s35, 0x20000
    s_mov_b32 s38, 256
    s_mov_b32 s39, 0x20000
    s_mov_b32 s42, 268435456
    s_mov_b32 s43, 0x20000
    s_and_b32 s45, s2, 15
    s_lshl_b32 s49, s45, 19
    s_lshr_b32 s47, s46, 3
    s_and_b32 s48, s46, 7
    s_lshl_b32 s6, s47, 2
    s_add_u32 s6, s6, s44
    s_lshl_b32 s69, s6, 15
    s_add_u32 s69, s69, s58
    s_lshl_b32 s68, s48, 7
    s_add_u32 s81, s69, s68
    s_or_b32 s75, s46, s44
    s_cselect_b32 s68, 0x40000000, 0
    v_mov_b32 v234, 0
    v_mov_b32_e64 v235, 0
    v_lshl_add_u32 v236, v0, 3, s68
    s_add_u32 s68, s49, 139264
    buffer_store_dwordx2 v[234:235], v236, s[40:43], s68 offen sc1
    s_sub_u32 s16, s16, 1024
    s_subb_u32 s17, s17, 0
    s_sub_u32 s28, s28, 1024
    s_subb_u32 s29, s29, 0
    s_lshr_b32 s68, s46, 2
    s_and_b32 s69, s46, 3
    s_mul_i32 s69, s69, 3
    s_cmp_eq_u32 s68, 3
    s_cselect_b32 s70, 7, 8
    s_mov_b32 s71, s69
    s_min_u32 s69, s69, s70
    s_sub_u32 s71, s71, s69
    s_lshl_b32 s71, s71, 6
    s_mul_i32 s59, s68, 11
    s_add_u32 s59, s59, s69
    s_lshl_b32 s68, s59, 6
    s_add_u32 s83, s83, s68
    s_lshl_b32 s68, s48, 7
    s_lshl_b32 s96, s44, 17
    s_add_u32 s96, s96, s68
    s_mul_i32 s97, s44, 360448
    s_add_u32 s97, s97, s68
    s_lshr_b32 s7, s48, 1
    s_lshl_b32 s7, s7, 5
    s_and_b32 s69, s48, 1
    s_add_u32 s7, s7, s69
    s_lshl_b32 s7, s7, 3
    s_add_u32 s4, s68, s49
    s_add_u32 s4, s4, 159744
    s_lshl_b32 s3, s48, 11
    s_add_u32 s3, s3, s49
    s_add_u32 s3, s3, 143360
    s_lshl_b32 s5, s48, 2
    s_add_u32 s5, s5, s49
    s_add_u32 s5, s5, 139520
    s_add_u32 s68, s49, 139264
    s_lshl_b32 s69, s44, 6
    s_add_u32 s57, s68, s69
    s_lshl_b32 s69, s46, 2
    s_add_u32 s54, s57, s69
    s_lshl_b32 s69, s47, 7
    s_add_u32 s68, s68, s69
    s_lshl_b32 s69, s44, 4
    s_add_u32 s56, s68, s69
    s_lshl_b32 s69, s44, 3
    s_add_u32 s69, s69, s48
    s_lshl_b32 s69, s69, 2
    s_add_u32 s55, s68, s69
    s_mov_b32 s84, 0x3b000000
    s_mov_b32 s88, 0x22222222
    s_mov_b32 s89, 0x22222222
    s_mov_b32 s90, 0x44444444
    s_mov_b32 s91, 0x44444444
    s_mov_b32 s92, 0x88888888
    s_mov_b32 s93, 0x88888888
    s_mov_b32 s94, 0x00f0000f
    s_mov_b32 s95, 0xf0000f00
    s_mov_b32 s98, 0x3fb8aa3b
    s_mov_b32 s99, 0x3f317218
    v_and_b32 v36, 15, v0
    v_lshrrev_b32 v37, 4, v0
    v_lshrrev_b32 v38, 2, v0
    v_and_b32 v39, 3, v0
    v_and_b32 v40, 1, v37
    v_lshlrev_b32 v1, 4, v0
    v_lshlrev_b32 v32, 4, v37
    v_lshlrev_b32_e64 v34, 3, v39
    v_lshl_or_b32 v34, v40, 5, v34
    v_lshl_or_b32 v2, v38, 6, v34
    v_mul_u32_u24 v35, 192, v38
    v_add_u32 v34, v34, v35
    v_add_u32 v34, 98304, v34
    v_xor_b32 v35, 32, v34
    v_xor_b32 v3, 32, v2
    v_add_u32 v4, 0x10000, v2
    v_add_u32 v5, 0x10000, v3
    v_add_u32 v6, s61, v2
    v_add_u32 v7, s61, v3
    v_lshlrev_b32 v40, 1, v40
    v_xor_b32 v39, v40, v39
    v_lshlrev_b32 v39, 4, v39
    v_lshl_or_b32 v39, v38, 10, v39
    v_lshrrev_b32 v40, 5, v0
    v_mul_u32_u24 v40, 8128, v40
    v_sub_u32 v39, v39, v40
    v_add_u32 v8, 1024, v39
    v_add_u32 v9, 8192, v39
    v_add_u32 v10, 15360, v39
    v_add_u32 v11, 22528, v39
    v_and_b32 v40, 32, v0
    v_lshlrev_b32 v40, 4, v40
    v_add_u32 v6, v6, v40
    v_add_u32 v7, v7, v40
    v_add_u32 v38, 0, v0
    v_mul_u32_u24 v39, 43691, v38
    v_lshrrev_b32 v39, 19, v39
    v_mul_u32_u24 v40, 12, v39
    v_sub_u32 v38, v38, v40
    v_bfe_u32 v40, v39, 2, 1
    v_lshlrev_b32 v40, 1, v40
    v_xor_b32 v38, v38, v40
    v_lshlrev_b32 v38, 4, v38
    v_and_b32 v40, 12, v39
    v_add_u32 v39, v39, v40
    v_mul_u32_u24 v39, 2752, v39
    v_cmp_gt_u32 vcc, s71, v38
    v_mov_b32 v40, 0x40000000
    s_nop 0
    v_cndmask_b32 v39, v39, v40, vcc
    v_add_u32 v12, v38, v39
    v_add_u32 v38, 64, v0
    v_mul_u32_u24 v39, 43691, v38
    v_lshrrev_b32 v39, 19, v39
    v_mul_u32_u24 v40, 12, v39
    v_sub_u32 v38, v38, v40
    v_bfe_u32 v40, v39, 2, 1
    v_lshlrev_b32 v40, 1, v40
    v_xor_b32 v38, v38, v40
    v_lshlrev_b32 v38, 4, v38
    v_and_b32 v40, 12, v39
    v_add_u32 v39, v39, v40
    v_mul_u32_u24 v39, 2752, v39
    v_cmp_gt_u32 vcc, s71, v38
    v_mov_b32 v40, 0x40000000
    s_nop 0
    v_cndmask_b32 v39, v39, v40, vcc
    v_add_u32 v13, v38, v39
    v_subrev_u32 v13, 1024, v13
    v_add_u32 v38, 128, v0
    v_mul_u32_u24 v39, 43691, v38
    v_lshrrev_b32 v39, 19, v39
    v_mul_u32_u24 v40, 12, v39
    v_sub_u32 v38, v38, v40
    v_bfe_u32 v40, v39, 2, 1
    v_lshlrev_b32 v40, 1, v40
    v_xor_b32 v38, v38, v40
    v_lshlrev_b32 v38, 4, v38
    v_and_b32 v40, 12, v39
    v_add_u32 v39, v39, v40
    v_mul_u32_u24 v39, 2752, v39
    v_cmp_gt_u32 vcc, s71, v38
    v_mov_b32 v40, 0x40000000
    s_nop 0
    v_cndmask_b32 v39, v39, v40, vcc
    v_add_u32 v14, v38, v39
    v_subrev_u32 v14, 2048, v14
    v_lshlrev_b32 v15, 2, v36
    v_bfe_u32 v30, v0, 2, 1
    v_and_b32_e64 v38, 12, v15
    v_lshl_or_b32 v30, v30, 6, v38
    v_mov_b32 v16, 0x3f803f80
    v_mov_b32 v17, 0x3f803f80
    v_mov_b32 v18, 0x3f803f80
    v_mov_b32 v19, 0x3f803f80
    s_and_b32 s68, s44, 1
    s_lshl_b32 s68, s68, 5
    v_xor_b32 v33, s68, v2
    s_lshr_b32 s68, s44, 1
    s_add_u32 s68, s68, 1
    s_lshl_b32 s68, s68, 10
    v_add_u32 v33, s68, v33
    v_lshlrev_b32 v37, 2, v37
    v_sub_u32 v37, v36, v37
    v_mov_b32 v38, 0xff800000
    s_or_b32 s68, s62, s44
    s_cmp_lg_u32 s68, 0
    s_cselect_b32 s68, 0, 0xff800000
    v_subrev_u32 v39, 0, v37
    v_cmp_gt_u32 vcc, 8, v39
    v_cmp_gt_i32 s[70:71], -8, v39
    v_ashrrev_i32 v39, 31, v39
    v_cndmask_b32 v242, v38, 0, vcc
    v_cndmask_b32 v246, v38, 0, s[70:71]
    v_or_b32 v250, s68, v246
    v_and_b32 v254, 0xffff, v39
    v_subrev_u32 v39, 1, v37
    v_cmp_gt_u32 vcc, 8, v39
    v_cmp_gt_i32 s[70:71], -8, v39
    v_ashrrev_i32 v39, 31, v39
    v_cndmask_b32 v243, v38, 0, vcc
    v_cndmask_b32 v247, v38, 0, s[70:71]
    v_or_b32 v251, s68, v247
    v_and_b32 v39, 0xffff0000, v39
    v_or_b32 v254, v254, v39
    v_subrev_u32 v39, 2, v37
    v_cmp_gt_u32 vcc, 8, v39
    v_cmp_gt_i32 s[70:71], -8, v39
    v_ashrrev_i32 v39, 31, v39
    v_cndmask_b32 v244, v38, 0, vcc
    v_cndmask_b32 v248, v38, 0, s[70:71]
    v_or_b32 v252, s68, v248
    v_and_b32 v255, 0xffff, v39
    v_subrev_u32 v39, 3, v37
    v_cmp_gt_u32 vcc, 8, v39
    v_cmp_gt_i32 s[70:71], -8, v39
    v_ashrrev_i32_e64 v39, 31, v39
    v_cndmask_b32 v245, v38, 0, vcc
    v_cndmask_b32 v249, v38, 0, s[70:71]
    v_or_b32 v253, s68, v249
    v_and_b32 v39, 0xffff0000, v39
    v_or_b32 v255, v255, v39
    s_getreg_b32 s68, hwreg(HW_REG_XCC_ID)
    s_and_b32 s68, s68, 15
    s_mul_i32 s69, s68, s68
    s_lshl_b32 s69, s69, 16
    s_lshl_b32 s68, s68, 8
    s_add_u32 s60, s68, s69
    s_add_u32 s60, s60, 1
    v_and_b32 v36, 15, v0
    v_lshrrev_b32 v37, 1, v36
    v_lshlrev_b32 v37, 4, v37
    v_xor_b32 v37, v37, v32
    v_lshl_or_b32 v28, v36, 7, v37
    v_xor_b32 v29, 64, v28
    v_lshrrev_b32 v38, 5, v0
    v_lshrrev_b32 v39, 1, v36
    v_xor_b32 v38, v38, v39
    v_lshlrev_b32 v38, 4, v38
    v_lshl_or_b32 v105, v36, 7, v38
    v_bfe_u32 v38, v0, 4, 1
    v_lshl_or_b32 v105, v38, 3, v105
    v_add_u32 v105, s61, v105
    v_or_b32 v36, 8, v36
    v_lshrrev_b32 v37, 1, v36
    v_lshlrev_b32 v37, 4, v37
    v_xor_b32 v37, v37, v32
    v_and_b32 v36, 7, v36
    v_lshl_or_b32 v241, v36, 7, v37
    v_add_u32 v241, 147456, v241
    v_xor_b32 v238, 64, v241
    v_add_u32 v28, s61, v28
    v_add_u32 v29, s61, v29
    v_add_u32 v240, 61440, v33
    s_and_b32 s68, s44, 1
    s_lshl_b32 s68, s68, 5
    v_xor_b32 v102, s68, v2
    s_lshr_b32 s68, s44, 1
    s_mul_i32 s68, s68, 6144
    v_add_u32 v102, s68, v102
    s_lshl_b32 s68, s44, 6
    s_add_u32 s68, s68, 159744
    v_add_u32 v103, s68, v32
    v_lshrrev_b32 v36, 5, v0
    v_and_b32 v37, 31, v0
    v_lshlrev_b32 v37, 2, v37
    v_lshl_or_b32 v36, v36, 10, v37
    s_lshl_b32 s68, s44, 11
    s_add_u32 s68, s68, 147456
    v_add_u32 v104, s68, v36
    s_cmp_lg_u32 s62, 0
    s_cselect_b32 s67, 0, 0x40000000
    s_cselect_b32 s66, 32768, 0
    s_sub_u32 s66, s58, s66
    v_add_u32 v237, s67, v229
    s_lshl_b32 s67, s44, 1
    s_add_u32 s67, s67, s0
    s_and_b32 s67, s67, 7
    s_lshl_b32 s67, s67, 7
    s_add_u32 s66, s66, s67
    s_lshl_b32 s67, s44, 11
    s_add_u32 m0, s67, 146432
    s_nop 0
    buffer_load_dwordx4 v237, s[8:11], s66 offen offset:1024  lds
    s_add_u32 m0, s67, 147328
    s_nop 0
    buffer_load_dwordx4 v237, s[8:11], s66 offen offset:1152  lds
    s_lshl_b32 s69, s74, 9
    s_lshl_b32 s70, s72, 12
    s_mul_i32 s71, s74, 1376
    s_mul_i32 s76, s72, 11264
    s_lshl_b32 s68, s46, 2
    s_add_u32 s68, s68, s44
    s_lshr_b32 s77, s68, 3
    s_mul_i32 s77, s77, 45056
    s_and_b32 s78, s68, 7
    s_lshl_b32 s78, s78, 11
    s_add_u32 s77, s77, s78
    s_add_u32 s77, s77, s49
    s_add_u32 s77, s77, 163840
    s_mul_i32 s78, s68, 2176
    s_add_u32 s78, s78, s49
    s_mul_i32 s79, s74, 768
    s_add_u32 s79, s79, 786432
    s_lshl_b32 s1, s68, 12
    s_add_u32 s1, s1, s58
    s_cmp_eq_u32 s75, 0
    s_cselect_b32 s68, 1, 0
    v_mov_b32 v234, s60
    v_mov_b32 v235, s68
    s_lshl_b32 s68, s44, 12
    v_mov_b32 v236, s68
    s_lshl_b32 s73, s45, 4
    s_mov_b64 exec, 0
    s_cmp_eq_u32 s44, 0
    s_cbranch_scc1 L_pg0
    s_cmp_eq_u32 s44, 1
    s_cbranch_scc1 L_pg1
    s_cmp_eq_u32 s44, 2
    s_cbranch_scc1 L_pg2
    s_branch L_pg3
L_walked0:
    s_mov_b64 exec, -1
    s_add_u32 m0, s61, 8192
    s_nop 0
    buffer_load_dwordx4 v228, s[8:11], s81 offen offset:0  lds
    buffer_load_dwordx4 v229, s[8:11], s81 offen offset:1024  lds
    s_add_u32 m0, s61, 4096
    s_add_u32 s65, s64, 128
    buffer_load_dwordx4 v228, s[8:11], s65 offen offset:0  lds
    buffer_load_dwordx4 v229, s[8:11], s65 offen offset:1024  lds
    buffer_load_dwordx4 v230, s[8:11], s65 offen offset:2048  lds
    buffer_load_dwordx4 v231, s[8:11], s65 offen offset:3072  lds
    s_add_u32 m0, s63, 12288
    s_add_u32 s80, s82, 196608
    buffer_load_dwordx4 v232, s[12:15], s80 offen offset:0  lds
    buffer_load_dwordx4 v232, s[12:15], s80 offen offset:1024  lds
    buffer_load_dwordx4 v232, s[12:15], s80 offen offset:2048  lds
    s_waitcnt vmcnt(16)
    s_waitcnt vmcnt(13)
    s_barrier
    ds_read_b128 v[42:45], v28 offset:0
    ds_read_b128 v[46:49], v28 offset:2048
    ds_read_b128 v[50:53], v29 offset:0
    ds_read_b128 v[54:57], v29 offset:2048
    ds_read_b64_tr_b16 v[186:187], v2 offset:0
    ds_read_b64_tr_b16 v[188:189], v2 offset:3072
    ds_read_b64_tr_b16 v[190:191], v3 offset:0
    ds_read_b64_tr_b16 v[192:193], v3 offset:3072
    ds_read_b64_tr_b16 v[194:195], v2 offset:1024
    ds_read_b64_tr_b16 v[196:197], v2 offset:4096
    ds_read_b64_tr_b16 v[198:199], v3 offset:1024
    ds_read_b64_tr_b16 v[200:201], v3 offset:4096
    ds_read_b64_tr_b16 v[202:203], v2 offset:2048
    ds_read_b64_tr_b16 v[204:205], v2 offset:5120
    ds_read_b64_tr_b16 v[206:207], v3 offset:2048
    ds_read_b64_tr_b16 v[208:209], v3 offset:5120
    s_waitcnt lgkmcnt(14)
    s_waitcnt lgkmcnt(6)
    v_mfma_f32_16x16x32_bf16 v[138:141], v[186:189], v[42:45], 0
    ds_read_b64_tr_b16 v[210:211], v2 offset:6144
    s_add_u32 m0, s63, 24576
    s_add_u32 s80, s82, 393216
    buffer_load_dwordx4 v232, s[12:15], s80 offen offset:0  lds
    v_mfma_f32_16x16x32_bf16 v[142:145], v[186:189], v[46:49], 0
    ds_read_b64_tr_b16 v[212:213], v2 offset:9216
    ds_read_b64_tr_b16 v[90:91], v102 offset:0
    v_mfma_f32_16x16x32_bf16 v[146:149], v[190:193], v[42:45], 0
    ds_read_b64_tr_b16 v[214:215], v3 offset:6144
    ds_read_b64_tr_b16 v[92:93], v102 offset:3072
    v_mfma_f32_16x16x32_bf16 v[150:153], v[190:193], v[46:49], 0
    ds_read_b64_tr_b16 v[216:217], v3 offset:9216
    s_waitcnt vmcnt(8)
    v_mfma_f32_16x16x32_bf16 v[154:157], v[194:197], v[42:45], 0
    ds_read_b64_tr_b16 v[186:187], v2 offset:7168
    buffer_load_dwordx4 v232, s[12:15], s80 offen offset:1024  lds
    v_mfma_f32_16x16x32_bf16 v[158:161], v[194:197], v[46:49], 0
    ds_read_b64_tr_b16 v[188:189], v2 offset:10240
    v_xor_b32 v40, 0, v105
    ds_read_b64 v[20:21], v40 offset:8192
    v_mfma_f32_16x16x32_bf16 a[208:211], v[16:19], v[42:45], 0
    v_xor_b32 v40, 32, v105
    ds_read_b64 v[22:23], v40 offset:8192
    v_xor_b32_e64 v40, 64, v105
    ds_read_b64 v[24:25], v40 offset:8192
    v_mfma_f32_16x16x32_bf16 a[216:219], v[42:45], v[42:45], 0
    v_xor_b32 v40, 96, v105
    ds_read_b64 v[26:27], v40 offset:8192
    s_waitcnt lgkmcnt(12)
    v_mfma_f32_16x16x32_bf16 v[162:165], v[198:201], v[42:45], 0
    ds_read_b64_tr_b16 v[190:191], v3 offset:7168
    buffer_load_dwordx4 v232, s[12:15], s80 offen offset:2048  lds
    v_mfma_f32_16x16x32_bf16 v[166:169], v[198:201], v[46:49], 0
    ds_read_b64_tr_b16 v[192:193], v3 offset:10240
    v_mfma_f32_16x16x32_bf16 a[212:215], v[16:19], v[46:49], 0
    v_mfma_f32_16x16x32_bf16 a[220:223], v[46:49], v[46:49], 0
    v_mfma_f32_16x16x32_bf16 v[170:173], v[202:205], v[42:45], 0
    ds_read_b64_tr_b16 v[194:195], v2 offset:8192
    s_waitcnt lgkmcnt(3)
    s_add_u32 m0, s61, 8192
    s_add_u32 s65, s64, 256
    buffer_load_dwordx4 v228, s[8:11], s65 offen offset:0  lds
    v_mfma_f32_16x16x32_bf16 v[174:177], v[202:205], v[46:49], 0
    ds_read_b64_tr_b16 v[196:197], v2 offset:11264
    v_mfma_f32_16x16x32_bf16 a[208:211], v[16:19], v[50:53], a[208:211]
    v_mfma_f32_16x16x32_bf16 a[216:219], v[50:53], v[50:53], a[216:219]
    v_mfma_f32_16x16x32_bf16 v[178:181], v[206:209], v[42:45], 0
    ds_read_b64_tr_b16 v[198:199], v3 offset:8192
    buffer_load_dwordx4 v229, s[8:11], s65 offen offset:1024  lds
    v_mfma_f32_16x16x32_bf16 v[182:185], v[206:209], v[46:49], 0
    ds_read_b64_tr_b16 v[200:201], v3 offset:11264
    v_mfma_f32_16x16x32_bf16 a[212:215], v[16:19], v[54:57], a[212:215]
    v_mfma_f32_16x16x32_bf16 a[220:223], v[54:57], v[54:57], a[220:223]
    v_mfma_f32_16x16x32_bf16 a[224:227], v[90:93], v[16:19], 0
    buffer_load_dwordx4 v230, s[8:11], s65 offen offset:2048  lds
    s_waitcnt vmcnt(6)
    s_barrier
    v_mfma_f32_16x16x32_bf16 v[138:141], v[210:213], v[50:53], v[138:141]
    ds_read_b64_tr_b16 v[202:203], v2 offset:12288
    ds_read_b128 v[58:61], v28 offset:4096
    v_mfma_f32_16x16x32_bf16 v[142:145], v[210:213], v[54:57], v[142:145]
    ds_read_b64_tr_b16 v[204:205], v2 offset:15360
    ds_read_b128 v[62:65], v28 offset:6144
    v_mfma_f32_16x16x32_bf16 v[146:149], v[214:217], v[50:53], v[146:149]
    ds_read_b64_tr_b16 v[206:207], v3 offset:12288
    ds_read_b128 v[66:69], v29 offset:4096
    v_mfma_f32_16x16x32_bf16 v[150:153], v[214:217], v[54:57], v[150:153]
    ds_read_b64_tr_b16 v[208:209], v3 offset:15360
    buffer_load_dwordx4 v231, s[8:11], s65 offen offset:3072  lds
    v_mfma_f32_16x16x32_bf16 v[154:157], v[186:189], v[50:53], v[154:157]
    ds_read_b64_tr_b16 v[210:211], v2 offset:13312
    ds_read_b128 v[70:73], v29 offset:6144
    v_mfma_f32_16x16x32_bf16 v[158:161], v[186:189], v[54:57], v[158:161]
    ds_read_b64_tr_b16 v[212:213], v2 offset:16384
    ds_read_b64_tr_b16 v[90:91], v102 offset:12288
    s_waitcnt lgkmcnt(11)
    v_mfma_f32_16x16x32_bf16 v[162:165], v[190:193], v[50:53], v[162:165]
    ds_read_b64_tr_b16 v[214:215], v3 offset:13312
    ds_read_b64_tr_b16 v[92:93], v102 offset:15360
    v_mfma_f32_16x16x32_bf16 v[166:169], v[190:193], v[54:57], v[166:169]
    ds_read_b64_tr_b16 v[216:217], v3 offset:16384
    s_mov_b64 exec, 0x3f
    buffer_load_dword a239, v41, s[12:15], s79 offen
    s_mov_b64 exec, -1
    v_mfma_f32_16x16x32_bf16 v[170:173], v[194:197], v[50:53], v[170:173]
    ds_read_b64_tr_b16 v[186:187], v2 offset:14336
    ds_write_b32 v104, v16
    v_mfma_f32_16x16x32_bf16 v[174:177], v[194:197], v[54:57], v[174:177]
    ds_read_b64_tr_b16 v[188:189], v2 offset:17408
    s_waitcnt lgkmcnt(13)
    v_mfma_f32_16x16x32_bf16 a[208:211], v[16:19], v[58:61], a[208:211]
L_pg0:
    s_cbranch_execz L_walked0
    v_mfma_f32_16x16x32_bf16 a[216:219], v[58:61], v[58:61], a[216:219]
    s_mov_b64 exec, 0xf0f0
    buffer_load_dword a239, v233, s[8:11], s1 offen
    s_mov_b64 exec, -1
    v_mfma_f32_16x16x32_bf16 v[178:181], v[198:201], v[50:53], v[178:181]
    ds_read_b64_tr_b16 v[190:191], v3 offset:14336
    v_mfma_f32_16x16x32_bf16 v[182:185], v[198:201], v[54:57], v[182:185]
    ds_read_b64_tr_b16 v[192:193], v3 offset:17408
    v_mfma_f32_16x16x32_bf16 a[212:215], v[16:19], v[62:65], a[212:215]
    v_mfma_f32_16x16x32_bf16 a[220:223], v[62:65], v[62:65], a[220:223]
    s_mov_b64 exec, 0xf
    buffer_load_dword a239, v41, s[16:19], s69 offen offset:1024
    buffer_load_dword a239, v239, s[16:19], s70 offen offset:1408
    s_mov_b64 exec, -1
    s_waitcnt lgkmcnt(9)
    v_mfma_f32_16x16x32_bf16 v[138:141], v[202:205], v[58:61], v[138:141]
    ds_read_b64_tr_b16 v[194:195], v2 offset:18432
    v_add_u32 v36, s67, v241
    v_mfma_f32_16x16x32_bf16 v[142:145], v[202:205], v[62:65], v[142:145]
    ds_read_b64_tr_b16 v[196:197], v2 offset:21504
    v_xor_b32_e64 v37, 64, v36
    v_mfma_f32_16x16x32_bf16 v[146:149], v[206:209], v[58:61], v[146:149]
    ds_read_b64_tr_b16 v[198:199], v3 offset:18432
    ds_read_b128 v[106:109], v36 offset:0
    v_mfma_f32_16x16x32_bf16 v[150:153], v[206:209], v[62:65], v[150:153]
    ds_read_b64_tr_b16 v[200:201], v3 offset:21504
    s_add_u32 m0, s63, 36864
    s_add_u32 s80, s82, 589824
    buffer_load_dwordx4 v232, s[12:15], s80 offen offset:0  lds
    v_mfma_f32_16x16x32_bf16 v[154:157], v[210:213], v[58:61], v[154:157]
    ds_read_b64_tr_b16 v[202:203], v2 offset:19456
    ds_read_b128 v[110:113], v37 offset:0
    v_mfma_f32_16x16x32_bf16 v[158:161], v[210:213], v[62:65], v[158:161]
    ds_read_b64_tr_b16 v[204:205], v2 offset:22528
    ds_read_b128 v[114:117], v36 offset:1024
    s_waitcnt lgkmcnt(14)
    v_mfma_f32_16x16x32_bf16 a[224:227], v[90:93], v[16:19], a[224:227]
    ds_read_b128 v[118:121], v37 offset:1024
    s_waitcnt lgkmcnt(10)
    v_mfma_f32_16x16x32_bf16 v[162:165], v[214:217], v[58:61], v[162:165]
    ds_read_b64_tr_b16 v[206:207], v3 offset:19456
    buffer_load_dwordx4 v232, s[12:15], s80 offen offset:1024  lds
    v_mfma_f32_16x16x32_bf16 v[166:169], v[214:217], v[62:65], v[166:169]
    ds_read_b64_tr_b16 v[208:209], v3 offset:22528
    v_mfma_f32_16x16x32_bf16 v[170:173], v[186:189], v[58:61], v[170:173]
    ds_read_b64_tr_b16 v[210:211], v2 offset:20480
    v_mfma_f32_16x16x32_bf16 v[174:177], v[186:189], v[62:65], v[174:177]
    ds_read_b64_tr_b16 v[212:213], v2 offset:23552
    v_mfma_f32_16x16x32_bf16 a[208:211], v[16:19], v[66:69], a[208:211]
    buffer_load_dwordx4 v232, s[12:15], s80 offen offset:2048  lds
    v_mfma_f32_16x16x32_bf16 a[216:219], v[66:69], v[66:69], a[216:219]
    v_mfma_f32_16x16x32_bf16 v[178:181], v[190:193], v[58:61], v[178:181]
    ds_read_b64_tr_b16 v[214:215], v3 offset:20480
    v_mfma_f32_16x16x32_bf16 v[182:185], v[190:193], v[62:65], v[182:185]
    ds_read_b64_tr_b16 v[216:217], v3 offset:23552
    v_mfma_f32_16x16x32_bf16 a[212:215], v[16:19], v[70:73], a[212:215]
    s_add_u32 m0, s61, 0
    s_add_u32 s65, s64, 384
    buffer_load_dwordx4 v228, s[8:11], s65 offen offset:0  lds
    v_mfma_f32_16x16x32_bf16 a[220:223], v[70:73], v[70:73], a[220:223]
    s_waitcnt vmcnt(12)
    s_barrier
    s_waitcnt vmcnt(8)
    s_waitcnt lgkmcnt(8)
    v_mfma_f32_16x16x32_bf16 v[138:141], v[194:197], v[66:69], v[138:141]
    ds_read_b64_tr_b16 v[186:187], v2 offset:24576
    ds_read_b128 v[74:77], v28 offset:8192
    v_mfma_f32_16x16x32_bf16 v[142:145], v[194:197], v[70:73], v[142:145]
    ds_read_b64_tr_b16 v[188:189], v2 offset:27648
    ds_read_b128 v[78:81], v28 offset:10240
    s_waitcnt lgkmcnt(10)
    v_mfma_f32_16x16x32_bf16 v[130:133], v[16:19], v[106:109], 0
    buffer_load_dwordx4 v229, s[8:11], s65 offen offset:1024  lds
    v_mfma_f32_16x16x32_bf16 v[134:137], v[106:109], v[106:109], 0
    ds_read_b128 v[82:85], v29 offset:8192
    ds_read_b128 v[86:89], v29 offset:10240
    v_mfma_f32_16x16x32_bf16 v[146:149], v[198:201], v[66:69], v[146:149]
    ds_read_b64_tr_b16 v[190:191], v3 offset:24576
    ds_read_b64_tr_b16 v[90:91], v102 offset:24576
    v_mfma_f32_16x16x32_bf16 v[150:153], v[198:201], v[70:73], v[150:153]
    ds_read_b64_tr_b16 v[192:193], v3 offset:27648
    ds_read_b64_tr_b16 v[92:93], v102 offset:27648
    v_mfma_f32_16x16x32_bf16 v[130:133], v[16:19], v[110:113], v[130:133]
    buffer_load_dwordx4 v230, s[8:11], s65 offen offset:2048  lds
    v_mfma_f32_16x16x32_bf16 v[134:137], v[110:113], v[110:113], v[134:137]
    v_mfma_f32_16x16x32_bf16 v[154:157], v[202:205], v[66:69], v[154:157]
    ds_read_b64_tr_b16 v[194:195], v2 offset:25600
    v_mfma_f32_16x16x32_bf16 v[158:161], v[202:205], v[70:73], v[158:161]
    ds_read_b64_tr_b16 v[196:197], v2 offset:28672
    v_mfma_f32_16x16x32_bf16 v[130:133], v[16:19], v[114:117], v[130:133]
    buffer_load_dwordx4 v231, s[8:11], s65 offen offset:3072  lds
    v_mfma_f32_16x16x32_bf16 v[134:137], v[114:117], v[114:117], v[134:137]
    s_waitcnt lgkmcnt(12)
    v_mfma_f32_16x16x32_bf16 v[162:165], v[206:209], v[66:69], v[162:165]
    ds_read_b64_tr_b16 v[198:199], v3 offset:25600
    v_mfma_f32_16x16x32_bf16 v[166:169], v[206:209], v[70:73], v[166:169]
    ds_read_b64_tr_b16 v[200:201], v3 offset:28672
    v_mfma_f32_16x16x32_bf16 v[130:133], v[16:19], v[118:121], v[130:133]
    s_add_u32 m0, s61, 4096
    s_add_u32 s65, s64, 512
    buffer_load_dwordx4 v228, s[8:11], s65 offen offset:0  lds
    v_mfma_f32_16x16x32_bf16 v[134:137], v[118:121], v[118:121], v[134:137]
    v_mfma_f32_16x16x32_bf16 v[170:173], v[210:213], v[66:69], v[170:173]
    ds_read_b64_tr_b16 v[202:203], v2 offset:26624
    v_mfma_f32_16x16x32_bf16 v[174:177], v[210:213], v[70:73], v[174:177]
    ds_read_b64_tr_b16 v[204:205], v2 offset:29696
    s_waitcnt lgkmcnt(12)
    v_mfma_f32_16x16x32_bf16 a[208:211], v[16:19], v[74:77], a[208:211]
    buffer_load_dwordx4 v229, s[8:11], s65 offen offset:1024  lds
    v_mfma_f32_16x16x32_bf16 a[216:219], v[74:77], v[74:77], a[216:219]
    v_mfma_f32_16x16x32_bf16 v[178:181], v[214:217], v[66:69], v[178:181]
    ds_read_b64_tr_b16 v[206:207], v3 offset:26624
    v_mfma_f32_16x16x32_bf16 v[182:185], v[214:217], v[70:73], v[182:185]
    ds_read_b64_tr_b16 v[208:209], v3 offset:29696
    v_mfma_f32_16x16x32_bf16 a[212:215], v[16:19], v[78:81], a[212:215]
    buffer_load_dwordx4 v230, s[8:11], s65 offen offset:2048  lds
    v_mfma_f32_16x16x32_bf16 a[220:223], v[78:81], v[78:81], a[220:223]
    s_waitcnt vmcnt(3)
    s_waitcnt lgkmcnt(6)
    v_mfma_f32_16x16x32_bf16 v[138:141], v[186:189], v[74:77], v[138:141]
    ds_read_b64_tr_b16 v[210:211], v2 offset:30720
    ds_read_b128 v[42:45], v28 offset:0
    v_mfma_f32_16x16x32_bf16 v[142:145], v[186:189], v[78:81], v[142:145]
    ds_read_b64_tr_b16 v[212:213], v2 offset:33792
    ds_read_b128 v[46:49], v28 offset:2048
    v_mfma_f32_16x16x32_bf16 v[146:149], v[190:193], v[74:77], v[146:149]
    ds_read_b64_tr_b16 v[214:215], v3 offset:30720
    buffer_load_dwordx4 v231, s[8:11], s65 offen offset:3072  lds
    v_mfma_f32_16x16x32_bf16 v[150:153], v[190:193], v[78:81], v[150:153]
    ds_read_b64_tr_b16 v[216:217], v3 offset:33792
    ds_read_b128 v[50:53], v29 offset:0
    v_mfma_f32_16x16x32_bf16 v[154:157], v[194:197], v[74:77], v[154:157]
    ds_read_b64_tr_b16 v[186:187], v2 offset:31744
    ds_read_b128 v[54:57], v29 offset:2048
    v_mfma_f32_16x16x32_bf16 v[158:161], v[194:197], v[78:81], v[158:161]
    ds_read_b64_tr_b16 v[188:189], v2 offset:34816
    ds_read_b64_tr_b16 v[106:107], v33 offset:0
    v_mfma_f32_16x16x32_bf16 a[208:211], v[16:19], v[82:85], a[208:211]
    s_add_u32 m0, s63, 49152
    s_add_u32 s80, s82, 786432
    buffer_load_dwordx4 v232, s[12:15], s80 offen offset:0  lds
    v_mfma_f32_16x16x32_bf16 a[216:219], v[82:85], v[82:85], a[216:219]
    ds_read_b64_tr_b16 v[108:109], v33 offset:3072
    ds_read_b128 v[110:113], v241 offset:0
    v_mfma_f32_16x16x32_bf16 a[224:227], v[90:93], v[16:19], a[224:227]
    ds_read_b64_tr_b16 v[114:115], v33 offset:6144
    ds_read_b64_tr_b16 v[116:117], v33 offset:9216
    s_waitcnt lgkmcnt(14)
    v_mfma_f32_16x16x32_bf16 v[162:165], v[198:201], v[74:77], v[162:165]
    ds_read_b64_tr_b16 v[190:191], v3 offset:31744
    ds_read_b128 v[118:121], v238 offset:0
    v_mfma_f32_16x16x32_bf16 v[166:169], v[198:201], v[78:81], v[166:169]
    ds_read_b64_tr_b16 v[192:193], v3 offset:34816
    buffer_load_dwordx4 v232, s[12:15], s80 offen offset:1024  lds
    v_mfma_f32_16x16x32_bf16 a[212:215], v[16:19], v[86:89], a[212:215]
    v_cndmask_b32 v223, v134, v135, s[88:89]
    v_cndmask_b32 v223, v223, v136, s[90:91]
    v_mfma_f32_16x16x32_bf16 a[220:223], v[86:89], v[86:89], a[220:223]
    v_cndmask_b32 v223, v223, v137, s[92:93]
    v_cndmask_b32 v222, 0, v130, s[94:95]
    v_mfma_f32_16x16x32_bf16 v[170:173], v[202:205], v[74:77], v[170:173]
    ds_read_b64_tr_b16 v[194:195], v2 offset:32768
    v_cndmask_b32 v223, 0, v223, s[94:95]
    v_mfma_f32_16x16x32_bf16 v[174:177], v[202:205], v[78:81], v[174:177]
    ds_read_b64_tr_b16 v[196:197], v2 offset:35840
    buffer_load_dwordx4 v232, s[12:15], s80 offen offset:2048  lds
    s_waitcnt lgkmcnt(14)
    v_mfma_f32_16x16x32_bf16 a[208:211], v[16:19], v[42:45], a[208:211]
    s_lshl_b32 s68, s44, 7
    s_add_u32 s68, s68, 161280
    v_lshl_add_u32 v36, v15, 1, s68
    s_mov_b64 exec, s[94:95]
    ds_write_b64 v36, v[222:223]
    s_mov_b64 exec, -1
    v_mfma_f32_16x16x32_bf16 a[216:219], v[42:45], v[42:45], a[216:219]
    v_mfma_f32_16x16x32_bf16 v[178:181], v[206:209], v[74:77], v[178:181]
    ds_read_b64_tr_b16 v[198:199], v3 offset:32768
    v_mfma_f32_16x16x32_bf16 v[182:185], v[206:209], v[78:81], v[182:185]
    ds_read_b64_tr_b16 v[200:201], v3 offset:35840
    s_add_u32 m0, s61, 8192
    s_add_u32 s65, s64, 640
    buffer_load_dwordx4 v228, s[8:11], s65 offen offset:0  lds
    v_mfma_f32_16x16x32_bf16 a[212:215], v[16:19], v[46:49], a[212:215]
    v_mfma_f32_16x16x32_bf16 a[220:223], v[46:49], v[46:49], a[220:223]
    s_barrier
    s_waitcnt lgkmcnt(13)
    v_mfma_f32_16x16x32_bf16 v[138:141], v[210:213], v[82:85], v[138:141]
    ds_read_b64_tr_b16 v[202:203], v2 offset:36864
    ds_read_b64_tr_b16 v[90:91], v102 offset:36864
    v_mfma_f32_16x16x32_bf16 v[142:145], v[210:213], v[86:89], v[142:145]
    ds_read_b64_tr_b16 v[204:205], v2 offset:39936
    buffer_load_dwordx4 v229, s[8:11], s65 offen offset:1024  lds
    v_mfma_f32_16x16x32_bf16 v[146:149], v[214:217], v[82:85], v[146:149]
    ds_read_b64_tr_b16 v[206:207], v3 offset:36864
    ds_read_b64_tr_b16 v[92:93], v102 offset:39936
    v_mfma_f32_16x16x32_bf16 v[150:153], v[214:217], v[86:89], v[150:153]
    ds_read_b64_tr_b16 v[208:209], v3 offset:39936
    ds_read_b64_tr_b16 v[122:123], v33 offset:12288
    s_waitcnt lgkmcnt(14)
    v_mfma_f32_16x16x32_bf16 v[224:227], v[106:109], v[110:113], 0
    ds_read_b64_tr_b16 v[124:125], v33 offset:15360
    ds_read_b128 v[126:129], v241 offset:1024
    s_waitcnt lgkmcnt(14)
    v_mfma_f32_16x16x32_bf16 v[224:227], v[114:117], v[118:121], v[224:227]
    buffer_load_dwordx4 v230, s[8:11], s65 offen offset:2048  lds
    v_mfma_f32_16x16x32_bf16 v[154:157], v[186:189], v[82:85], v[154:157]
    ds_read_b64_tr_b16 v[210:211], v2 offset:37888
    ds_read_b64_tr_b16 v[130:131], v33 offset:18432
    v_mfma_f32_16x16x32_bf16 v[158:161], v[186:189], v[86:89], v[158:161]
    ds_read_b64_tr_b16 v[212:213], v2 offset:40960
    ds_read_b64_tr_b16 v[132:133], v33 offset:21504
    s_waitcnt lgkmcnt(13)
    v_mfma_f32_16x16x32_bf16 v[162:165], v[190:193], v[82:85], v[162:165]
    ds_read_b64_tr_b16 v[214:215], v3 offset:37888
    ds_read_b128 v[134:137], v238 offset:1024
    v_mfma_f32_16x16x32_bf16 v[166:169], v[190:193], v[86:89], v[166:169]
    ds_read_b64_tr_b16 v[216:217], v3 offset:40960
    buffer_load_dwordx4 v231, s[8:11], s65 offen offset:3072  lds
    v_mfma_f32_16x16x32_bf16 v[170:173], v[194:197], v[82:85], v[170:173]
    ds_read_b64_tr_b16 v[186:187], v2 offset:38912
    v_mfma_f32_16x16x32_bf16 v[174:177], v[194:197], v[86:89], v[174:177]
    ds_read_b64_tr_b16 v[188:189], v2 offset:41984
    v_mfma_f32_16x16x32_bf16 a[208:211], v[16:19], v[50:53], a[208:211]
    v_mfma_f32_16x16x32_bf16 a[216:219], v[50:53], v[50:53], a[216:219]
    s_add_u32 m0, s63, 61440
    s_add_u32 s80, s82, 983040
    buffer_load_dwordx4 v232, s[12:15], s80 offen offset:0  lds
    v_mfma_f32_16x16x32_bf16 v[178:181], v[198:201], v[82:85], v[178:181]
    ds_read_b64_tr_b16 v[190:191], v3 offset:38912
    v_mfma_f32_16x16x32_bf16 v[182:185], v[198:201], v[86:89], v[182:185]
    ds_read_b64_tr_b16 v[192:193], v3 offset:41984
    v_mfma_f32_16x16x32_bf16 a[212:215], v[16:19], v[54:57], a[212:215]
    v_mfma_f32_16x16x32_bf16 a[220:223], v[54:57], v[54:57], a[220:223]
    buffer_load_dwordx4 v232, s[12:15], s80 offen offset:1024  lds
    s_waitcnt vmcnt(9)
    s_waitcnt lgkmcnt(8)
    v_mfma_f32_16x16x32_bf16 v[138:141], v[202:205], v[42:45], v[138:141]
    ds_read_b64_tr_b16 v[194:195], v2 offset:43008
    ds_read_b128 v[58:61], v28 offset:4096
    v_mfma_f32_16x16x32_bf16 v[142:145], v[202:205], v[46:49], v[142:145]
    ds_read_b64_tr_b16 v[196:197], v2 offset:46080
    ds_read_b128 v[62:65], v28 offset:6144
    v_mfma_f32_16x16x32_bf16 v[146:149], v[206:209], v[42:45], v[146:149]
    ds_read_b64_tr_b16 v[198:199], v3 offset:43008
    ds_read_b128 v[66:69], v29 offset:4096
    v_mfma_f32_16x16x32_bf16 v[150:153], v[206:209], v[46:49], v[150:153]
    ds_read_b64_tr_b16 v[200:201], v3 offset:46080
    buffer_load_dwordx4 v232, s[12:15], s80 offen offset:2048  lds
    v_mfma_f32_16x16x32_bf16 v[224:227], v[122:125], v[126:129], v[224:227]
    ds_read_b128 v[70:73], v29 offset:6144
    ds_read_b64_tr_b16 v[106:107], v33 offset:24576
    s_waitcnt lgkmcnt(14)
    v_mfma_f32_16x16x32_bf16 v[224:227], v[130:133], v[134:137], v[224:227]
    ds_read_b64_tr_b16 v[108:109], v33 offset:27648
    ds_read_b128 v[110:113], v241 offset:2048
    v_mfma_f32_16x16x32_bf16 v[154:157], v[210:213], v[42:45], v[154:157]
    ds_read_b64_tr_b16 v[202:203], v2 offset:44032
    ds_read_b64_tr_b16 v[114:115], v33 offset:30720
    v_mfma_f32_16x16x32_bf16 v[158:161], v[210:213], v[46:49], v[158:161]
    ds_read_b64_tr_b16 v[204:205], v2 offset:47104
    s_add_u32 m0, s61, 0
    s_add_u32 s65, s64, 768
    buffer_load_dwordx4 v228, s[8:11], s65 offen offset:0  lds
    s_waitcnt lgkmcnt(10)
    v_mfma_f32_16x16x32_bf16 a[208:211], v[16:19], v[58:61], a[208:211]
    ds_read_b64_tr_b16 v[116:117], v33 offset:33792
    ds_read_b128 v[118:121], v238 offset:2048
    v_mfma_f32_16x16x32_bf16 a[216:219], v[58:61], v[58:61], a[216:219]
    v_lshrrev_b32 v39, 1, v32
    v_lshrrev_b32 v105, 1, v15
    v_mfma_f32_16x16x32_bf16 a[224:227], v[90:93], v[16:19], a[224:227]
    v_and_b32 v105, 24, v105
    v_xor_b32_e64 v105, v105, v39
    v_mfma_f32_16x16x32_bf16 v[162:165], v[214:217], v[42:45], v[162:165]
    ds_read_b64_tr_b16 v[206:207], v3 offset:44032
    buffer_load_dwordx4 v229, s[8:11], s65 offen offset:1024  lds
    v_mfma_f32_16x16x32_bf16 v[166:169], v[214:217], v[46:49], v[166:169]
    ds_read_b64_tr_b16 v[208:209], v3 offset:47104
    v_lshl_or_b32 v105, v15, 3, v105
    v_mfma_f32_16x16x32_bf16 a[212:215], v[16:19], v[62:65], a[212:215]
    v_lshrrev_b32 v38, 1, v1
    v_xor_b32 v38, v38, v39
    v_mfma_f32_16x16x32_bf16 a[220:223], v[62:65], v[62:65], a[220:223]
    s_add_u32 s68, s63, 144384
    s_cmp_eq_u32 s44, 0
    s_cselect_b32 s68, 161792, s68
    v_add_u32 v233, s68, v105
    v_add_u32 v39, s68, v38
    s_lshl_b32 s68, s44, 9
    s_add_u32 s68, s68, 161792
    v_add_u32_e64 v237, s68, v105
    v_mfma_f32_16x16x32_bf16 v[170:173], v[186:189], v[42:45], v[170:173]
    ds_read_b64_tr_b16 v[210:211], v2 offset:45056
    buffer_load_dwordx4 v230, s[8:11], s65 offen offset:2048  lds
    v_mfma_f32_16x16x32_bf16 v[174:177], v[186:189], v[46:49], v[174:177]
    ds_read_b64_tr_b16 v[212:213], v2 offset:48128
    s_add_u32 s68, s63, 147456
    v_add_u32 v105, s68, v105
    v_add_u32 v38, s68, v38
    s_waitcnt lgkmcnt(12)
    v_mfma_f32_16x16x32_bf16 a[208:211], v[16:19], v[66:69], a[208:211]
    v_mfma_f32_16x16x32_bf16 a[216:219], v[66:69], v[66:69], a[216:219]
    v_mfma_f32_16x16x32_bf16 v[178:181], v[190:193], v[42:45], v[178:181]
    ds_read_b64_tr_b16 v[214:215], v3 offset:45056
    buffer_load_dwordx4 v231, s[8:11], s65 offen offset:3072  lds
    v_mfma_f32_16x16x32_bf16 v[182:185], v[190:193], v[46:49], v[182:185]
    ds_read_b64_tr_b16 v[216:217], v3 offset:48128
    v_mfma_f32_16x16x32_bf16 a[212:215], v[16:19], v[70:73], a[212:215]
    v_mfma_f32_16x16x32_bf16 a[220:223], v[70:73], v[70:73], a[220:223]
    s_waitcnt vmcnt(11)
    s_barrier
    s_waitcnt vmcnt(7)
    s_waitcnt lgkmcnt(8)
    v_mfma_f32_16x16x32_bf16 v[138:141], v[194:197], v[50:53], v[138:141]
    ds_read_b64_tr_b16 v[186:187], v2 offset:49152
    s_add_u32 m0, s63, 73728
    s_add_u32 s80, s82, 1179648
    buffer_load_dwordx4 v232, s[12:15], s80 offen offset:0  lds
    v_mfma_f32_16x16x32_bf16 v[142:145], v[194:197], v[54:57], v[142:145]
    ds_read_b64_tr_b16 v[188:189], v2 offset:52224
    ds_read_b128 v[74:77], v28 offset:8192
    v_mfma_f32_16x16x32_bf16 v[146:149], v[198:201], v[50:53], v[146:149]
    ds_read_b64_tr_b16 v[190:191], v3 offset:49152
    ds_read_b128 v[78:81], v28 offset:10240
    v_mfma_f32_16x16x32_bf16 v[150:153], v[198:201], v[54:57], v[150:153]
    ds_read_b64_tr_b16 v[192:193], v3 offset:52224
    ds_read_b128 v[82:85], v29 offset:8192
    v_mfma_f32_16x16x32_bf16 v[224:227], v[106:109], v[110:113], v[224:227]
    buffer_load_dwordx4 v232, s[12:15], s80 offen offset:1024  lds
    s_waitcnt lgkmcnt(13)
    v_mfma_f32_16x16x32_bf16 v[224:227], v[114:117], v[118:121], v[224:227]
    ds_read_b128 v[86:89], v29 offset:10240
    v_add_u32 v102, 49152, v102
    v_mfma_f32_16x16x32_bf16 v[154:157], v[202:205], v[50:53], v[154:157]
    ds_read_b64_tr_b16 v[194:195], v2 offset:50176
    ds_read_b64_tr_b16 v[90:91], v102 offset:0
    v_mfma_f32_16x16x32_bf16 v[158:161], v[202:205], v[54:57], v[158:161]
    ds_read_b64_tr_b16 v[196:197], v2 offset:53248
    ds_read_b64_tr_b16 v[92:93], v102 offset:3072
    s_waitcnt lgkmcnt(12)
    v_mfma_f32_16x16x32_bf16 v[162:165], v[206:209], v[50:53], v[162:165]
    ds_read_b64_tr_b16 v[198:199], v3 offset:50176
    buffer_load_dwordx4 v232, s[12:15], s80 offen offset:2048  lds
    v_mfma_f32_16x16x32_bf16 v[166:169], v[206:209], v[54:57], v[166:169]
    ds_read_b64_tr_b16 v[200:201], v3 offset:53248
    ds_read_b64_tr_b16 v[122:123], v33 offset:36864
    v_mfma_f32_16x16x32_bf16 v[170:173], v[210:213], v[50:53], v[170:173]
    ds_read_b64_tr_b16 v[202:203], v2 offset:51200
    ds_read_b64_tr_b16 v[124:125], v33 offset:39936
    v_mfma_f32_16x16x32_bf16 v[174:177], v[210:213], v[54:57], v[174:177]
    ds_read_b64_tr_b16 v[204:205], v2 offset:54272
    ds_read_b128 v[126:129], v241 offset:3072
    s_waitcnt lgkmcnt(14)
    v_mfma_f32_16x16x32_bf16 a[208:211], v[16:19], v[74:77], a[208:211]
    s_add_u32 m0, s61, 4096
    s_add_u32 s65, s64, 896
    buffer_load_dwordx4 v228, s[8:11], s65 offen offset:0  lds
    v_mfma_f32_16x16x32_bf16 a[216:219], v[74:77], v[74:77], a[216:219]
    ds_read_b64_tr_b16 v[130:131], v33 offset:43008
    ds_read_b64_tr_b16 v[132:133], v33 offset:46080
    v_mfma_f32_16x16x32_bf16 v[178:181], v[214:217], v[50:53], v[178:181]
    ds_read_b64_tr_b16 v[206:207], v3 offset:51200
    ds_read_b128 v[134:137], v238 offset:3072
    v_mfma_f32_16x16x32_bf16 v[182:185], v[214:217], v[54:57], v[182:185]
    ds_read_b64_tr_b16 v[208:209], v3 offset:54272
    v_mfma_f32_16x16x32_bf16 a[212:215], v[16:19], v[78:81], a[212:215]
    buffer_load_dwordx4 v229, s[8:11], s65 offen offset:1024  lds
    v_mfma_f32_16x16x32_bf16 a[220:223], v[78:81], v[78:81], a[220:223]
    s_waitcnt lgkmcnt(13)
    v_mfma_f32_16x16x32_bf16 v[138:141], v[186:189], v[58:61], v[138:141]
    ds_read_b64_tr_b16 v[210:211], v2 offset:55296
    ds_read_b64_tr_b16 v[106:107], v33 offset:49152
    v_mfma_f32_16x16x32_bf16 v[142:145], v[186:189], v[62:65], v[142:145]
    ds_read_b64_tr_b16 v[212:213], v2 offset:58368
    ds_read_b64_tr_b16 v[108:109], v33 offset:52224
    v_mfma_f32_16x16x32_bf16 v[146:149], v[190:193], v[58:61], v[146:149]
    ds_read_b64_tr_b16 v[214:215], v3 offset:55296
    buffer_load_dwordx4 v230, s[8:11], s65 offen offset:2048  lds
    v_mfma_f32_16x16x32_bf16 v[150:153], v[190:193], v[62:65], v[150:153]
    ds_read_b64_tr_b16 v[216:217], v3 offset:58368
    ds_read_b128 v[110:113], v241 offset:4096
    s_waitcnt lgkmcnt(12)
    v_mfma_f32_16x16x32_bf16 v[224:227], v[122:125], v[126:129], v[224:227]
    ds_read_b64_tr_b16 v[114:115], v33 offset:55296
    ds_read_b64_tr_b16 v[116:117], v33 offset:58368
    s_waitcnt lgkmcnt(10)
    v_mfma_f32_16x16x32_bf16 v[224:227], v[130:133], v[134:137], v[224:227]
    ds_read_b128 v[118:121], v238 offset:4096
    v_mfma_f32_16x16x32_bf16 v[154:157], v[194:197], v[58:61], v[154:157]
    ds_read_b64_tr_b16 v[186:187], v2 offset:56320
    buffer_load_dwordx4 v231, s[8:11], s65 offen offset:3072  lds
    v_mfma_f32_16x16x32_bf16 v[158:161], v[194:197], v[62:65], v[158:161]
    ds_read_b64_tr_b16 v[188:189], v2 offset:59392
    v_mfma_f32_16x16x32_bf16 a[224:227], v[90:93], v[16:19], a[224:227]
    s_waitcnt lgkmcnt(12)
    v_mfma_f32_16x16x32_bf16 v[162:165], v[198:201], v[58:61], v[162:165]
    ds_read_b64_tr_b16 v[190:191], v3 offset:56320
    v_mfma_f32_16x16x32_bf16 v[166:169], v[198:201], v[62:65], v[166:169]
    ds_read_b64_tr_b16 v[192:193], v3 offset:59392
    s_add_u32 m0, s63, 86016
    s_add_u32 s80, s82, 1376256
    buffer_load_dwordx4 v232, s[12:15], s80 offen offset:0  lds
    v_mfma_f32_16x16x32_bf16 v[170:173], v[202:205], v[58:61], v[170:173]
    ds_read_b64_tr_b16 v[194:195], v2 offset:57344
    v_mfma_f32_16x16x32_bf16 v[174:177], v[202:205], v[62:65], v[174:177]
    ds_read_b64_tr_b16 v[196:197], v2 offset:60416
    v_mfma_f32_16x16x32_bf16 a[208:211], v[16:19], v[82:85], a[208:211]
    v_mfma_f32_16x16x32_bf16 a[216:219], v[82:85], v[82:85], a[216:219]
    buffer_load_dwordx4 v232, s[12:15], s80 offen offset:1024  lds
    v_mfma_f32_16x16x32_bf16 v[178:181], v[206:209], v[58:61], v[178:181]
    ds_read_b64_tr_b16 v[198:199], v3 offset:57344
    v_mfma_f32_16x16x32_bf16 v[182:185], v[206:209], v[62:65], v[182:185]
    ds_read_b64_tr_b16 v[200:201], v3 offset:60416
    v_mfma_f32_16x16x32_bf16 a[212:215], v[16:19], v[86:89], a[212:215]
    v_mfma_f32_16x16x32_bf16 a[220:223], v[86:89], v[86:89], a[220:223]
    buffer_load_dwordx4 v232, s[12:15], s80 offen offset:2048  lds
    s_waitcnt vmcnt(14)
    s_barrier
    s_waitcnt vmcnt(10)
    s_waitcnt lgkmcnt(6)
    v_mfma_f32_16x16x32_bf16 v[138:141], v[210:213], v[66:69], v[138:141]
    ds_read_b64_tr_b16 v[202:203], v2 offset:61440
    ds_read_b128 v[42:45], v28 offset:0
    v_mfma_f32_16x16x32_bf16 v[142:145], v[210:213], v[70:73], v[142:145]
    ds_read_b64_tr_b16 v[204:205], v2 offset:64512
    ds_read_b128 v[46:49], v28 offset:2048
    v_mfma_f32_16x16x32_bf16 v[146:149], v[214:217], v[66:69], v[146:149]
    ds_read_b64_tr_b16 v[206:207], v3 offset:61440
    ds_read_b128 v[50:53], v29 offset:0
    v_mfma_f32_16x16x32_bf16 v[150:153], v[214:217], v[70:73], v[150:153]
    ds_read_b64_tr_b16 v[208:209], v3 offset:64512
    s_add_u32 m0, s61, 8192
    s_add_u32 s81, s96, 0
    buffer_load_dwordx4 v8, s[16:19], s81 offen offset:0  lds
    v_mfma_f32_16x16x32_bf16 v[224:227], v[106:109], v[110:113], v[224:227]
    ds_read_b128 v[54:57], v29 offset:2048
    ds_read_b64_tr_b16 v[90:91], v102 offset:12288
    v_mfma_f32_16x16x32_bf16 v[224:227], v[114:117], v[118:121], v[224:227]
    ds_read_b64_tr_b16 v[92:93], v102 offset:15360
    ds_read_b64_tr_b16 v[122:123], v240 offset:0
    v_mfma_f32_16x16x32_bf16 v[154:157], v[186:189], v[66:69], v[154:157]
    ds_read_b64_tr_b16 v[210:211], v2 offset:62464
    ds_read_b64_tr_b16 v[124:125], v240 offset:3072
    v_mfma_f32_16x16x32_bf16 v[158:161], v[186:189], v[70:73], v[158:161]
    ds_read_b64_tr_b16 v[212:213], v4 offset:0
    buffer_load_dwordx4 v9, s[16:19], s81 offen offset:1024  lds
    s_waitcnt lgkmcnt(14)
    v_mfma_f32_16x16x32_bf16 v[162:165], v[190:193], v[66:69], v[162:165]
    ds_read_b64_tr_b16 v[214:215], v3 offset:62464
    ds_read_b128 v[126:129], v241 offset:5120
    v_mfma_f32_16x16x32_bf16 v[166:169], v[190:193], v[70:73], v[166:169]
    ds_read_b64_tr_b16 v[216:217], v5 offset:0
    v_lshlrev_b32_e64 v36, 3, v0
    v_mfma_f32_16x16x32_bf16 v[170:173], v[194:197], v[66:69], v[170:173]
    ds_read_b64_tr_b16 v[186:187], v2 offset:63488
    v_add_u32 v36, 161280, v36
    v_mfma_f32_16x16x32_bf16 v[174:177], v[194:197], v[70:73], v[174:177]
    ds_read_b64_tr_b16 v[188:189], v4 offset:1024
    buffer_load_dwordx4 v10, s[16:19], s81 offen offset:2048  lds
    s_waitcnt lgkmcnt(14)
    v_mfma_f32_16x16x32_bf16 a[208:211], v[16:19], v[42:45], a[208:211]
    ds_read_b64 v[222:223], v36
    v_mfma_f32_16x16x32_bf16 a[216:219], v[42:45], v[42:45], a[216:219]
    v_mfma_f32_16x16x32_bf16 v[178:181], v[198:201], v[66:69], v[178:181]
    ds_read_b64_tr_b16 v[190:191], v3 offset:63488
    v_mfma_f32_16x16x32_bf16 v[182:185], v[198:201], v[70:73], v[182:185]
    ds_read_b64_tr_b16 v[192:193], v5 offset:1024
    buffer_load_dwordx4 v11, s[16:19], s81 offen offset:3072  lds
    v_mfma_f32_16x16x32_bf16 a[212:215], v[16:19], v[46:49], a[212:215]
    v_mfma_f32_16x16x32_bf16 a[220:223], v[46:49], v[46:49], a[220:223]
    s_waitcnt lgkmcnt(8)
    v_mfma_f32_16x16x32_bf16 v[138:141], v[202:205], v[74:77], v[138:141]
    ds_read_b64_tr_b16 v[194:195], v4 offset:2048
    ds_read_b64_tr_b16 v[130:131], v240 offset:6144
    v_mfma_f32_16x16x32_bf16 v[142:145], v[202:205], v[78:81], v[142:145]
    ds_read_b64_tr_b16 v[196:197], v4 offset:5120
    s_add_u32 m0, s61, 0
    s_add_u32 s81, s96, 32768
    buffer_load_dwordx4 v8, s[16:19], s81 offen offset:0  lds
    v_mfma_f32_16x16x32_bf16 v[146:149], v[206:209], v[74:77], v[146:149]
    ds_read_b64_tr_b16 v[198:199], v5 offset:2048
    ds_read_b64_tr_b16 v[132:133], v240 offset:9216
    v_mfma_f32_16x16x32_bf16 v[150:153], v[206:209], v[78:81], v[150:153]
    ds_read_b64_tr_b16 v[200:201], v5 offset:5120
    ds_read_b128 v[134:137], v238 offset:5120
    s_waitcnt lgkmcnt(13)
    v_mfma_f32_16x16x32_bf16 v[224:227], v[122:125], v[126:129], v[224:227]
    s_waitcnt lgkmcnt(9)
    v_permlane16_swap_b32 v222, v223
    v_mfma_f32_16x16x32_bf16 v[154:157], v[210:213], v[74:77], v[154:157]
    ds_read_b64_tr_b16 v[202:203], v4 offset:3072
    buffer_load_dwordx4 v9, s[16:19], s81 offen offset:1024  lds
    v_mfma_f32_16x16x32_bf16 v[158:161], v[210:213], v[78:81], v[158:161]
    ds_read_b64_tr_b16 v[204:205], v4 offset:6144
    v_add_f32 v222, v222, v223
    v_mfma_f32_16x16x32_bf16 a[224:227], v[90:93], v[16:19], a[224:227]
    v_mov_b32 v36, v222
    s_nop 1
    v_permlane32_swap_b32 v222, v36
    s_waitcnt lgkmcnt(9)
    v_mfma_f32_16x16x32_bf16 v[162:165], v[214:217], v[74:77], v[162:165]
    ds_read_b64_tr_b16 v[206:207], v5 offset:3072
    v_add_f32 v222, v222, v36
    v_mfma_f32_16x16x32_bf16 v[166:169], v[214:217], v[78:81], v[166:169]
    ds_read_b64_tr_b16 v[208:209], v5 offset:6144
    buffer_load_dwordx4 v10, s[16:19], s81 offen offset:2048  lds
    v_mfma_f32_16x16x32_bf16 v[170:173], v[186:189], v[74:77], v[170:173]
    ds_read_b64_tr_b16 v[210:211], v4 offset:4096
    v_mul_f32 v222, s84, v222
    v_mfma_f32_16x16x32_bf16 v[174:177], v[186:189], v[78:81], v[174:177]
    ds_read_b64_tr_b16 v[212:213], v4 offset:7168
    v_mov_b32 v223, v222
    v_mfma_f32_16x16x32_bf16 a[208:211], v[16:19], v[50:53], a[208:211]
    s_nop 0
    v_permlane16_swap_b32 v222, v223
    v_fma_f32 v36, -v222, v222, v223
    v_mfma_f32_16x16x32_bf16 a[216:219], v[50:53], v[50:53], a[216:219]
    buffer_load_dwordx4 v11, s[16:19], s81 offen offset:3072  lds
    v_mfma_f32_16x16x32_bf16 v[178:181], v[190:193], v[74:77], v[178:181]
    ds_read_b64_tr_b16 v[214:215], v5 offset:4096
    v_max_f32_e64 v36, 0, v36
    v_mfma_f32_16x16x32_bf16 v[182:185], v[190:193], v[78:81], v[182:185]
    ds_read_b64_tr_b16 v[216:217], v5 offset:7168
    v_add_f32 v36, 0x3727c5ac, v36
    v_mfma_f32_16x16x32_bf16 a[212:215], v[16:19], v[54:57], a[212:215]
    v_sub_f32 v223, 0, v222
    v_rsq_f32 v222, v36
    v_mfma_f32_16x16x32_bf16 a[220:223], v[54:57], v[54:57], a[220:223]
    s_mov_b64 exec, 1
    buffer_atomic_add_x2 v[234:235], v236, s[36:39], s73 offen sc1
    s_mov_b64 exec, -1
    s_waitcnt vmcnt(16)
    s_barrier
    s_waitcnt vmcnt(12)
    s_waitcnt lgkmcnt(6)
    v_mfma_f32_16x16x32_bf16 v[138:141], v[194:197], v[82:85], v[138:141]
    ds_read_b64_tr_b16 v[186:187], v4 offset:8192
    ds_read_b128 v[58:61], v28 offset:4096
    v_mfma_f32_16x16x32_bf16 v[142:145], v[194:197], v[86:89], v[142:145]
    ds_read_b64_tr_b16 v[188:189], v4 offset:11264
    ds_read_b128 v[62:65], v28 offset:6144
    v_mfma_f32_16x16x32_bf16 v[146:149], v[198:201], v[82:85], v[146:149]
    ds_read_b64_tr_b16 v[190:191], v5 offset:8192
    ds_read_b128 v[66:69], v29 offset:4096
    v_mfma_f32_16x16x32_bf16 v[150:153], v[198:201], v[86:89], v[150:153]
    ds_read_b64_tr_b16 v[192:193], v5 offset:11264
    ds_read_b128 v[70:73], v29 offset:6144
    v_mfma_f32_16x16x32_bf16 v[224:227], v[130:133], v[134:137], v[224:227]
    ds_read_b64_tr_b16 v[90:91], v102 offset:24576
    ds_read_b64_tr_b16 v[92:93], v102 offset:27648
    v_mfma_f32_16x16x32_bf16 v[154:157], v[202:205], v[82:85], v[154:157]
    ds_read_b64_tr_b16 v[194:195], v4 offset:9216
    ds_read_b64_tr_b16 v[106:107], v240 offset:12288
    v_mfma_f32_16x16x32_bf16 v[158:161], v[202:205], v[86:89], v[158:161]
L_pg1:
    s_cbranch_execz L_walked0
    ds_read_b64_tr_b16 v[196:197], v4 offset:12288
    ds_read_b64_tr_b16 v[108:109], v240 offset:15360
    s_waitcnt lgkmcnt(10)
    v_mfma_f32_16x16x32_bf16 a[208:211], v[16:19], v[58:61], a[208:211]
    ds_read_b128 v[110:113], v241 offset:6144
    v_mfma_f32_16x16x32_bf16 a[216:219], v[58:61], v[58:61], a[216:219]
    v_mfma_f32_16x16x32_bf16 v[162:165], v[206:209], v[82:85], v[162:165]
    ds_read_b64_tr_b16 v[198:199], v5 offset:9216
    v_mfma_f32_16x16x32_bf16 v[166:169], v[206:209], v[86:89], v[166:169]
    ds_read_b64_tr_b16 v[200:201], v5 offset:12288
    v_mfma_f32_16x16x32_bf16 a[212:215], v[16:19], v[62:65], a[212:215]
    v_mfma_f32_16x16x32_bf16 a[220:223], v[62:65], v[62:65], a[220:223]
    v_mfma_f32_16x16x32_bf16 v[170:173], v[210:213], v[82:85], v[170:173]
    ds_read_b64_tr_b16 v[202:203], v4 offset:10240
    v_mfma_f32_16x16x32_bf16 v[174:177], v[210:213], v[86:89], v[174:177]
    ds_read_b64_tr_b16 v[204:205], v4 offset:13312
    s_waitcnt lgkmcnt(11)
    v_mfma_f32_16x16x32_bf16 a[208:211], v[16:19], v[66:69], a[208:211]
    v_mfma_f32_16x16x32_bf16 a[216:219], v[66:69], v[66:69], a[216:219]
    v_mfma_f32_16x16x32_bf16 v[178:181], v[214:217], v[82:85], v[178:181]
    ds_read_b64_tr_b16 v[206:207], v5 offset:10240
    v_mfma_f32_16x16x32_bf16 v[182:185], v[214:217], v[86:89], v[182:185]
    ds_read_b64_tr_b16 v[208:209], v5 offset:13312
    v_mfma_f32_16x16x32_bf16 a[212:215], v[16:19], v[70:73], a[212:215]
    v_mfma_f32_16x16x32_bf16 a[220:223], v[70:73], v[70:73], a[220:223]
    s_waitcnt lgkmcnt(8)
    v_mfma_f32_16x16x32_bf16 v[138:141], v[186:189], v[42:45], v[138:141]
    ds_read_b64_tr_b16 v[210:211], v4 offset:14336
    s_add_u32 m0, s61, 4096
    s_add_u32 s81, s96, 65536
    buffer_load_dwordx4 v8, s[16:19], s81 offen offset:0  lds
    v_mfma_f32_16x16x32_bf16 v[142:145], v[186:189], v[46:49], v[142:145]
    ds_read_b64_tr_b16 v[212:213], v4 offset:17408
    ds_read_b64_tr_b16 v[114:115], v240 offset:18432
    v_mfma_f32_16x16x32_bf16 v[146:149], v[190:193], v[42:45], v[146:149]
    ds_read_b64_tr_b16 v[214:215], v5 offset:14336
    ds_read_b64_tr_b16 v[116:117], v240 offset:21504
    v_mfma_f32_16x16x32_bf16 v[150:153], v[190:193], v[46:49], v[150:153]
    ds_read_b64_tr_b16 v[216:217], v5 offset:17408
    ds_read_b128 v[118:121], v238 offset:6144
    s_waitcnt lgkmcnt(13)
    v_mfma_f32_16x16x32_bf16 v[224:227], v[106:109], v[110:113], v[224:227]
    buffer_load_dwordx4 v9, s[16:19], s81 offen offset:1024  lds
    v_mfma_f32_16x16x32_bf16 v[154:157], v[194:197], v[42:45], v[154:157]
    ds_read_b64_tr_b16 v[186:187], v4 offset:15360
    v_accvgpr_read_b32 v74, a208
    v_mfma_f32_16x16x32_bf16 v[158:161], v[194:197], v[46:49], v[158:161]
    ds_read_b64_tr_b16 v[188:189], v4 offset:18432
    v_accvgpr_read_b32 v75, a216
    v_mfma_f32_16x16x32_bf16 a[224:227], v[90:93], v[16:19], a[224:227]
    v_accvgpr_read_b32 v76, a217
    v_accvgpr_read_b32 v77, a218
    s_waitcnt lgkmcnt(9)
    v_mfma_f32_16x16x32_bf16 v[162:165], v[198:201], v[42:45], v[162:165]
    ds_read_b64_tr_b16 v[190:191], v5 offset:15360
    buffer_load_dwordx4 v10, s[16:19], s81 offen offset:2048  lds
    v_mfma_f32_16x16x32_bf16 v[166:169], v[198:201], v[46:49], v[166:169]
    ds_read_b64_tr_b16 v[192:193], v5 offset:18432
    v_accvgpr_read_b32 v78, a219
    v_mfma_f32_16x16x32_bf16 v[170:173], v[202:205], v[42:45], v[170:173]
    ds_read_b64_tr_b16 v[194:195], v4 offset:16384
    v_accvgpr_read_b32 v79, a212
    v_mfma_f32_16x16x32_bf16 v[174:177], v[202:205], v[46:49], v[174:177]
    ds_read_b64_tr_b16 v[196:197], v4 offset:19456
    v_accvgpr_read_b32 v80, a220
    v_mfma_f32_16x16x32_bf16 v[178:181], v[206:209], v[42:45], v[178:181]
    ds_read_b64_tr_b16 v[198:199], v5 offset:16384
    buffer_load_dwordx4 v11, s[16:19], s81 offen offset:3072  lds
    v_mfma_f32_16x16x32_bf16 v[182:185], v[206:209], v[46:49], v[182:185]
    ds_read_b64_tr_b16 v[200:201], v5 offset:19456
    v_accvgpr_read_b32 v81, a221
    s_waitcnt vmcnt(13)
    s_barrier
    s_waitcnt lgkmcnt(6)
    v_mfma_f32_16x16x32_bf16 v[138:141], v[210:213], v[50:53], v[138:141]
    ds_read_b64_tr_b16 v[202:203], v4 offset:20480
    ds_read_b64_tr_b16 v[90:91], v102 offset:36864
    v_mfma_f32_16x16x32_bf16 v[142:145], v[210:213], v[54:57], v[142:145]
    ds_read_b64_tr_b16 v[204:205], v4 offset:23552
    ds_read_b64_tr_b16 v[92:93], v102 offset:39936
    v_mfma_f32_16x16x32_bf16 v[146:149], v[214:217], v[50:53], v[146:149]
    ds_read_b64_tr_b16 v[206:207], v5 offset:20480
    s_mov_b64 exec, 0x7ff
    buffer_load_dword a239, v41, s[20:23], s71 offen
    buffer_load_dword a239, v41, s[28:31], s71 offen offset:1024
    buffer_load_dword a239, v239, s[28:31], s76 offen offset:1408
    s_mov_b64 exec, -1
    v_mfma_f32_16x16x32_bf16 v[150:153], v[214:217], v[54:57], v[150:153]
    ds_read_b64_tr_b16 v[208:209], v5 offset:23552
    ds_read_b64_tr_b16 v[122:123], v240 offset:24576
    v_mfma_f32_16x16x32_bf16 v[224:227], v[114:117], v[118:121], v[224:227]
    ds_read_b64_tr_b16 v[124:125], v240 offset:27648
    ds_read_b128 v[126:129], v241 offset:7168
    v_mfma_f32_16x16x32_bf16 v[154:157], v[186:189], v[50:53], v[154:157]
    ds_read_b64_tr_b16 v[210:211], v4 offset:21504
    ds_read_b64_tr_b16 v[130:131], v240 offset:30720
    v_mfma_f32_16x16x32_bf16 v[158:161], v[186:189], v[54:57], v[158:161]
    ds_read_b64_tr_b16 v[212:213], v4 offset:24576
    ds_read_b64_tr_b16 v[132:133], v240 offset:33792
    s_waitcnt lgkmcnt(13)
    v_mfma_f32_16x16x32_bf16 v[162:165], v[190:193], v[50:53], v[162:165]
    ds_read_b64_tr_b16 v[214:215], v5 offset:21504
    ds_read_b128 v[134:137], v238 offset:7168
    v_mfma_f32_16x16x32_bf16 v[166:169], v[190:193], v[54:57], v[166:169]
    ds_read_b64_tr_b16 v[216:217], v5 offset:24576
    v_accvgpr_read_b32 v82, a222
    s_waitcnt lgkmcnt(12)
    v_mfma_f32_16x16x32_bf16 a[224:227], v[90:93], v[16:19], a[224:227]
    v_accvgpr_read_b32 v83, a223
    v_cndmask_b32 v219, v75, v76, s[88:89]
    v_mfma_f32_16x16x32_bf16 v[170:173], v[194:197], v[50:53], v[170:173]
    ds_read_b64_tr_b16 v[186:187], v4 offset:22528
    v_cndmask_b32 v221, v80, v81, s[88:89]
    v_mfma_f32_16x16x32_bf16 v[174:177], v[194:197], v[54:57], v[174:177]
    ds_read_b64_tr_b16 v[188:189], v4 offset:25600
    v_cndmask_b32 v219, v219, v77, s[90:91]
    v_mfma_f32_16x16x32_bf16 v[178:181], v[198:201], v[50:53], v[178:181]
    ds_read_b64_tr_b16 v[190:191], v5 offset:22528
    v_cndmask_b32 v221, v221, v82, s[90:91]
    v_mfma_f32_16x16x32_bf16 v[182:185], v[198:201], v[54:57], v[182:185]
    ds_read_b64_tr_b16 v[192:193], v5 offset:25600
    v_cndmask_b32 v219, v219, v78, s[92:93]
    s_waitcnt lgkmcnt(11)
    v_mfma_f32_16x16x32_bf16 v[224:227], v[122:125], v[126:129], v[224:227]
    v_cndmask_b32 v221, v221, v83, s[92:93]
    v_cndmask_b32 v218, 0, v74, s[94:95]
    s_waitcnt lgkmcnt(5)
    v_mfma_f32_16x16x32_bf16 v[224:227], v[130:133], v[134:137], v[224:227]
    v_cndmask_b32 v220, 0, v79, s[94:95]
    v_cndmask_b32 v219, 0, v219, s[94:95]
    v_mfma_f32_16x16x32_bf16 v[138:141], v[202:205], v[58:61], v[138:141]
    ds_read_b64_tr_b16 v[194:195], v4 offset:26624
    s_mov_b64 exec, 0x1ffff
    buffer_load_dword a239, v41, s[40:43], s77 offen sc1
    buffer_load_dword a239, v41, s[40:43], s78 offen sc1
    s_mov_b64 exec, -1
    v_mfma_f32_16x16x32_bf16 v[142:145], v[202:205], v[62:65], v[142:145]
    ds_read_b64_tr_b16 v[196:197], v4 offset:29696
    v_cndmask_b32 v221, 0, v221, s[94:95]
    v_mfma_f32_16x16x32_bf16 v[146:149], v[206:209], v[58:61], v[146:149]
    ds_read_b64_tr_b16 v[198:199], v5 offset:26624
    v_permlane16_swap_b32 v218, v219
    v_mfma_f32_16x16x32_bf16 v[150:153], v[206:209], v[62:65], v[150:153]
    ds_read_b64_tr_b16 v[200:201], v5 offset:29696
    v_permlane16_swap_b32 v220, v221
    s_mov_b32 exec_lo, 0x10001
    s_mov_b32 exec_hi, 0x10001
    ds_write_b128 v103, v[224:227] offset:1152
    ds_write_b128 v103, a[224:227]
    s_mov_b64 exec, -1
    v_mfma_f32_16x16x32_bf16 v[154:157], v[210:213], v[58:61], v[154:157]
    ds_read_b64_tr_b16 v[202:203], v4 offset:27648
    v_add_f32 v218, v218, v219
    v_mfma_f32_16x16x32_bf16 v[158:161], v[210:213], v[62:65], v[158:161]
    ds_read_b64_tr_b16 v[204:205], v4 offset:30720
    v_add_f32 v220, v220, v221
    s_waitcnt lgkmcnt(8)
    v_mfma_f32_16x16x32_bf16 v[162:165], v[214:217], v[58:61], v[162:165]
    ds_read_b64_tr_b16 v[206:207], v5 offset:27648
    v_permlane32_swap_b32 v218, v220
    v_mfma_f32_16x16x32_bf16 v[166:169], v[214:217], v[62:65], v[166:169]
    ds_read_b64_tr_b16 v[208:209], v5 offset:30720
    v_add_f32_e64 v218, v218, v220
    v_mfma_f32_16x16x32_bf16 v[170:173], v[186:189], v[58:61], v[170:173]
    ds_read_b64_tr_b16 v[210:211], v4 offset:28672
    v_mul_f32_e64 v219, -s84, v218
    v_mfma_f32_16x16x32_bf16 v[174:177], v[186:189], v[62:65], v[174:177]
    ds_read_b64_tr_b16 v[212:213], v4 offset:31744
    v_mul_f32_e64 v74, -s84, v218
    s_waitcnt lgkmcnt(6)
    s_barrier
    v_mfma_f32_16x16x32_bf16 v[178:181], v[190:193], v[58:61], v[178:181]
    ds_read_b64_tr_b16 v[214:215], v5 offset:28672
    v_add_u32 v40, 159744, v32
    v_mfma_f32_16x16x32_bf16 v[182:185], v[190:193], v[62:65], v[182:185]
    ds_read_b64_tr_b16 v[216:217], v5 offset:31744
    ds_read_b128 v[114:117], v40 offset:0
    s_waitcnt lgkmcnt(7)
    v_mfma_f32_16x16x32_bf16 v[138:141], v[194:197], v[66:69], v[138:141]
    ds_read_b128 v[118:121], v40 offset:64
    ds_read_b128 v[90:93], v40 offset:128
    v_mfma_f32_16x16x32_bf16 v[142:145], v[194:197], v[70:73], v[142:145]
    ds_read_b128 v[94:97], v40 offset:192
    ds_read_b128 v[122:125], v40 offset:1152
    v_mfma_f32_16x16x32_bf16 v[146:149], v[198:201], v[66:69], v[146:149]
    ds_read_b128 v[126:129], v40 offset:1216
    ds_read_b128 v[130:133], v40 offset:1280
    v_mfma_f32_16x16x32_bf16 v[150:153], v[198:201], v[70:73], v[150:153]
    ds_read_b128 v[134:137], v40 offset:1344
    ds_read_b128 v[228:231], v103 offset:1152
    v_mfma_f32_16x16x32_bf16 v[154:157], v[202:205], v[66:69], v[154:157]
    v_permlane16_swap_b32 v219, v74
    v_fma_f32 v74, -v219, v219, -v74
    v_mfma_f32_16x16x32_bf16 v[158:161], v[202:205], v[70:73], v[158:161]
    v_max_f32 v74, 0, v74
    v_add_f32 v74, 0x3727c5ac, v74
    s_waitcnt lgkmcnt(9)
    v_mfma_f32_16x16x32_bf16 v[162:165], v[206:209], v[66:69], v[162:165]
    s_waitcnt lgkmcnt(5)
    v_add_f32 v114, v114, v90
    v_mfma_f32_16x16x32_bf16 v[166:169], v[206:209], v[70:73], v[166:169]
    v_add_f32 v115, v115, v91
    v_add_f32 v116, v116, v92
    v_mfma_f32_16x16x32_bf16 v[170:173], v[210:213], v[66:69], v[170:173]
    v_add_f32 v117, v117, v93
    v_add_f32 v118, v118, v94
    v_mfma_f32_16x16x32_bf16 v[174:177], v[210:213], v[70:73], v[174:177]
    v_add_f32 v119, v119, v95
    v_add_f32 v120, v120, v96
    v_mfma_f32_16x16x32_bf16 v[178:181], v[214:217], v[66:69], v[178:181]
    v_add_f32_e64 v121, v121, v97
    s_mov_b32 exec_lo, 0x10001
    s_mov_b32 exec_hi, 0x10001
    ds_write_b128 v40, v[114:117] offset:1024
    ds_write_b128 v40, v[118:121] offset:1088
    s_mov_b64 exec, -1
    v_mfma_f32_16x16x32_bf16 v[182:185], v[214:217], v[70:73], v[182:185]
    v_mov_b32 v221, v219
    v_rsq_f32 v218, v74
    s_nop 0
    v_permlane32_swap_b32 v219, v221
    v_mov_b32 v220, v218
    s_nop 1
    v_permlane32_swap_b32 v218, v220
    s_mov_b32 s51, s49
    v_mov_b32 v240, v41
    s_waitcnt lgkmcnt(2)
    v_pk_fma_f32 v[138:139], v[114:115], v[218:219], v[138:139] op_sel:[0,1,0] op_sel_hi:[1,1,1]
    v_pk_fma_f32 v[140:141], v[116:117], v[218:219], v[140:141] op_sel:[0,1,0] op_sel_hi:[1,1,1]
    v_pk_fma_f32 v[142:143], v[114:115], v[220:221], v[142:143] op_sel:[0,1,0] op_sel_hi:[1,1,1]
    v_pk_fma_f32 v[144:145], v[116:117], v[220:221], v[144:145] op_sel:[0,1,0] op_sel_hi:[1,1,1]
    v_pk_fma_f32 v[146:147], v[118:119], v[218:219], v[146:147] op_sel:[0,1,0] op_sel_hi:[1,1,1]
    v_pk_fma_f32 v[148:149], v[120:121], v[218:219], v[148:149] op_sel:[0,1,0] op_sel_hi:[1,1,1]
    v_pk_fma_f32 v[150:151], v[118:119], v[220:221], v[150:151] op_sel:[0,1,0] op_sel_hi:[1,1,1]
    v_pk_fma_f32 v[152:153], v[120:121], v[220:221], v[152:153] op_sel:[0,1,0] op_sel_hi:[1,1,1]
    v_pk_fma_f32 v[154:155], v[122:123], v[218:219], v[154:155] op_sel:[0,1,0] op_sel_hi:[1,1,1]
    v_pk_fma_f32 v[156:157], v[124:125], v[218:219], v[156:157] op_sel:[0,1,0] op_sel_hi:[1,1,1]
    v_pk_fma_f32 v[158:159], v[122:123], v[220:221], v[158:159] op_sel:[0,1,0] op_sel_hi:[1,1,1]
    v_pk_fma_f32 v[160:161], v[124:125], v[220:221], v[160:161] op_sel:[0,1,0] op_sel_hi:[1,1,1]
    v_pk_fma_f32 v[162:163], v[126:127], v[218:219], v[162:163] op_sel:[0,1,0] op_sel_hi:[1,1,1]
    v_pk_fma_f32 v[164:165], v[128:129], v[218:219], v[164:165] op_sel:[0,1,0] op_sel_hi:[1,1,1]
    v_pk_fma_f32 v[166:167], v[126:127], v[220:221], v[166:167] op_sel:[0,1,0] op_sel_hi:[1,1,1]
    v_pk_fma_f32 v[168:169], v[128:129], v[220:221], v[168:169] op_sel:[0,1,0] op_sel_hi:[1,1,1]
    v_pk_fma_f32 v[170:171], v[130:131], v[218:219], v[170:171] op_sel:[0,1,0] op_sel_hi:[1,1,1]
    v_pk_fma_f32 v[172:173], v[132:133], v[218:219], v[172:173] op_sel:[0,1,0] op_sel_hi:[1,1,1]
    v_pk_fma_f32 v[174:175], v[130:131], v[220:221], v[174:175] op_sel:[0,1,0] op_sel_hi:[1,1,1]
    v_pk_fma_f32 v[176:177], v[132:133], v[220:221], v[176:177] op_sel:[0,1,0] op_sel_hi:[1,1,1]
    v_pk_fma_f32 v[178:179], v[134:135], v[218:219], v[178:179] op_sel:[0,1,0] op_sel_hi:[1,1,1]
    v_pk_fma_f32 v[180:181], v[136:137], v[218:219], v[180:181] op_sel:[0,1,0] op_sel_hi:[1,1,1]
    v_pk_fma_f32 v[182:183], v[134:135], v[220:221], v[182:183] op_sel:[0,1,0] op_sel_hi:[1,1,1]
    v_pk_fma_f32 v[184:185], v[136:137], v[220:221], v[184:185] op_sel:[0,1,0] op_sel_hi:[1,1,1]
    v_cvt_pk_bf16_f32 v54, v138, v139
    v_cvt_pk_bf16_f32 v55, v140, v141
    v_cvt_pk_bf16_f32 v56, v142, v143
    v_cvt_pk_bf16_f32 v57, v144, v145
    v_cvt_pk_bf16_f32 v58, v146, v147
    v_cvt_pk_bf16_f32 v59, v148, v149
    v_cvt_pk_bf16_f32 v60, v150, v151
    v_cvt_pk_bf16_f32 v61, v152, v153
    v_pk_mul_f32 v[154:155], v[154:155], v[218:219] op_sel_hi:[1,0]
    v_pk_mul_f32 v[156:157], v[156:157], v[218:219] op_sel_hi:[1,0]
    v_cvt_pk_bf16_f32 v44, v154, v155
    v_cvt_pk_bf16_f32 v45, v156, v157
    v_pk_mul_f32 v[158:159], v[158:159], v[220:221] op_sel_hi:[1,0]
    v_pk_mul_f32 v[160:161], v[160:161], v[220:221] op_sel_hi:[1,0]
    v_cvt_pk_bf16_f32 v46, v158, v159
    v_cvt_pk_bf16_f32 v47, v160, v161
    ds_write_b64 v105, v[46:47] offset:0
    v_pk_mul_f32 v[162:163], v[162:163], v[218:219] op_sel_hi:[1,0]
    v_pk_mul_f32 v[164:165], v[164:165], v[218:219] op_sel_hi:[1,0]
    v_cvt_pk_bf16_f32 v50, v162, v163
    v_cvt_pk_bf16_f32 v51, v164, v165
    v_pk_mul_f32 v[166:167], v[166:167], v[220:221] op_sel_hi:[1,0]
    v_pk_mul_f32 v[168:169], v[168:169], v[220:221] op_sel_hi:[1,0]
    v_cvt_pk_bf16_f32 v52, v166, v167
    v_cvt_pk_bf16_f32 v53, v168, v169
    ds_write_b64 v105, v[52:53] offset:512
    v_pk_mul_f32 v[170:171], v[170:171], v[218:219] op_sel_hi:[1,0]
    v_pk_mul_f32 v[172:173], v[172:173], v[218:219] op_sel_hi:[1,0]
    v_pk_mul_f32 v[174:175], v[174:175], v[220:221] op_sel_hi:[1,0]
    v_pk_mul_f32 v[176:177], v[176:177], v[220:221] op_sel_hi:[1,0]
    v_pk_mul_f32 v[178:179], v[178:179], v[218:219] op_sel_hi:[1,0]
    v_pk_mul_f32 v[180:181], v[180:181], v[218:219] op_sel_hi:[1,0]
    v_pk_mul_f32 v[182:183], v[182:183], v[220:221] op_sel_hi:[1,0]
    v_pk_mul_f32 v[184:185], v[184:185], v[220:221] op_sel_hi:[1,0]
    v_mfma_f32_16x16x16_bf16 v[138:141], v[46:47], v[56:57], v[242:245]
    v_cvt_pk_bf16_f32 v170, v170, v171
    v_cvt_pk_bf16_f32 v171, v172, v173
    v_mfma_f32_16x16x16_bf16 v[142:145], v[44:45], v[56:57], v[246:249]
    ds_write_b64 v105, v[170:171] offset:2048
    v_cvt_pk_bf16_f32 v174, v174, v175
    v_mfma_f32_16x16x16_bf16 v[146:149], v[52:53], v[60:61], v[242:245]
    v_cvt_pk_bf16_f32 v175, v176, v177
    ds_write_b64 v105, v[174:175] offset:1024
    v_mfma_f32_16x16x16_bf16 v[150:153], v[50:51], v[60:61], v[246:249]
    v_cvt_pk_bf16_f32 v178, v178, v179
    v_cvt_pk_bf16_f32 v179, v180, v181
    v_mfma_f32_16x16x16_bf16 v[154:157], v[44:45], v[54:55], v[242:245]
    ds_write_b64 v105, v[178:179] offset:2560
    v_cvt_pk_bf16_f32 v182, v182, v183
    v_mfma_f32_16x16x16_bf16 v[162:165], v[50:51], v[58:59], v[242:245]
    v_cvt_pk_bf16_f32 v183, v184, v185
    ds_write_b64 v105, v[182:183] offset:1536
    ds_read_b64_tr_b16 v[66:67], v38 offset:1024
    ds_read_b64_tr_b16 v[64:65], v38 offset:2048
    ds_read_b64_tr_b16 v[72:73], v38 offset:1536
    ds_read_b64_tr_b16 v[70:71], v38 offset:2560
    v_mul_f32 v40, 0x3eb8aa3b, v218
    v_mul_f32 v41, 0x3eb8aa3b, v220
    s_sub_u32 s72, s45, s62
    s_lshl_b32 s72, s72, 4
    v_mov_b32 v37, 0
    buffer_load_dwordx2 v[82:83], v37, s[36:39], s73 offen sc1
    buffer_load_dwordx2 v[84:85], v37, s[36:39], s72 offen sc1
    v_fmac_f32 v224, v228, v223
    v_fmac_f32 v225, v229, v223
    v_fmac_f32 v226, v230, v223
    v_fmac_f32 v227, v231, v223
    v_mul_f32 v224, v224, v222
    v_mul_f32 v225, v225, v222
    v_mul_f32 v226, v226, v222
    s_waitcnt vmcnt(16)
    ds_read_b64_tr_b16 a[0:1], v6 offset:8192
    ds_read_b64_tr_b16 a[4:5], v7 offset:8192
    ds_read_b64_tr_b16 a[8:9], v6 offset:8704
    ds_read_b64_tr_b16 a[12:13], v7 offset:8704
    ds_read_b64_tr_b16 a[2:3], v6 offset:10240
    ds_read_b64_tr_b16 a[6:7], v7 offset:10240
    ds_read_b64_tr_b16 a[10:11], v6 offset:10752
    ds_read_b64_tr_b16 a[14:15], v7 offset:10752
    v_mul_f32_e64 v227, v227, v222
    v_cvt_pk_bf16_f32 v224, v224, v225
    v_cvt_pk_bf16_f32 v225, v226, v227
    ds_write_b64 v237, v[224:225]
    v_max_f32 v138, v138, v142
    v_max_f32 v139, v139, v143
    v_max_f32 v140, v140, v144
    v_max_f32 v141, v141, v145
    s_waitcnt lgkmcnt(0)
    s_add_u32 m0, s61, 8192
    s_add_u32 s81, s96, 98304
    buffer_load_dwordx4 v8, s[16:19], s81 offen offset:0  lds
    v_max_f32 v146, v146, v150
    v_max_f32 v147, v147, v151
    v_max_f32 v148, v148, v152
    v_max_f32 v149, v149, v153
    v_max3_f32 v142, v138, v139, v140
    v_max3_f32 v143, v146, v147, v148
    v_max_f32 v142, v142, v141
    buffer_load_dwordx4 v9, s[16:19], s81 offen offset:1024  lds
    v_max_f32 v143, v143, v149
    s_mul_i32 s67, s44, 90112
    s_lshl_b32 s68, s46, 10
    v_permlane16_swap_b32 v142, v143
    v_max_f32 v150, v142, v143
    v_max_f32 v142, v142, v143
    s_add_u32 s67, s67, s68
    s_add_u32 s67, s67, s51
    v_permlane32_swap_b32 v142, v150
    v_max_f32 v142, v142, v150
    v_mul_f32 v143, v142, v41
    v_mul_f32_e64 v142, v142, v41
    s_add_u32 s67, s67, 163840
    s_add_u32 s68, s67, 45056
    v_permlane16_swap_b32 v142, v143
    v_pk_fma_f32 v[138:139], v[138:139], v[40:41], v[142:143] op_sel:[0,1,0] op_sel_hi:[1,1,0] neg_lo:[0,0,1] neg_hi:[0,0,1]
    buffer_load_dwordx4 v10, s[16:19], s81 offen offset:2048  lds
    v_pk_fma_f32 v[140:141], v[140:141], v[40:41], v[142:143] op_sel:[0,1,0] op_sel_hi:[1,1,0] neg_lo:[0,0,1] neg_hi:[0,0,1]
    v_pk_fma_f32 v[146:147], v[146:147], v[40:41], v[142:143] op_sel:[0,1,1] op_sel_hi:[1,1,1] neg_lo:[0,0,1] neg_hi:[0,0,1]
    v_pk_fma_f32 v[148:149], v[148:149], v[40:41], v[142:143] op_sel:[0,1,1] op_sel_hi:[1,1,1] neg_lo:[0,0,1] neg_hi:[0,0,1]
    s_barrier
    ds_read_b64 v[42:43], v233 offset:0
    ds_read_b64 v[48:49], v233 offset:512
    ds_read_b64_tr_b16 v[62:63], v39 offset:1024
    ds_read_b64_tr_b16 v[68:69], v39 offset:1536
    v_exp_f32 v138, v138
    v_exp_f32 v139, v139
    v_exp_f32 v140, v140
    v_exp_f32 v141, v141
    buffer_load_dwordx4 v11, s[16:19], s81 offen offset:3072  lds
    v_exp_f32 v146, v146
    v_exp_f32 v147, v147
    v_exp_f32 v148, v148
    v_exp_f32 v149, v149
    v_cvt_pk_bf16_f32 v138, v138, v139
    v_cvt_pk_bf16_f32 v139, v140, v141
    v_and_b32 v142, v254, v138
    s_waitcnt vmcnt(16)
    ds_read_b64_tr_b16 a[16:17], v6 offset:0
    ds_read_b64_tr_b16 a[20:21], v7 offset:0
    ds_read_b64_tr_b16 a[24:25], v6 offset:512
    ds_read_b64_tr_b16 a[28:29], v7 offset:512
    ds_read_b64_tr_b16 a[18:19], v6 offset:2048
    ds_read_b64_tr_b16 a[22:23], v7 offset:2048
    ds_read_b64_tr_b16 a[26:27], v6 offset:2560
    ds_read_b64_tr_b16 a[30:31], v7 offset:2560
    v_bfi_b32 v144, v254, 0, v138
    v_and_b32_e64 v143, v255, v139
    v_bfi_b32 v145, v255, 0, v139
    v_cvt_pk_bf16_f32 v146, v146, v147
    v_cvt_pk_bf16_f32 v147, v148, v149
    v_and_b32 v150, v254, v146
    v_bfi_b32 v152, v254, 0, v146
    s_waitcnt lgkmcnt(0)
    s_add_u32 m0, s61, 0
    s_add_u32 s81, s97, 65536
    buffer_load_dwordx4 v8, s[28:31], s81 offen offset:0  lds
    v_and_b32 v151, v255, v147
    v_bfi_b32 v153, v255, 0, v147
    v_mfma_f32_16x16x16_bf16 v[158:161], v[42:43], v[54:55], v[250:253]
    v_mfma_f32_16x16x16_bf16 v[166:169], v[48:49], v[58:59], v[250:253]
    v_mfma_f32_16x16x32_bf16 v[174:177], v[16:19], v[142:145], 0
    v_mfma_f32_16x16x32_bf16 v[182:185], v[16:19], v[150:153], 0
    v_mfma_f32_16x16x32_bf16 v[170:173], v[64:67], v[142:145], 0
    v_mfma_f32_16x16x32_bf16 v[178:181], v[70:73], v[150:153], 0
    s_nop 2
    v_max_f32 v154, v154, v158
    v_max_f32 v155, v155, v159
    v_max_f32 v156, v156, v160
    v_max_f32 v157, v157, v161
    v_max_f32 v162, v162, v166
    buffer_load_dwordx4 v9, s[28:31], s81 offen offset:1024  lds
    v_max_f32 v163, v163, v167
    v_max_f32 v164, v164, v168
    v_max_f32_e64 v165, v165, v169
    v_max3_f32 v158, v154, v155, v156
    v_max3_f32 v159, v162, v163, v164
    v_max_f32 v158, v158, v157
    v_max_f32 v159, v159, v165
    buffer_load_dwordx4 v10, s[28:31], s81 offen offset:2048  lds
    v_rcp_f32 v174, v174
    v_rcp_f32 v182, v182
    v_permlane16_swap_b32 v158, v159
    v_max_f32 v166, v158, v159
    v_max_f32 v158, v158, v159
    v_pk_mul_f32 v[170:171], v[170:171], v[174:175] op_sel_hi:[1,0]
    v_pk_mul_f32 v[172:173], v[172:173], v[174:175] op_sel_hi:[1,0]
    v_permlane32_swap_b32 v158, v166
    v_max_f32 v158, v158, v166
    buffer_load_dwordx4 v11, s[28:31], s81 offen offset:3072  lds
    v_mul_f32 v159, v158, v40
    v_mul_f32_e64 v158, v158, v40
    v_pk_mul_f32 v[178:179], v[178:179], v[182:183] op_sel_hi:[1,0]
    v_pk_mul_f32 v[180:181], v[180:181], v[182:183] op_sel_hi:[1,0]
    v_permlane16_swap_b32 v158, v159
    v_cvt_pk_bf16_f32 v78, v170, v171
    v_cvt_pk_bf16_f32 v79, v172, v173
    v_cvt_pk_bf16_f32 v80, v178, v179
    s_waitcnt vmcnt(15)
    ds_read_b64_tr_b16 a[32:33], v6 offset:4096
    ds_read_b64_tr_b16 a[36:37], v7 offset:4096
    ds_read_b64_tr_b16 a[40:41], v6 offset:4608
    ds_read_b64_tr_b16 a[44:45], v7 offset:4608
    ds_read_b64_tr_b16 a[34:35], v6 offset:6144
    ds_read_b64_tr_b16 a[38:39], v7 offset:6144
    ds_read_b64_tr_b16 a[42:43], v6 offset:6656
    ds_read_b64_tr_b16 a[46:47], v7 offset:6656
    v_cvt_pk_bf16_f32 v81, v180, v181
    v_pk_fma_f32 v[154:155], v[154:155], v[40:41], v[158:159] op_sel:[0,0,0] op_sel_hi:[1,0,0] neg_lo:[0,0,1] neg_hi:[0,0,1]
    v_pk_fma_f32 v[156:157], v[156:157], v[40:41], v[158:159] op_sel:[0,0,0] op_sel_hi:[1,0,0] neg_lo:[0,0,1] neg_hi:[0,0,1]
    v_pk_fma_f32 v[162:163], v[162:163], v[40:41], v[158:159] op_sel:[0,0,1] op_sel_hi:[1,0,1] neg_lo:[0,0,1] neg_hi:[0,0,1]
    v_pk_fma_f32 v[164:165], v[164:165], v[40:41], v[158:159] op_sel:[0,0,1] op_sel_hi:[1,0,1] neg_lo:[0,0,1] neg_hi:[0,0,1]
    v_exp_f32 v154, v154
    v_exp_f32 v155, v155
    s_waitcnt lgkmcnt(0)
    s_add_u32 m0, s61, 4096
    s_add_u32 s81, s97, 163840
    buffer_load_dwordx4 v8, s[28:31], s81 offen offset:0  lds
    v_exp_f32 v156, v156
    v_exp_f32 v157, v157
    v_exp_f32 v162, v162
    v_exp_f32 v163, v163
    v_exp_f32 v164, v164
    v_exp_f32_e64 v165, v165
    v_cvt_pk_bf16_f32 v154, v154, v155
    buffer_load_dwordx4 v9, s[28:31], s81 offen offset:1024  lds
    v_cvt_pk_bf16_f32 v155, v156, v157
    v_and_b32 v158, v254, v154
    v_bfi_b32 v160, v254, 0, v154
    v_and_b32 v159, v255, v155
    v_bfi_b32 v161, v255, 0, v155
    v_cvt_pk_bf16_f32 v162, v162, v163
    v_cvt_pk_bf16_f32 v163, v164, v165
    buffer_load_dwordx4 v10, s[28:31], s81 offen offset:2048  lds
    v_and_b32_e64 v166, v254, v162
    v_bfi_b32 v168, v254, 0, v162
    v_and_b32 v167, v255, v163
    v_bfi_b32 v169, v255, 0, v163
    v_mfma_f32_16x16x32_bf16 v[174:177], v[16:19], v[158:161], 0
    s_nop 0
    v_mfma_f32_16x16x32_bf16 v[182:185], v[16:19], v[166:169], 0
    v_mfma_f32_16x16x32_bf16 v[170:173], v[62:65], v[158:161], 0
    v_mfma_f32_16x16x32_bf16 v[178:181], v[68:71], v[166:169], 0
    s_mov_b32 s85, 0
    s_waitcnt vmcnt(11)
L_cenc_6:
    v_readfirstlane_b32 s69, v82
    v_readfirstlane_b32 s70, v83
    v_readfirstlane_b32 s71, v85
    s_nop 0
    s_and_b32 s70, s70, s71
    s_lshl_b32 s70, s70, 4
    s_and_b32 s70, s70, s69
    s_cbranch_scc1 L_cend_7
    v_mov_b32 v40, 0
    buffer_load_dwordx2 v[82:83], v40, s[36:39], s73 offen sc1
    buffer_load_dwordx2 v[84:85], v40, s[36:39], s72 offen sc1
    s_waitcnt vmcnt(0)
    s_add_u32 s85, s85, 1
    s_cmp_lt_u32 s85, 131072
    s_cbranch_scc1 L_cenc_6
L_cend_7:
    s_lshl_b32 s70, s60, 4
    s_cmp_lg_u32 s69, s70
    s_cselect_b32 s53, 1, 0
    s_lshl_b32 s52, s53, 23
    s_cmp_lg_u32 s53, 0
    s_cbranch_scc1 L_slow_8
    buffer_store_dwordx4 v[78:81], v1, s[40:43], s68 offen
L_st_9:
    v_rcp_f32 v174, v174
    v_rcp_f32 v182, v182
    v_pk_mul_f32 v[170:171], v[170:171], v[174:175] op_sel_hi:[1,0]
    v_pk_mul_f32 v[172:173], v[172:173], v[174:175] op_sel_hi:[1,0]
    v_pk_mul_f32 v[178:179], v[178:179], v[182:183] op_sel_hi:[1,0]
    v_pk_mul_f32 v[180:181], v[180:181], v[182:183] op_sel_hi:[1,0]
    v_cvt_pk_bf16_f32 v74, v170, v171
    v_cvt_pk_bf16_f32 v75, v172, v173
    v_cvt_pk_bf16_f32 v76, v178, v179
    v_cvt_pk_bf16_f32 v77, v180, v181
    s_cmp_lg_u32 s53, 0
    s_cbranch_scc1 L_slow_10
    buffer_store_dwordx4 v[74:77], v1, s[40:43], s67 offen
L_st_11:
    buffer_load_dwordx4 v11, s[28:31], s81 offen offset:3072  lds
    v_min_u32 v28, 1, v0
    v_lshlrev_b32 v28, 30, v28
    s_cmp_eq_u32 s44, 3
    s_cselect_b32 s64, 0x40000000, 0
    v_add_u32 v29, s64, v1
    s_add_u32 s64, s44, 1
    s_and_b32 s64, s64, 3
    s_mul_i32 s12, s64, 12288
    s_add_u32 s12, s12, 98304
    s_lshl_b32 s65, s47, 2
    s_add_u32 s64, s64, s65
    s_mul_i32 s8, s64, 45056
    s_add_u32 s8, s8, 163840
    s_add_u32 s64, s44, 2
    s_and_b32 s64, s64, 3
    s_mul_i32 s13, s64, 12288
    s_add_u32 s13, s13, 102400
    s_lshl_b32 s65, s47, 2
    s_add_u32 s64, s64, s65
    s_mul_i32 s9, s64, 45056
    s_add_u32 s9, s9, 163840
    s_add_u32 s64, s44, 3
    s_and_b32 s64, s64, 3
    s_mul_i32 s14, s64, 12288
    s_add_u32 s14, s14, 106496
    s_lshl_b32 s65, s47, 2
    s_add_u32 s64, s64, s65
    s_mul_i32 s10, s64, 45056
    s_add_u32 s10, s10, 163840
    s_add_u32 s64, s44, 4
    s_and_b32 s64, s64, 3
    s_lshl_b32 s65, s47, 2
    s_add_u32 s64, s64, s65
    s_mul_i32 s11, s64, 45056
    s_add_u32 s11, s11, 163840
    s_mul_i32 s64, s44, 4096
    s_add_u32 s64, s64, s51
    s_waitcnt vmcnt(10)
    ds_read_b64_tr_b16 a[48:49], v6 offset:8192
    ds_read_b64_tr_b16 a[52:53], v7 offset:8192
    ds_read_b64_tr_b16 a[56:57], v6 offset:8704
    ds_read_b64_tr_b16 a[60:61], v7 offset:8704
    ds_read_b64_tr_b16 a[50:51], v6 offset:10240
    ds_read_b64_tr_b16 a[54:55], v7 offset:10240
    ds_read_b64_tr_b16 a[58:59], v6 offset:10752
    ds_read_b64_tr_b16 a[62:63], v7 offset:10752
    s_waitcnt vmcnt(6)
    ds_read_b64_tr_b16 a[96:97], v6 offset:0
    ds_read_b64_tr_b16 a[100:101], v7 offset:0
    ds_read_b64_tr_b16 a[104:105], v6 offset:512
    ds_read_b64_tr_b16 a[108:109], v7 offset:512
    ds_read_b64_tr_b16 a[98:99], v6 offset:2048
    ds_read_b64_tr_b16 a[102:103], v7 offset:2048
    ds_read_b64_tr_b16 a[106:107], v6 offset:2560
    ds_read_b64_tr_b16 a[110:111], v7 offset:2560
    s_waitcnt lgkmcnt(0)
    s_add_u32 m0, s61, 8192
    s_add_u32 s81, s97, 262144
    buffer_load_dwordx4 v8, s[28:31], s81 offen offset:0  lds
    buffer_load_dwordx4 v9, s[28:31], s81 offen offset:1024  lds
    buffer_load_dwordx4 v10, s[28:31], s81 offen offset:2048  lds
    buffer_load_dwordx4 v11, s[28:31], s81 offen offset:3072  lds
    s_add_u32 m0, s61, 0
    s_add_u32 s81, s97, 327680
    s_min_u32 s81, s81, 1376256
    buffer_load_dwordx4 v8, s[28:31], s81 offen offset:0  lds
    buffer_load_dwordx4 v9, s[28:31], s81 offen offset:1024  lds
    buffer_load_dwordx4 v10, s[28:31], s81 offen offset:2048  lds
L_pg2:
    s_cbranch_execz L_walked0
    buffer_load_dwordx4 v11, s[28:31], s81 offen offset:3072  lds
    v_mov_b32 v36, 2
    s_waitcnt vmcnt(9)
    s_cmp_lg_u32 s53, 0
    s_cbranch_scc1 L_slow_12
    buffer_store_dword v36, v28, s[40:43], s54 offen
L_st_13:
    s_mov_b64 exec, 0
    s_cmp_eq_u32 s44, 0
    s_cbranch_scc1 L_pg4
    s_cmp_eq_u32 s44, 1
    s_cbranch_scc1 L_pg5
    s_cmp_eq_u32 s44, 2
    s_cbranch_scc1 L_pg6
    s_branch L_pg7
L_walked1:
    s_mov_b64 exec, -1
    buffer_load_dword v38, v30, s[40:43], s56 offen sc1
    v_add_u32 v39, s12, v1
    v_add_u32 v40, s13, v1
    v_add_u32 v41, s14, v1
    v_lshlrev_b32 v154, 16, v20
    v_and_b32 v155, 0xffff0000, v20
    v_lshlrev_b32 v156, 16, v21
    v_and_b32 v157, 0xffff0000, v21
    v_lshlrev_b32 v158, 16, v22
    v_and_b32 v159, 0xffff0000, v22
    v_lshlrev_b32 v160, 16, v23
    v_and_b32 v161, 0xffff0000, v23
    v_lshlrev_b32 v162, 16, v24
    v_and_b32 v163, 0xffff0000, v24
    v_lshlrev_b32_e64 v164, 16, v25
    v_and_b32 v165, 0xffff0000, v25
    v_lshlrev_b32 v166, 16, v26
    v_and_b32 v167, 0xffff0000, v26
    v_lshlrev_b32 v168, 16, v27
    v_and_b32 v169, 0xffff0000, v27
    s_mov_b32 s50, s51
    s_add_u32 s51, s51, s52
    v_add_u32 v219, s61, v1
    s_lshl_b32 s69, s6, 14
    s_lshl_b32 s70, s48, 11
    s_mov_b32 s85, 0
L_poll_14:
    buffer_load_dword v37, v30, s[40:43], s56 offen sc1
    s_add_u32 s85, s85, 1
    s_cmp_lt_u32 s85, 131072
    s_cbranch_scc0 L_got_15
    s_waitcnt vmcnt(1)
    v_cmp_gt_u32 vcc, 2, v38
    s_cbranch_vccz L_got_15
    buffer_load_dword v38, v30, s[40:43], s56 offen sc1
    s_waitcnt vmcnt(1)
    v_cmp_gt_u32 vcc, 2, v37
    s_cbranch_vccnz L_poll_14
L_got_15:
    s_add_u32 s68, s8, s64
    buffer_load_dwordx4 v[42:45], v1, s[40:43], s68 offen offset:0 sc1
    buffer_load_dwordx4 v[46:49], v1, s[40:43], s68 offen offset:1024 sc1
    buffer_load_dwordx4 v[50:53], v1, s[40:43], s68 offen offset:2048 sc1
    buffer_load_dwordx4 v[54:57], v1, s[40:43], s68 offen offset:3072 sc1
    s_add_u32 s68, s9, s64
    buffer_load_dwordx4 v[58:61], v1, s[40:43], s68 offen offset:0 sc1
    buffer_load_dwordx4 v[62:65], v1, s[40:43], s68 offen offset:1024 sc1
    s_add_u32 s69, s69, s70
    s_add_u32 s69, s69, s51
    s_lshl_b32 s70, s6, 10
    s_add_u32 s70, s70, s7
    s_add_u32 s70, s70, s51
    s_add_u32 s70, s70, 131072
    v_bfe_u32 v220, v0, 4, 1
    v_lshrrev_b32 v221, 5, v0
    v_lshl_or_b32 v220, v220, 1, v221
    v_lshlrev_b32_e64 v221, 2, v15
    v_lshl_or_b32 v220, v220, 8, v221
    ds_read_b64_tr_b16 a[144:145], v6 offset:4096
    ds_read_b64_tr_b16 a[148:149], v7 offset:4096
    ds_read_b64_tr_b16 a[152:153], v6 offset:4608
    ds_read_b64_tr_b16 a[156:157], v7 offset:4608
    ds_read_b64_tr_b16 a[146:147], v6 offset:6144
    ds_read_b64_tr_b16 a[150:151], v7 offset:6144
    ds_read_b64_tr_b16 a[154:155], v6 offset:6656
    ds_read_b64_tr_b16 a[158:159], v7 offset:6656
    ds_read_b64_tr_b16 a[192:193], v6 offset:8192
    ds_read_b64_tr_b16 a[196:197], v7 offset:8192
    ds_read_b64_tr_b16 a[200:201], v6 offset:8704
    ds_read_b64_tr_b16 a[204:205], v7 offset:8704
    ds_read_b64_tr_b16 a[194:195], v6 offset:10240
    ds_read_b64_tr_b16 a[198:199], v7 offset:10240
    ds_read_b64_tr_b16 a[202:203], v6 offset:10752
    ds_read_b64_tr_b16 a[206:207], v7 offset:10752
    ds_read_b64_tr_b16 a[224:225], v6 offset:0
    ds_read_b64_tr_b16 a[228:229], v7 offset:0
    ds_read_b64_tr_b16 a[232:233], v6 offset:512
    ds_read_b64_tr_b16 a[236:237], v7 offset:512
    ds_read_b64_tr_b16 a[226:227], v6 offset:2048
    ds_read_b64_tr_b16 a[230:231], v7 offset:2048
    ds_read_b64_tr_b16 a[234:235], v6 offset:2560
    ds_read_b64_tr_b16 a[238:239], v7 offset:2560
    s_waitcnt lgkmcnt(0)
    s_barrier
    s_waitcnt vmcnt(5)
    v_mfma_f32_16x16x32_bf16 v[106:109], a[0:3], v[42:45], 0
    buffer_load_dwordx4 v[66:69], v1, s[40:43], s68 offen offset:2048 sc1
    v_mfma_f32_16x16x32_bf16 v[110:113], a[4:7], v[42:45], 0
    v_mfma_f32_16x16x32_bf16 v[114:117], a[8:11], v[42:45], 0
    v_mfma_f32_16x16x32_bf16 v[118:121], a[12:15], v[42:45], 0
    s_waitcnt vmcnt(5)
    v_mfma_f32_16x16x32_bf16 v[106:109], a[16:19], v[46:49], v[106:109]
    buffer_load_dwordx4 v[70:73], v1, s[40:43], s68 offen offset:3072 sc1
    v_mfma_f32_16x16x32_bf16 v[110:113], a[20:23], v[46:49], v[110:113]
    v_mfma_f32_16x16x32_bf16 v[114:117], a[24:27], v[46:49], v[114:117]
    v_mfma_f32_16x16x32_bf16 v[118:121], a[28:31], v[46:49], v[118:121]
    s_waitcnt vmcnt(5)
    v_mfma_f32_16x16x32_bf16 v[106:109], a[32:35], v[50:53], v[106:109]
    s_add_u32 s68, s10, s64
    buffer_load_dwordx4 v[74:77], v1, s[40:43], s68 offen offset:0 sc1
    v_mfma_f32_16x16x32_bf16 v[110:113], a[36:39], v[50:53], v[110:113]
    v_mfma_f32_16x16x32_bf16 v[114:117], a[40:43], v[50:53], v[114:117]
    v_mfma_f32_16x16x32_bf16 v[118:121], a[44:47], v[50:53], v[118:121]
    s_waitcnt vmcnt(5)
    v_mfma_f32_16x16x32_bf16 v[106:109], a[48:51], v[54:57], v[106:109]
    buffer_load_dwordx4 v[78:81], v1, s[40:43], s68 offen offset:1024 sc1
    v_mfma_f32_16x16x32_bf16 v[110:113], a[52:55], v[54:57], v[110:113]
    v_mfma_f32_16x16x32_bf16 v[114:117], a[56:59], v[54:57], v[114:117]
    v_mfma_f32_16x16x32_bf16 v[118:121], a[60:63], v[54:57], v[118:121]
    s_waitcnt vmcnt(5)
    v_mfma_f32_16x16x32_bf16 v[122:125], a[0:3], v[58:61], 0
    buffer_load_dwordx4 v[82:85], v1, s[40:43], s68 offen offset:2048 sc1
    v_mfma_f32_16x16x32_bf16 v[126:129], a[4:7], v[58:61], 0
    v_mfma_f32_16x16x32_bf16 v[130:133], a[8:11], v[58:61], 0
    ds_write_b128 v39, v[106:109] offset:0
    v_mfma_f32_16x16x32_bf16 v[134:137], a[12:15], v[58:61], 0
    s_waitcnt vmcnt(5)
    v_mfma_f32_16x16x32_bf16 v[122:125], a[16:19], v[62:65], v[122:125]
    buffer_load_dwordx4 v[86:89], v1, s[40:43], s68 offen offset:3072 sc1
    v_mfma_f32_16x16x32_bf16 v[126:129], a[20:23], v[62:65], v[126:129]
    ds_write_b128 v39, v[110:113] offset:1024
    v_mfma_f32_16x16x32_bf16 v[130:133], a[24:27], v[62:65], v[130:133]
    v_mfma_f32_16x16x32_bf16 v[134:137], a[28:31], v[62:65], v[134:137]
    s_waitcnt vmcnt(5)
    v_mfma_f32_16x16x32_bf16 v[122:125], a[32:35], v[66:69], v[122:125]
    s_add_u32 s68, s11, s64
    buffer_load_dwordx4 v[90:93], v1, s[40:43], s68 offen offset:0 sc1
    v_mfma_f32_16x16x32_bf16 v[126:129], a[36:39], v[66:69], v[126:129]
    ds_write_b128 v39, v[114:117] offset:2048
    v_mfma_f32_16x16x32_bf16 v[130:133], a[40:43], v[66:69], v[130:133]
    v_mfma_f32_16x16x32_bf16 v[134:137], a[44:47], v[66:69], v[134:137]
    s_waitcnt vmcnt(5)
    v_mfma_f32_16x16x32_bf16 v[122:125], a[48:51], v[70:73], v[122:125]
    buffer_load_dwordx4 v[94:97], v1, s[40:43], s68 offen offset:1024 sc1
    v_mfma_f32_16x16x32_bf16 v[126:129], a[52:55], v[70:73], v[126:129]
    ds_write_b128 v39, v[118:121] offset:3072
    v_mfma_f32_16x16x32_bf16 v[130:133], a[56:59], v[70:73], v[130:133]
    v_mfma_f32_16x16x32_bf16 v[134:137], a[60:63], v[70:73], v[134:137]
    s_waitcnt vmcnt(5)
    v_mfma_f32_16x16x32_bf16 v[138:141], a[0:3], v[74:77], 0
    buffer_load_dwordx4 v[98:101], v1, s[40:43], s68 offen offset:2048 sc1
    v_mfma_f32_16x16x32_bf16 v[142:145], a[4:7], v[74:77], 0
    v_mfma_f32_16x16x32_bf16 v[146:149], a[8:11], v[74:77], 0
    ds_write_b128 v40, v[122:125] offset:0
    v_mfma_f32_16x16x32_bf16 v[150:153], a[12:15], v[74:77], 0
    s_waitcnt vmcnt(5)
    v_mfma_f32_16x16x32_bf16 v[138:141], a[16:19], v[78:81], v[138:141]
    buffer_load_dwordx4 v[102:105], v1, s[40:43], s68 offen offset:3072 sc1
    v_mfma_f32_16x16x32_bf16 v[142:145], a[20:23], v[78:81], v[142:145]
    ds_write_b128 v40, v[126:129] offset:1024
    v_mfma_f32_16x16x32_bf16 v[146:149], a[24:27], v[78:81], v[146:149]
    s_add_u32 m0, s63, 147456
    s_add_u32 s80, s83, 0
    buffer_load_dwordx4 v12, s[20:23], s80 offen offset:0  lds
    v_mfma_f32_16x16x32_bf16 v[150:153], a[28:31], v[78:81], v[150:153]
    s_waitcnt vmcnt(6)
    v_mfma_f32_16x16x32_bf16 v[138:141], a[32:35], v[82:85], v[138:141]
    ds_write_b128 v40, v[130:133] offset:2048
    v_mfma_f32_16x16x32_bf16 v[142:145], a[36:39], v[82:85], v[142:145]
    v_mfma_f32_16x16x32_bf16 v[146:149], a[40:43], v[82:85], v[146:149]
    buffer_load_dwordx4 v13, s[20:23], s80 offen offset:1024  lds
    v_mfma_f32_16x16x32_bf16 v[150:153], a[44:47], v[82:85], v[150:153]
    ds_write_b128 v40, v[134:137] offset:3072
    s_waitcnt vmcnt(6)
    v_mfma_f32_16x16x32_bf16 v[138:141], a[48:51], v[86:89], v[138:141]
    v_mfma_f32_16x16x32_bf16 v[142:145], a[52:55], v[86:89], v[142:145]
    v_mfma_f32_16x16x32_bf16 v[146:149], a[56:59], v[86:89], v[146:149]
    buffer_load_dwordx4 v14, s[20:23], s80 offen offset:2048  lds
    v_mfma_f32_16x16x32_bf16 v[150:153], a[60:63], v[86:89], v[150:153]
    s_waitcnt vmcnt(6)
    v_mfma_f32_16x16x32_bf16 v[154:157], a[0:3], v[90:93], v[154:157]
    v_mfma_f32_16x16x32_bf16 v[158:161], a[4:7], v[90:93], v[158:161]
    v_mfma_f32_16x16x32_bf16 v[162:165], a[8:11], v[90:93], v[162:165]
    ds_write_b128 v41, v[138:141] offset:0
    v_mfma_f32_16x16x32_bf16 v[166:169], a[12:15], v[90:93], v[166:169]
    s_waitcnt lgkmcnt(1)
    s_barrier
    s_waitcnt vmcnt(5)
    v_mfma_f32_16x16x32_bf16 v[154:157], a[16:19], v[94:97], v[154:157]
    ds_read_b128 v[170:173], v219 offset:0
    ds_read_b128 v[174:177], v219 offset:1024
    v_mfma_f32_16x16x32_bf16 v[158:161], a[20:23], v[94:97], v[158:161]
    ds_write_b128 v41, v[142:145] offset:1024
    v_mfma_f32_16x16x32_bf16 v[162:165], a[24:27], v[94:97], v[162:165]
    ds_read_b128 v[178:181], v219 offset:2048
    ds_read_b128 v[182:185], v219 offset:3072
    v_mfma_f32_16x16x32_bf16 v[166:169], a[28:31], v[94:97], v[166:169]
    ds_read_b128 v[186:189], v219 offset:4096
    ds_read_b128 v[190:193], v219 offset:5120
    s_waitcnt vmcnt(4)
    v_mfma_f32_16x16x32_bf16 v[154:157], a[32:35], v[98:101], v[154:157]
    ds_write_b128 v41, v[146:149] offset:2048
    v_mfma_f32_16x16x32_bf16 v[158:161], a[36:39], v[98:101], v[158:161]
    ds_read_b128 v[194:197], v219 offset:6144
    ds_read_b128 v[198:201], v219 offset:7168
    v_mfma_f32_16x16x32_bf16 v[162:165], a[40:43], v[98:101], v[162:165]
    s_waitcnt lgkmcnt(0)
    v_mfma_f32_16x16x32_bf16 v[166:169], a[44:47], v[98:101], v[166:169]
    ds_write_b128 v41, v[150:153] offset:3072
    s_waitcnt lgkmcnt(0)
    s_barrier
    s_waitcnt vmcnt(3)
    v_mfma_f32_16x16x32_bf16 v[154:157], a[48:51], v[102:105], v[154:157]
    ds_read_b128 v[202:205], v219 offset:8192
    ds_read_b128 v[206:209], v219 offset:9216
    v_mfma_f32_16x16x32_bf16 v[158:161], a[52:55], v[102:105], v[158:161]
    ds_read_b128 v[210:213], v219 offset:10240
    ds_read_b128 v[214:217], v219 offset:11264
    v_mfma_f32_16x16x32_bf16 v[162:165], a[56:59], v[102:105], v[162:165]
    v_mfma_f32_16x16x32_bf16 v[166:169], a[60:63], v[102:105], v[166:169]
    s_lshl_b32 s64, s44, 15
    s_add_u32 s64, s64, s51
    s_add_u32 s65, s64, 16384
    s_mov_b32 s78, s64
    v_lshlrev_b32 v241, 10, v0
    v_pk_add_f32 v[154:155], v[154:155], v[170:171]
    v_pk_add_f32 v[156:157], v[156:157], v[172:173]
    v_pk_add_f32 v[158:159], v[158:159], v[174:175]
    v_pk_add_f32 v[160:161], v[160:161], v[176:177]
    v_pk_add_f32 v[162:163], v[162:163], v[178:179]
    v_pk_add_f32 v[164:165], v[164:165], v[180:181]
    v_pk_add_f32 v[166:167], v[166:167], v[182:183]
    v_pk_add_f32 v[168:169], v[168:169], v[184:185]
    v_pk_add_f32 v[154:155], v[154:155], v[186:187]
    v_pk_add_f32 v[156:157], v[156:157], v[188:189]
    v_pk_add_f32 v[158:159], v[158:159], v[190:191]
    v_pk_add_f32 v[160:161], v[160:161], v[192:193]
    v_pk_add_f32 v[162:163], v[162:163], v[194:195]
    v_pk_add_f32 v[164:165], v[164:165], v[196:197]
    v_pk_add_f32 v[166:167], v[166:167], v[198:199]
    v_pk_add_f32 v[168:169], v[168:169], v[200:201]
    s_waitcnt lgkmcnt(2)
    v_pk_add_f32 v[154:155], v[154:155], v[202:203]
    v_pk_add_f32 v[156:157], v[156:157], v[204:205]
    v_pk_add_f32 v[158:159], v[158:159], v[206:207]
    v_pk_add_f32 v[160:161], v[160:161], v[208:209]
    v_cvt_pk_bf16_f32 v20, v154, v155
    v_cvt_pk_bf16_f32 v21, v156, v157
    v_cvt_pk_bf16_f32 v22, v158, v159
    v_cvt_pk_bf16_f32 v23, v160, v161
    s_nop 0
    v_permlane16_swap_b32 v20, v22
    v_permlane16_swap_b32 v21, v23
    s_cmp_lg_u32 s53, 0
    s_cbranch_scc1 L_slow_16
    buffer_store_dwordx4 v[20:23], v220, s[40:43], s69 offen offset:0
L_st_17:
    s_waitcnt lgkmcnt(0)
    v_pk_add_f32 v[162:163], v[162:163], v[210:211]
    v_pk_add_f32 v[164:165], v[164:165], v[212:213]
    v_pk_add_f32 v[166:167], v[166:167], v[214:215]
    v_pk_add_f32 v[168:169], v[168:169], v[216:217]
    v_cvt_pk_bf16_f32 v24, v162, v163
    v_cvt_pk_bf16_f32 v25, v164, v165
    v_cvt_pk_bf16_f32 v26, v166, v167
    v_cvt_pk_bf16_f32 v27, v168, v169
    s_nop 0
    v_permlane16_swap_b32 v24, v26
    v_permlane16_swap_b32 v25, v27
    s_cmp_lg_u32 s53, 0
    s_cbranch_scc1 L_slow_18
    buffer_store_dwordx4 v[24:27], v220, s[40:43], s69 offen offset:1024
L_st_19:
    v_mfma_f32_16x16x32_bf16 v[110:113], v[20:23], v[20:23], 0
    v_mfma_f32_16x16x32_bf16 v[106:109], v[16:19], v[20:23], 0
    v_mfma_f32_16x16x32_bf16 v[110:113], v[24:27], v[24:27], v[110:113]
    v_mfma_f32_16x16x32_bf16 v[106:109], v[16:19], v[24:27], v[106:109]
    s_or_b64 vcc, s[90:91], s[92:93]
    s_nop 5
    v_cndmask_b32 v110, v110, v111, s[88:89]
    v_cndmask_b32 v112, v112, v113, s[92:93]
    v_cndmask_b32 v107, v110, v112, vcc
    s_mov_b64 exec, s[94:95]
    s_cmp_lg_u32 s53, 0
    s_cbranch_scc1 L_slow_20
    buffer_store_dwordx2 v[106:107], v221, s[40:43], s70 offen
L_st_21:
    s_mov_b64 exec, -1
    s_barrier
    s_add_u32 m0, s63, 98304
    s_add_u32 s80, s83, 176128
    buffer_load_dwordx4 v12, s[20:23], s80 offen offset:0  lds
    buffer_load_dwordx4 v13, s[20:23], s80 offen offset:1024  lds
    buffer_load_dwordx4 v14, s[20:23], s80 offen offset:2048  lds
    s_mov_b32 s50, s51
    s_add_u32 s51, s51, s52
    s_lshl_b32 s66, s44, 11
    s_add_u32 s66, s66, s50
    s_add_u32 s66, s66, 131072
    s_mul_i32 s72, s44, 90112
    s_lshl_b32 s73, s59, 10
    s_add_u32 s72, s72, s73
    s_add_u32 s72, s72, s51
    s_add_u32 s72, s72, 163840
    s_add_u32 s73, s72, 45056
    v_add_u32 v41, 159744, v32
    s_and_b32 s68, s46, 3
    s_cmp_eq_u32 s68, 3
    s_cselect_b32 s68, 0x40000000, 0
    v_add_u32 v238, s68, v1
    s_cmp_eq_u32 s46, 15
    s_cselect_b32 s68, 0x40000000, 0
    v_add_u32 v239, s68, v1
    s_lshr_b32 s68, s44, 1
    s_mul_i32 s68, s68, 6144
    s_and_b32 s69, s44, 1
    s_lshl_b32 s70, s69, 5
    s_lshl_b32 s69, s69, 6
    s_add_u32 s68, s68, s69
    v_xor_b32 v198, s70, v34
    v_add_u32 v198, s68, v198
    v_xor_b32 v199, 32, v198
    v_add_u32 v199, s69, v199
    v_add_u32 v200, 64, v198
    s_lshl_b32 s96, s44, 12
    s_add_u32 s96, s96, 98304
    s_sub_u32 s68, s96, s61
    v_add_u32 v6, s68, v6
    v_add_u32 v7, s68, v7
    v_mov_b32 v36, 3
    s_waitcnt vmcnt(4)
    s_cmp_lg_u32 s53, 0
    s_cbranch_scc1 L_slow_22
    buffer_store_dword v36, v28, s[40:43], s55 offen
L_st_23:
    s_add_u32 m0, s63, 110592
    s_add_u32 s80, s83, 352256
    buffer_load_dwordx4 v12, s[20:23], s80 offen offset:0  lds
    buffer_load_dwordx4 v13, s[20:23], s80 offen offset:1024  lds
    buffer_load_dwordx4 v14, s[20:23], s80 offen offset:2048  lds
    s_barrier
    s_lshl_b32 s67, s59, 6
    v_lshlrev_b32_e64 v39, 1, v0
    buffer_load_short_d16_hi v234, v39, s[24:27], s67 offen
    buffer_load_short_d16_hi v235, v39, s[24:27], s67 offen offset:128
    buffer_load_dword v38, v15, s[40:43], s57 offen sc1
    ds_read_b64_tr_b16 v[154:155], v34 offset:49152
    ds_read_b64_tr_b16 v[156:157], v34 offset:52224
    ds_read_b64_tr_b16 v[158:159], v35 offset:49152
    ds_read_b64_tr_b16 v[160:161], v35 offset:52224
    ds_read_b64_tr_b16 v[162:163], v34 offset:49216
    ds_read_b64_tr_b16 v[164:165], v34 offset:52288
    ds_read_b64_tr_b16 v[166:167], v35 offset:49216
    ds_read_b64_tr_b16 v[168:169], v35 offset:52288
    ds_read_b64_tr_b16 v[170:171], v34 offset:49280
    ds_read_b64_tr_b16 v[172:173], v34 offset:52352
    ds_read_b64_tr_b16 v[174:175], v35 offset:49280
    ds_read_b64_tr_b16 v[176:177], v35 offset:52352
    s_mov_b32 s85, 0
L_poll_24:
    buffer_load_dword v37, v15, s[40:43], s57 offen sc1
    s_add_u32 s85, s85, 1
    s_cmp_lt_u32 s85, 131072
    s_cbranch_scc0 L_got_25
    s_waitcnt vmcnt(1)
    v_cmp_gt_u32 vcc, 3, v38
    s_cbranch_vccz L_got_25
    buffer_load_dword v38, v15, s[40:43], s57 offen sc1
    s_waitcnt vmcnt(1)
    v_cmp_gt_u32 vcc, 3, v37
    s_cbranch_vccnz L_poll_24
L_got_25:
    buffer_load_dwordx4 v[42:45], v1, s[40:43], s64 offen offset:0 sc1
    buffer_load_dwordx4 v[46:49], v1, s[40:43], s65 offen offset:0 sc1
    buffer_load_dwordx4 v[50:53], v1, s[40:43], s64 offen offset:1024 sc1
    buffer_load_dwordx4 v[54:57], v1, s[40:43], s65 offen offset:1024 sc1
    v_mov_b32 v36, 4
    s_cmp_lg_u32 s53, 0
    s_cbranch_scc1 L_slow_26
    buffer_store_dword v36, v28, s[40:43], s55 offen
L_st_27:
    v_and_b32 v234, 0xffff0000, v234
    v_and_b32 v235, 0xffff0000, v235
    v_mul_f32 v234, s98, v234
    v_mul_f32 v235, s98, v235
    v_lshlrev_b32_e64 v36, 2, v0
    v_add_u32 v36, 160256, v36
    ds_write2_b32 v36, v234, v235 offset0:0 offset1:64
    s_waitcnt vmcnt(3) lgkmcnt(7)
    v_mfma_f32_16x16x32_bf16 v[106:109], v[154:157], v[42:45], 0
    ds_read_b64_tr_b16 v[178:179], v34 offset:55296
    buffer_load_dwordx4 v[58:61], v1, s[40:43], s64 offen offset:2048 sc1
    v_mfma_f32_16x16x32_bf16 v[110:113], v[154:157], v[46:49], 0
    ds_read_b64_tr_b16 v[180:181], v34 offset:58368
    ds_read_b64_tr_b16 v[186:187], v198 offset:49152
    v_mfma_f32_16x16x32_bf16 v[114:117], v[158:161], v[42:45], 0
    ds_read_b64_tr_b16 v[182:183], v35 offset:55296
    ds_read_b64_tr_b16 v[188:189], v198 offset:52224
    v_mfma_f32_16x16x32_bf16 v[118:121], v[158:161], v[46:49], 0
    ds_read_b64_tr_b16 v[184:185], v35 offset:58368
    buffer_load_dwordx4 v[62:65], v1, s[40:43], s65 offen offset:2048 sc1
    v_mfma_f32_16x16x32_bf16 v[122:125], v[162:165], v[42:45], 0
    ds_read_b64_tr_b16 v[154:155], v34 offset:55360
    ds_read_b64_tr_b16 v[190:191], v199 offset:49152
    v_mfma_f32_16x16x32_bf16 v[126:129], v[162:165], v[46:49], 0
    ds_read_b64_tr_b16 v[156:157], v34 offset:58432
    ds_read_b64_tr_b16 v[192:193], v199 offset:52224
    s_waitcnt lgkmcnt(11)
    v_mfma_f32_16x16x32_bf16 v[130:133], v[166:169], v[42:45], 0
    ds_read_b64_tr_b16 v[158:159], v35 offset:55360
    s_add_u32 m0, s63, 122880
    s_add_u32 s80, s83, 528384
    buffer_load_dwordx4 v12, s[20:23], s80 offen offset:0  lds
    v_mfma_f32_16x16x32_bf16 v[134:137], v[166:169], v[46:49], 0
    ds_read_b64_tr_b16 v[160:161], v35 offset:58432
    ds_read_b64_tr_b16 v[194:195], v200 offset:49152
    v_mfma_f32_16x16x32_bf16 v[138:141], v[170:173], v[42:45], 0
    ds_read_b64_tr_b16 v[162:163], v34 offset:55424
    ds_read_b64_tr_b16 v[196:197], v200 offset:52224
    v_mfma_f32_16x16x32_bf16 v[142:145], v[170:173], v[46:49], 0
    ds_read_b64_tr_b16 v[164:165], v34 offset:58496
    buffer_load_dwordx4 v13, s[20:23], s80 offen offset:1024  lds
    v_mfma_f32_16x16x32_bf16 v[146:149], v[174:177], v[42:45], 0
    ds_read_b64_tr_b16 v[166:167], v35 offset:55424
    v_mfma_f32_16x16x32_bf16 v[150:153], v[174:177], v[46:49], 0
    ds_read_b64_tr_b16 v[168:169], v35 offset:58496
    s_waitcnt lgkmcnt(3)
    v_mfma_f32_16x16x32_bf16 a[208:211], v[16:19], v[186:189], 0
    buffer_load_dwordx4 v14, s[20:23], s80 offen offset:2048  lds
    v_mfma_f32_16x16x32_bf16 a[212:215], v[16:19], v[190:193], 0
    v_mfma_f32_16x16x32_bf16 a[216:219], v[16:19], v[194:197], 0
    s_barrier
    s_waitcnt vmcnt(6)
    v_mfma_f32_16x16x32_bf16 v[106:109], v[178:181], v[50:53], v[106:109]
    ds_read_b64_tr_b16 v[170:171], v34 offset:0
    buffer_load_dwordx4 v[66:69], v1, s[40:43], s64 offen offset:3072 sc1
    v_mfma_f32_16x16x32_bf16 v[110:113], v[178:181], v[54:57], v[110:113]
    ds_read_b64_tr_b16 v[172:173], v34 offset:3072
    ds_read_b64_tr_b16 v[186:187], v198 offset:0
    v_mfma_f32_16x16x32_bf16 v[114:117], v[182:185], v[50:53], v[114:117]
    ds_read_b64_tr_b16 v[174:175], v35 offset:0
    ds_read_b64_tr_b16 v[188:189], v198 offset:3072
    v_mfma_f32_16x16x32_bf16 v[118:121], v[182:185], v[54:57], v[118:121]
    ds_read_b64_tr_b16 v[176:177], v35 offset:3072
    buffer_load_dwordx4 v[70:73], v1, s[40:43], s65 offen offset:3072 sc1
    v_mfma_f32_16x16x32_bf16 v[122:125], v[154:157], v[50:53], v[122:125]
    ds_read_b64_tr_b16 v[178:179], v34 offset:64
    ds_read_b64_tr_b16 v[190:191], v199 offset:0
    v_mfma_f32_16x16x32_bf16 v[126:129], v[154:157], v[54:57], v[126:129]
    ds_read_b64_tr_b16 v[180:181], v34 offset:3136
    ds_read_b64_tr_b16 v[192:193], v199 offset:3072
    s_waitcnt lgkmcnt(10)
    v_mfma_f32_16x16x32_bf16 v[130:133], v[158:161], v[50:53], v[130:133]
    ds_read_b64_tr_b16 v[182:183], v35 offset:64
    s_add_u32 s64, s64, 4096
    s_add_u32 s65, s65, 4096
    buffer_load_dwordx4 v[74:77], v1, s[40:43], s64 offen offset:0 sc1
    v_mfma_f32_16x16x32_bf16 v[134:137], v[158:161], v[54:57], v[134:137]
    ds_read_b64_tr_b16 v[184:185], v35 offset:3136
    ds_read_b64_tr_b16 v[194:195], v200 offset:0
    v_mfma_f32_16x16x32_bf16 v[138:141], v[162:165], v[50:53], v[138:141]
    ds_read_b64_tr_b16 v[154:155], v34 offset:128
    ds_read_b64_tr_b16 v[196:197], v200 offset:3072
    v_mfma_f32_16x16x32_bf16 v[142:145], v[162:165], v[54:57], v[142:145]
    ds_read_b64_tr_b16 v[156:157], v34 offset:3200
    buffer_load_dwordx4 v[78:81], v1, s[40:43], s65 offen offset:0 sc1
    v_mfma_f32_16x16x32_bf16 v[146:149], v[166:169], v[50:53], v[146:149]
    ds_read_b64_tr_b16 v[158:159], v35 offset:128
    v_mfma_f32_16x16x32_bf16 v[150:153], v[166:169], v[54:57], v[150:153]
    ds_read_b64_tr_b16 v[160:161], v35 offset:3200
    s_waitcnt vmcnt(7) lgkmcnt(9)
    v_mfma_f32_16x16x32_bf16 v[106:109], v[170:173], v[58:61], v[106:109]
    ds_read_b64_tr_b16 v[162:163], v34 offset:6144
    s_add_u32 m0, s63, 135168
    s_add_u32 s80, s83, 704512
    buffer_load_dwordx4 v12, s[20:23], s80 offen offset:0  lds
    v_mfma_f32_16x16x32_bf16 v[110:113], v[170:173], v[62:65], v[110:113]
    ds_read_b64_tr_b16 v[164:165], v34 offset:9216
    v_mfma_f32_16x16x32_bf16 v[114:117], v[174:177], v[58:61], v[114:117]
    ds_read_b64_tr_b16 v[166:167], v35 offset:6144
    v_mfma_f32_16x16x32_bf16 v[118:121], v[174:177], v[62:65], v[118:121]
    ds_read_b64_tr_b16 v[168:169], v35 offset:9216
    buffer_load_dwordx4 v13, s[20:23], s80 offen offset:1024  lds
    v_mfma_f32_16x16x32_bf16 v[122:125], v[178:181], v[58:61], v[122:125]
    ds_read_b64_tr_b16 v[170:171], v34 offset:6208
    v_mfma_f32_16x16x32_bf16 v[126:129], v[178:181], v[62:65], v[126:129]
    ds_read_b64_tr_b16 v[172:173], v34 offset:9280
    s_waitcnt lgkmcnt(9)
    v_mfma_f32_16x16x32_bf16 a[208:211], v[16:19], v[186:189], a[208:211]
    buffer_load_dwordx4 v14, s[20:23], s80 offen offset:2048  lds
    v_mfma_f32_16x16x32_bf16 a[212:215], v[16:19], v[190:193], a[212:215]
    v_mfma_f32_16x16x32_bf16 a[216:219], v[16:19], v[194:197], a[216:219]
    s_waitcnt lgkmcnt(6)
    v_mfma_f32_16x16x32_bf16 v[130:133], v[182:185], v[58:61], v[130:133]
    ds_read_b64_tr_b16 v[174:175], v35 offset:6208
    buffer_load_dwordx4 v[82:85], v1, s[40:43], s64 offen offset:1024 sc1
    v_mfma_f32_16x16x32_bf16 v[134:137], v[182:185], v[62:65], v[134:137]
    ds_read_b64_tr_b16 v[176:177], v35 offset:9280
    v_mfma_f32_16x16x32_bf16 v[138:141], v[154:157], v[58:61], v[138:141]
    ds_read_b64_tr_b16 v[178:179], v34 offset:6272
    v_mfma_f32_16x16x32_bf16 v[142:145], v[154:157], v[62:65], v[142:145]
    ds_read_b64_tr_b16 v[180:181], v34 offset:9344
    buffer_load_dwordx4 v[86:89], v1, s[40:43], s65 offen offset:1024 sc1
    v_mfma_f32_16x16x32_bf16 v[146:149], v[158:161], v[58:61], v[146:149]
    ds_read_b64_tr_b16 v[182:183], v35 offset:6272
    v_mfma_f32_16x16x32_bf16 v[150:153], v[158:161], v[62:65], v[150:153]
    ds_read_b64_tr_b16 v[184:185], v35 offset:9344
    s_waitcnt vmcnt(7) lgkmcnt(6)
    v_mfma_f32_16x16x32_bf16 v[106:109], v[162:165], v[66:69], v[106:109]
    ds_read_b64_tr_b16 v[154:155], v34 offset:12288
    buffer_load_dwordx4 v[90:93], v1, s[40:43], s64 offen offset:2048 sc1
    v_mfma_f32_16x16x32_bf16 v[110:113], v[162:165], v[70:73], v[110:113]
    ds_read_b64_tr_b16 v[156:157], v34 offset:15360
    ds_read_b64_tr_b16 v[186:187], v198 offset:12288
    v_mfma_f32_16x16x32_bf16 v[114:117], v[166:169], v[66:69], v[114:117]
    ds_read_b64_tr_b16 v[158:159], v35 offset:12288
    ds_read_b64_tr_b16 v[188:189], v198 offset:15360
    v_mfma_f32_16x16x32_bf16 v[118:121], v[166:169], v[70:73], v[118:121]
    ds_read_b64_tr_b16 v[160:161], v35 offset:15360
    buffer_load_dwordx4 v[94:97], v1, s[40:43], s65 offen offset:2048 sc1
    v_mfma_f32_16x16x32_bf16 v[122:125], v[170:173], v[66:69], v[122:125]
    ds_read_b64_tr_b16 v[162:163], v34 offset:12352
    ds_read_b64_tr_b16 v[190:191], v199 offset:12288
    v_mfma_f32_16x16x32_bf16 v[126:129], v[170:173], v[70:73], v[126:129]
    ds_read_b64_tr_b16 v[164:165], v34 offset:15424
    ds_read_b64_tr_b16 v[192:193], v199 offset:15360
    s_waitcnt lgkmcnt(10)
    v_mfma_f32_16x16x32_bf16 v[130:133], v[174:177], v[66:69], v[130:133]
    ds_read_b64_tr_b16 v[166:167], v35 offset:12352
    buffer_load_dwordx4 v[98:101], v1, s[40:43], s64 offen offset:3072 sc1
    v_mfma_f32_16x16x32_bf16 v[134:137], v[174:177], v[70:73], v[134:137]
    ds_read_b64_tr_b16 v[168:169], v35 offset:15424
    ds_read_b64_tr_b16 v[194:195], v200 offset:12288
    v_mfma_f32_16x16x32_bf16 v[138:141], v[178:181], v[66:69], v[138:141]
    ds_read_b64_tr_b16 v[170:171], v34 offset:12416
    ds_read_b64_tr_b16 v[196:197], v200 offset:15360
    v_mfma_f32_16x16x32_bf16 v[142:145], v[178:181], v[70:73], v[142:145]
    ds_read_b64_tr_b16 v[172:173], v34 offset:15488
    buffer_load_dwordx4 v[102:105], v1, s[40:43], s65 offen offset:3072 sc1
    v_mfma_f32_16x16x32_bf16 v[146:149], v[182:185], v[66:69], v[146:149]
    ds_read_b64_tr_b16 v[174:175], v35 offset:12416
    v_mfma_f32_16x16x32_bf16 v[150:153], v[182:185], v[70:73], v[150:153]
    ds_read_b64_tr_b16 v[176:177], v35 offset:15488
    s_waitcnt vmcnt(9) lgkmcnt(9)
    v_mfma_f32_16x16x32_bf16 v[106:109], v[154:157], v[74:77], v[106:109]
    ds_read_b64_tr_b16 v[178:179], v34 offset:18432
    s_add_u32 s64, s64, 4096
    s_add_u32 s65, s65, 4096
    buffer_load_dwordx4 v[42:45], v1, s[40:43], s64 offen offset:0 sc1
    v_mfma_f32_16x16x32_bf16 v[110:113], v[154:157], v[78:81], v[110:113]
    ds_read_b64_tr_b16 v[180:181], v34 offset:21504
    buffer_load_dword v38, v15, s[40:43], s57 offen sc1
    v_mfma_f32_16x16x32_bf16 v[114:117], v[158:161], v[74:77], v[114:117]
    ds_read_b64_tr_b16 v[182:183], v35 offset:18432
    v_mfma_f32_16x16x32_bf16 v[118:121], v[158:161], v[78:81], v[118:121]
    ds_read_b64_tr_b16 v[184:185], v35 offset:21504
    buffer_load_dwordx4 v[46:49], v1, s[40:43], s65 offen offset:0 sc1
    v_mfma_f32_16x16x32_bf16 v[122:125], v[162:165], v[74:77], v[122:125]
    ds_read_b64_tr_b16 v[154:155], v34 offset:18496
    v_mfma_f32_16x16x32_bf16 v[126:129], v[162:165], v[78:81], v[126:129]
    ds_read_b64_tr_b16 v[156:157], v34 offset:21568
    s_waitcnt lgkmcnt(9)
    v_mfma_f32_16x16x32_bf16 a[208:211], v[16:19], v[186:189], a[208:211]
    v_mfma_f32_16x16x32_bf16 a[212:215], v[16:19], v[190:193], a[212:215]
    v_mfma_f32_16x16x32_bf16 a[216:219], v[16:19], v[194:197], a[216:219]
    s_waitcnt lgkmcnt(6)
    v_mfma_f32_16x16x32_bf16 v[130:133], v[166:169], v[74:77], v[130:133]
    ds_read_b64_tr_b16 v[158:159], v35 offset:18496
    v_mfma_f32_16x16x32_bf16 v[134:137], v[166:169], v[78:81], v[134:137]
    ds_read_b64_tr_b16 v[160:161], v35 offset:21568
    v_mfma_f32_16x16x32_bf16 v[138:141], v[170:173], v[74:77], v[138:141]
    ds_read_b64_tr_b16 v[162:163], v34 offset:18560
    v_mfma_f32_16x16x32_bf16 v[142:145], v[170:173], v[78:81], v[142:145]
    ds_read_b64_tr_b16 v[164:165], v34 offset:21632
    v_mfma_f32_16x16x32_bf16 v[146:149], v[174:177], v[74:77], v[146:149]
    ds_read_b64_tr_b16 v[166:167], v35 offset:18560
    v_mfma_f32_16x16x32_bf16 v[150:153], v[174:177], v[78:81], v[150:153]
    ds_read_b64_tr_b16 v[168:169], v35 offset:21632
    s_barrier
    s_waitcnt vmcnt(7) lgkmcnt(6)
    v_mfma_f32_16x16x32_bf16 v[106:109], v[178:181], v[82:85], v[106:109]
    ds_read_b64_tr_b16 v[170:171], v34 offset:24576
    buffer_load_dwordx4 v[50:53], v1, s[40:43], s64 offen offset:1024 sc1
    v_mfma_f32_16x16x32_bf16 v[110:113], v[178:181], v[86:89], v[110:113]
    ds_read_b64_tr_b16 v[172:173], v34 offset:27648
    ds_read_b64_tr_b16 v[186:187], v198 offset:24576
    v_mfma_f32_16x16x32_bf16 v[114:117], v[182:185], v[82:85], v[114:117]
    ds_read_b64_tr_b16 v[174:175], v35 offset:24576
    ds_read_b64_tr_b16 v[188:189], v198 offset:27648
    v_mfma_f32_16x16x32_bf16 v[118:121], v[182:185], v[86:89], v[118:121]
    ds_read_b64_tr_b16 v[176:177], v35 offset:27648
    buffer_load_dwordx4 v[54:57], v1, s[40:43], s65 offen offset:1024 sc1
    v_mfma_f32_16x16x32_bf16 v[122:125], v[154:157], v[82:85], v[122:125]
    ds_read_b64_tr_b16 v[178:179], v34 offset:24640
    ds_read_b64_tr_b16 v[190:191], v199 offset:24576
L_pg3:
    s_cbranch_execz L_walked0
    v_mfma_f32_16x16x32_bf16 v[126:129], v[154:157], v[86:89], v[126:129]
    ds_read_b64_tr_b16 v[180:181], v34 offset:27712
    ds_read_b64_tr_b16 v[192:193], v199 offset:27648
    s_waitcnt lgkmcnt(10)
    v_mfma_f32_16x16x32_bf16 v[130:133], v[158:161], v[82:85], v[130:133]
    ds_read_b64_tr_b16 v[182:183], v35 offset:24640
    buffer_load_dwordx4 v[58:61], v1, s[40:43], s64 offen offset:2048 sc1
    v_mfma_f32_16x16x32_bf16 v[134:137], v[158:161], v[86:89], v[134:137]
    ds_read_b64_tr_b16 v[184:185], v35 offset:27712
    ds_read_b64_tr_b16 v[194:195], v200 offset:24576
    v_mfma_f32_16x16x32_bf16 v[138:141], v[162:165], v[82:85], v[138:141]
    ds_read_b64_tr_b16 v[154:155], v34 offset:24704
    ds_read_b64_tr_b16 v[196:197], v200 offset:27648
    v_mfma_f32_16x16x32_bf16 v[142:145], v[162:165], v[86:89], v[142:145]
    ds_read_b64_tr_b16 v[156:157], v34 offset:27776
    buffer_load_dwordx4 v[62:65], v1, s[40:43], s65 offen offset:2048 sc1
    v_mfma_f32_16x16x32_bf16 v[146:149], v[166:169], v[82:85], v[146:149]
    ds_read_b64_tr_b16 v[158:159], v35 offset:24704
    v_mfma_f32_16x16x32_bf16 v[150:153], v[166:169], v[86:89], v[150:153]
    ds_read_b64_tr_b16 v[160:161], v35 offset:27776
    s_waitcnt vmcnt(9) lgkmcnt(9)
    v_mfma_f32_16x16x32_bf16 v[106:109], v[170:173], v[90:93], v[106:109]
    ds_read_b64_tr_b16 v[162:163], v34 offset:30720
    s_add_u32 m0, s63, 147456
    s_add_u32 s80, s83, 880640
    buffer_load_dwordx4 v12, s[20:23], s80 offen offset:0  lds
    v_mfma_f32_16x16x32_bf16 v[110:113], v[170:173], v[94:97], v[110:113]
    ds_read_b64_tr_b16 v[164:165], v34 offset:33792
    v_mfma_f32_16x16x32_bf16 v[114:117], v[174:177], v[90:93], v[114:117]
    ds_read_b64_tr_b16 v[166:167], v35 offset:30720
    v_mfma_f32_16x16x32_bf16 v[118:121], v[174:177], v[94:97], v[118:121]
    ds_read_b64_tr_b16 v[168:169], v35 offset:33792
    buffer_load_dwordx4 v13, s[20:23], s80 offen offset:1024  lds
    v_mfma_f32_16x16x32_bf16 v[122:125], v[178:181], v[90:93], v[122:125]
    ds_read_b64_tr_b16 v[170:171], v34 offset:30784
    v_mfma_f32_16x16x32_bf16 v[126:129], v[178:181], v[94:97], v[126:129]
    ds_read_b64_tr_b16 v[172:173], v34 offset:33856
    s_waitcnt lgkmcnt(9)
    v_mfma_f32_16x16x32_bf16 a[208:211], v[16:19], v[186:189], a[208:211]
    buffer_load_dwordx4 v14, s[20:23], s80 offen offset:2048  lds
    v_mfma_f32_16x16x32_bf16 a[212:215], v[16:19], v[190:193], a[212:215]
    v_mfma_f32_16x16x32_bf16 a[216:219], v[16:19], v[194:197], a[216:219]
    s_waitcnt lgkmcnt(6)
    v_mfma_f32_16x16x32_bf16 v[130:133], v[182:185], v[90:93], v[130:133]
    ds_read_b64_tr_b16 v[174:175], v35 offset:30784
    buffer_load_dwordx4 v[66:69], v1, s[40:43], s64 offen offset:3072 sc1
    v_mfma_f32_16x16x32_bf16 v[134:137], v[182:185], v[94:97], v[134:137]
    ds_read_b64_tr_b16 v[176:177], v35 offset:33856
    v_mfma_f32_16x16x32_bf16 v[138:141], v[154:157], v[90:93], v[138:141]
    ds_read_b64_tr_b16 v[178:179], v34 offset:30848
    v_mfma_f32_16x16x32_bf16 v[142:145], v[154:157], v[94:97], v[142:145]
    ds_read_b64_tr_b16 v[180:181], v34 offset:33920
    buffer_load_dwordx4 v[70:73], v1, s[40:43], s65 offen offset:3072 sc1
    v_mfma_f32_16x16x32_bf16 v[146:149], v[158:161], v[90:93], v[146:149]
    ds_read_b64_tr_b16 v[182:183], v35 offset:30848
    v_mfma_f32_16x16x32_bf16 v[150:153], v[158:161], v[94:97], v[150:153]
    ds_read_b64_tr_b16 v[184:185], v35 offset:33920
    s_barrier
    s_waitcnt vmcnt(10)
    v_cmp_gt_u32 vcc, 4, v38
    s_cbranch_vccnz L_fb_29
L_ok_28:
    s_waitcnt lgkmcnt(6)
    v_mfma_f32_16x16x32_bf16 v[106:109], v[162:165], v[98:101], v[106:109]
    ds_read_b64_tr_b16 v[154:155], v34 offset:36864
    s_add_u32 s64, s64, 4096
    s_add_u32 s65, s65, 4096
    buffer_load_dwordx4 v[74:77], v1, s[40:43], s64 offen offset:0 sc1
    v_mfma_f32_16x16x32_bf16 v[110:113], v[162:165], v[102:105], v[110:113]
    ds_read_b64_tr_b16 v[156:157], v34 offset:39936
    ds_read_b64_tr_b16 v[186:187], v198 offset:36864
    v_mfma_f32_16x16x32_bf16 v[114:117], v[166:169], v[98:101], v[114:117]
    ds_read_b64_tr_b16 v[158:159], v35 offset:36864
    ds_read_b64_tr_b16 v[188:189], v198 offset:39936
    v_mfma_f32_16x16x32_bf16 v[118:121], v[166:169], v[102:105], v[118:121]
    ds_read_b64_tr_b16 v[160:161], v35 offset:39936
    buffer_load_dwordx4 v[78:81], v1, s[40:43], s65 offen offset:0 sc1
    v_mfma_f32_16x16x32_bf16 v[122:125], v[170:173], v[98:101], v[122:125]
    ds_read_b64_tr_b16 v[162:163], v34 offset:36928
    ds_read_b64_tr_b16 v[190:191], v199 offset:36864
    v_mfma_f32_16x16x32_bf16 v[126:129], v[170:173], v[102:105], v[126:129]
    ds_read_b64_tr_b16 v[164:165], v34 offset:40000
    ds_read_b64_tr_b16 v[192:193], v199 offset:39936
    s_waitcnt lgkmcnt(10)
    v_mfma_f32_16x16x32_bf16 v[130:133], v[174:177], v[98:101], v[130:133]
    ds_read_b64_tr_b16 v[166:167], v35 offset:36928
    buffer_load_dwordx4 v[210:213], v1, s[40:43], s66 offen offset:0 sc1
    v_mfma_f32_16x16x32_bf16 v[134:137], v[174:177], v[102:105], v[134:137]
    ds_read_b64_tr_b16 v[168:169], v35 offset:40000
    ds_read_b64_tr_b16 v[194:195], v200 offset:36864
    v_mfma_f32_16x16x32_bf16 v[138:141], v[178:181], v[98:101], v[138:141]
    ds_read_b64_tr_b16 v[170:171], v34 offset:36992
    ds_read_b64_tr_b16 v[196:197], v200 offset:39936
    v_mfma_f32_16x16x32_bf16 v[142:145], v[178:181], v[102:105], v[142:145]
    ds_read_b64_tr_b16 v[172:173], v34 offset:40064
    buffer_load_dwordx4 v[214:217], v1, s[40:43], s66 offen offset:1024 sc1
    v_mfma_f32_16x16x32_bf16 v[146:149], v[182:185], v[98:101], v[146:149]
    ds_read_b64_tr_b16 v[174:175], v35 offset:36992
    v_mfma_f32_16x16x32_bf16 v[150:153], v[182:185], v[102:105], v[150:153]
    ds_read_b64_tr_b16 v[176:177], v35 offset:40064
    s_waitcnt vmcnt(13) lgkmcnt(9)
    v_mfma_f32_16x16x32_bf16 v[106:109], v[154:157], v[42:45], v[106:109]
    ds_read_b64_tr_b16 v[178:179], v34 offset:43008
    s_add_u32 m0, s63, 98304
    s_add_u32 s80, s83, 1056768
    buffer_load_dwordx4 v12, s[20:23], s80 offen offset:0  lds
    v_mfma_f32_16x16x32_bf16 v[110:113], v[154:157], v[46:49], v[110:113]
    ds_read_b64_tr_b16 v[180:181], v34 offset:46080
    v_mfma_f32_16x16x32_bf16 v[114:117], v[158:161], v[42:45], v[114:117]
    ds_read_b64_tr_b16 v[182:183], v35 offset:43008
    v_mfma_f32_16x16x32_bf16 v[118:121], v[158:161], v[46:49], v[118:121]
    ds_read_b64_tr_b16 v[184:185], v35 offset:46080
    buffer_load_dwordx4 v13, s[20:23], s80 offen offset:1024  lds
    v_mfma_f32_16x16x32_bf16 v[122:125], v[162:165], v[42:45], v[122:125]
    ds_read_b64_tr_b16 v[154:155], v34 offset:43072
    v_mfma_f32_16x16x32_bf16 v[126:129], v[162:165], v[46:49], v[126:129]
    ds_read_b64_tr_b16 v[156:157], v34 offset:46144
    s_waitcnt lgkmcnt(9)
    v_mfma_f32_16x16x32_bf16 a[208:211], v[16:19], v[186:189], a[208:211]
    buffer_load_dwordx4 v14, s[20:23], s80 offen offset:2048  lds
    v_mfma_f32_16x16x32_bf16 a[212:215], v[16:19], v[190:193], a[212:215]
    v_mfma_f32_16x16x32_bf16 a[216:219], v[16:19], v[194:197], a[216:219]
    s_waitcnt lgkmcnt(6)
    v_mfma_f32_16x16x32_bf16 v[130:133], v[166:169], v[42:45], v[130:133]
    ds_read_b64_tr_b16 v[158:159], v35 offset:43072
    buffer_load_dwordx4 v[82:85], v1, s[40:43], s64 offen offset:1024 sc1
    v_mfma_f32_16x16x32_bf16 v[134:137], v[166:169], v[46:49], v[134:137]
    ds_read_b64_tr_b16 v[160:161], v35 offset:46144
    v_mfma_f32_16x16x32_bf16 v[138:141], v[170:173], v[42:45], v[138:141]
    ds_read_b64_tr_b16 v[162:163], v34 offset:43136
    v_mfma_f32_16x16x32_bf16 v[142:145], v[170:173], v[46:49], v[142:145]
    ds_read_b64_tr_b16 v[164:165], v34 offset:46208
    buffer_load_dwordx4 v[86:89], v1, s[40:43], s65 offen offset:1024 sc1
    v_mfma_f32_16x16x32_bf16 v[146:149], v[174:177], v[42:45], v[146:149]
    ds_read_b64_tr_b16 v[166:167], v35 offset:43136
    v_mfma_f32_16x16x32_bf16 v[150:153], v[174:177], v[46:49], v[150:153]
    ds_read_b64_tr_b16 v[168:169], v35 offset:46208
    s_waitcnt vmcnt(11)
    s_barrier
    s_waitcnt lgkmcnt(6)
    v_mfma_f32_16x16x32_bf16 v[106:109], v[178:181], v[50:53], v[106:109]
    ds_read_b64_tr_b16 v[170:171], v34 offset:49152
    buffer_load_dwordx4 v[90:93], v1, s[40:43], s64 offen offset:2048 sc1
    v_mfma_f32_16x16x32_bf16 v[110:113], v[178:181], v[54:57], v[110:113]
    ds_read_b64_tr_b16 v[172:173], v34 offset:52224
    ds_read_b64_tr_b16 v[186:187], v198 offset:49152
    v_mfma_f32_16x16x32_bf16 v[114:117], v[182:185], v[50:53], v[114:117]
    ds_read_b64_tr_b16 v[174:175], v35 offset:49152
    ds_read_b64_tr_b16 v[188:189], v198 offset:52224
    v_mfma_f32_16x16x32_bf16 v[118:121], v[182:185], v[54:57], v[118:121]
    ds_read_b64_tr_b16 v[176:177], v35 offset:52224
    buffer_load_dwordx4 v[94:97], v1, s[40:43], s65 offen offset:2048 sc1
    v_mfma_f32_16x16x32_bf16 v[122:125], v[154:157], v[50:53], v[122:125]
    ds_read_b64_tr_b16 v[178:179], v34 offset:49216
    ds_read_b64_tr_b16 v[190:191], v199 offset:49152
    v_mfma_f32_16x16x32_bf16 v[126:129], v[154:157], v[54:57], v[126:129]
    ds_read_b64_tr_b16 v[180:181], v34 offset:52288
    ds_read_b64_tr_b16 v[192:193], v199 offset:52224
    s_waitcnt lgkmcnt(10)
    v_mfma_f32_16x16x32_bf16 v[130:133], v[158:161], v[50:53], v[130:133]
    ds_read_b64_tr_b16 v[182:183], v35 offset:49216
    s_add_u32 m0, s63, 110592
    s_add_u32 s80, s83, 1232896
    buffer_load_dwordx4 v12, s[20:23], s80 offen offset:0  lds
    v_mfma_f32_16x16x32_bf16 v[134:137], v[158:161], v[54:57], v[134:137]
    ds_read_b64_tr_b16 v[184:185], v35 offset:52288
    ds_read_b64_tr_b16 v[194:195], v200 offset:49152
    v_mfma_f32_16x16x32_bf16 v[138:141], v[162:165], v[50:53], v[138:141]
    ds_read_b64_tr_b16 v[154:155], v34 offset:49280
    ds_read_b64_tr_b16 v[196:197], v200 offset:52224
    v_mfma_f32_16x16x32_bf16 v[142:145], v[162:165], v[54:57], v[142:145]
    ds_read_b64_tr_b16 v[156:157], v34 offset:52352
    buffer_load_dwordx4 v13, s[20:23], s80 offen offset:1024  lds
    v_mfma_f32_16x16x32_bf16 v[146:149], v[166:169], v[50:53], v[146:149]
    ds_read_b64_tr_b16 v[158:159], v35 offset:49280
    v_mfma_f32_16x16x32_bf16 v[150:153], v[166:169], v[54:57], v[150:153]
    ds_read_b64_tr_b16 v[160:161], v35 offset:52352
    s_waitcnt lgkmcnt(9)
    v_mfma_f32_16x16x32_bf16 v[106:109], v[170:173], v[58:61], v[106:109]
    ds_read_b64_tr_b16 v[162:163], v34 offset:55296
    buffer_load_dwordx4 v14, s[20:23], s80 offen offset:2048  lds
    v_mfma_f32_16x16x32_bf16 v[110:113], v[170:173], v[62:65], v[110:113]
    ds_read_b64_tr_b16 v[164:165], v34 offset:58368
    s_waitcnt vmcnt(10)
    v_mfma_f32_16x16x32_bf16 v[114:117], v[174:177], v[58:61], v[114:117]
    ds_read_b64_tr_b16 v[166:167], v35 offset:55296
    v_add_f32_e64 v234, v210, v212
    v_mfma_f32_16x16x32_bf16 v[118:121], v[174:177], v[62:65], v[118:121]
    ds_read_b64_tr_b16 v[168:169], v35 offset:58368
    buffer_load_dwordx4 v[98:101], v1, s[40:43], s64 offen offset:3072 sc1
    v_mfma_f32_16x16x32_bf16 v[122:125], v[178:181], v[58:61], v[122:125]
    ds_read_b64_tr_b16 v[170:171], v34 offset:55360
    v_add_f32_e64 v235, v211, v213
    v_mfma_f32_16x16x32_bf16 v[126:129], v[178:181], v[62:65], v[126:129]
    ds_read_b64_tr_b16 v[172:173], v34 offset:58432
    v_add_f32 v236, v214, v216
    s_waitcnt lgkmcnt(9)
    v_mfma_f32_16x16x32_bf16 a[208:211], v[16:19], v[186:189], a[208:211]
    buffer_load_dwordx4 v[102:105], v1, s[40:43], s65 offen offset:3072 sc1
    v_mfma_f32_16x16x32_bf16 a[212:215], v[16:19], v[190:193], a[212:215]
    v_add_f32 v237, v215, v217
    v_permlane16_swap_b32 v234, v235
    v_mfma_f32_16x16x32_bf16 a[216:219], v[16:19], v[194:197], a[216:219]
    v_permlane16_swap_b32 v236, v237
    v_add_f32 v234, v234, v235
    s_waitcnt lgkmcnt(6)
    v_mfma_f32_16x16x32_bf16 v[130:133], v[182:185], v[58:61], v[130:133]
    ds_read_b64_tr_b16 v[174:175], v35 offset:55360
    v_add_f32 v236, v236, v237
    v_mfma_f32_16x16x32_bf16 v[134:137], v[182:185], v[62:65], v[134:137]
    ds_read_b64_tr_b16 v[176:177], v35 offset:58432
    v_permlane32_swap_b32 v234, v236
    v_mfma_f32_16x16x32_bf16 v[138:141], v[154:157], v[58:61], v[138:141]
    ds_read_b64_tr_b16 v[178:179], v34 offset:55424
    v_add_f32 v234, v234, v236
    v_mfma_f32_16x16x32_bf16 v[142:145], v[154:157], v[62:65], v[142:145]
    ds_read_b64_tr_b16 v[180:181], v34 offset:58496
    v_mul_f32_e64 v235, -s84, v234
    v_mfma_f32_16x16x32_bf16 v[146:149], v[158:161], v[58:61], v[146:149]
    ds_read_b64_tr_b16 v[182:183], v35 offset:55424
    v_mul_f32_e64 v210, -s84, v234
    v_mfma_f32_16x16x32_bf16 v[150:153], v[158:161], v[62:65], v[150:153]
    ds_read_b64_tr_b16 v[184:185], v35 offset:58496
    v_permlane16_swap_b32 v235, v210
    s_waitcnt vmcnt(9)
    s_barrier
    s_waitcnt lgkmcnt(6)
    v_mfma_f32_16x16x32_bf16 v[106:109], v[162:165], v[66:69], v[106:109]
    ds_read_b64_tr_b16 v[154:155], v34 offset:0
    s_add_u32 m0, s96, 24576
    s_add_u32 s81, s97, 0
    buffer_load_dwordx4 v8, s[28:31], s81 offen offset:0  lds
    v_mfma_f32_16x16x32_bf16 v[110:113], v[162:165], v[70:73], v[110:113]
    ds_read_b64_tr_b16 v[156:157], v34 offset:3072
    ds_read_b64_tr_b16 v[186:187], v198 offset:0
    v_mfma_f32_16x16x32_bf16 v[114:117], v[166:169], v[66:69], v[114:117]
    ds_read_b64_tr_b16 v[158:159], v35 offset:0
    ds_read_b64_tr_b16 v[188:189], v198 offset:3072
    v_mfma_f32_16x16x32_bf16 v[118:121], v[166:169], v[70:73], v[118:121]
    ds_read_b64_tr_b16 v[160:161], v35 offset:3072
    buffer_load_dwordx4 v9, s[28:31], s81 offen offset:1024  lds
    v_mfma_f32_16x16x32_bf16 v[122:125], v[170:173], v[66:69], v[122:125]
    ds_read_b64_tr_b16 v[162:163], v34 offset:64
    ds_read_b64_tr_b16 v[190:191], v199 offset:0
    v_mfma_f32_16x16x32_bf16 v[126:129], v[170:173], v[70:73], v[126:129]
    ds_read_b64_tr_b16 v[164:165], v34 offset:3136
    ds_read_b64_tr_b16 v[192:193], v199 offset:3072
    s_waitcnt lgkmcnt(10)
    v_mfma_f32_16x16x32_bf16 v[130:133], v[174:177], v[66:69], v[130:133]
    ds_read_b64_tr_b16 v[166:167], v35 offset:64
    buffer_load_dwordx4 v10, s[28:31], s81 offen offset:2048  lds
    v_mfma_f32_16x16x32_bf16 v[134:137], v[174:177], v[70:73], v[134:137]
    ds_read_b64_tr_b16 v[168:169], v35 offset:3136
    ds_read_b64_tr_b16 v[194:195], v200 offset:0
    v_mfma_f32_16x16x32_bf16 v[138:141], v[178:181], v[66:69], v[138:141]
    ds_read_b64_tr_b16 v[170:171], v34 offset:128
    ds_read_b64_tr_b16 v[196:197], v200 offset:3072
    v_mfma_f32_16x16x32_bf16 v[142:145], v[178:181], v[70:73], v[142:145]
    ds_read_b64_tr_b16 v[172:173], v34 offset:3200
    buffer_load_dwordx4 v11, s[28:31], s81 offen offset:3072  lds
    v_mfma_f32_16x16x32_bf16 v[146:149], v[182:185], v[66:69], v[146:149]
    ds_read_b64_tr_b16 v[174:175], v35 offset:128
    v_fma_f32 v210, -v235, v235, -v210
    v_mfma_f32_16x16x32_bf16 v[150:153], v[182:185], v[70:73], v[150:153]
    ds_read_b64_tr_b16 v[176:177], v35 offset:3200
    v_max_f32 v210, 0, v210
    s_waitcnt lgkmcnt(9)
    v_mfma_f32_16x16x32_bf16 v[106:109], v[154:157], v[74:77], v[106:109]
    ds_read_b64_tr_b16 v[178:179], v34 offset:6144
    v_add_f32 v210, 0x3727c5ac, v210
    v_mfma_f32_16x16x32_bf16 v[110:113], v[154:157], v[78:81], v[110:113]
    ds_read_b64_tr_b16 v[180:181], v34 offset:9216
    v_mov_b32 v237, v235
    v_mfma_f32_16x16x32_bf16 v[114:117], v[158:161], v[74:77], v[114:117]
    ds_read_b64_tr_b16 v[182:183], v35 offset:6144
    v_rsq_f32 v234, v210
    v_mfma_f32_16x16x32_bf16 v[118:121], v[158:161], v[78:81], v[118:121]
    ds_read_b64_tr_b16 v[184:185], v35 offset:9216
    v_permlane32_swap_b32 v235, v237
    v_mfma_f32_16x16x32_bf16 v[122:125], v[162:165], v[74:77], v[122:125]
    ds_read_b64_tr_b16 v[154:155], v34 offset:6208
    v_mul_f32 v236, s98, v234
    v_mfma_f32_16x16x32_bf16 v[126:129], v[162:165], v[78:81], v[126:129]
    ds_read_b64_tr_b16 v[156:157], v34 offset:9280
    v_mul_f32 v234, s98, v234
    s_waitcnt lgkmcnt(9)
    v_mfma_f32_16x16x32_bf16 a[208:211], v[16:19], v[186:189], a[208:211]
    v_permlane32_swap_b32 v234, v236
    v_mfma_f32_16x16x32_bf16 a[212:215], v[16:19], v[190:193], a[212:215]
    v_mfma_f32_16x16x32_bf16 a[216:219], v[16:19], v[194:197], a[216:219]
    s_waitcnt lgkmcnt(6)
    v_mfma_f32_16x16x32_bf16 v[130:133], v[166:169], v[74:77], v[130:133]
    ds_read_b64_tr_b16 v[158:159], v35 offset:6208
    v_mfma_f32_16x16x32_bf16 v[134:137], v[166:169], v[78:81], v[134:137]
    ds_read_b64_tr_b16 v[160:161], v35 offset:9280
    v_mfma_f32_16x16x32_bf16 v[138:141], v[170:173], v[74:77], v[138:141]
    ds_read_b64_tr_b16 v[162:163], v34 offset:6272
    v_mfma_f32_16x16x32_bf16 v[142:145], v[170:173], v[78:81], v[142:145]
    ds_read_b64_tr_b16 v[164:165], v34 offset:9344
    v_mfma_f32_16x16x32_bf16 v[146:149], v[174:177], v[74:77], v[146:149]
    ds_read_b64_tr_b16 v[166:167], v35 offset:6272
    v_mfma_f32_16x16x32_bf16 v[150:153], v[174:177], v[78:81], v[150:153]
    ds_read_b64_tr_b16 v[168:169], v35 offset:9344
    s_waitcnt vmcnt(6)
    s_barrier
    s_waitcnt lgkmcnt(6)
    v_mfma_f32_16x16x32_bf16 v[106:109], v[178:181], v[82:85], v[106:109]
    ds_read_b64_tr_b16 v[170:171], v34 offset:12288
    s_add_u32 m0, s96, 40960
    s_add_u32 s81, s97, 32768
    buffer_load_dwordx4 v8, s[28:31], s81 offen offset:0  lds
    v_mfma_f32_16x16x32_bf16 v[110:113], v[178:181], v[86:89], v[110:113]
    ds_read_b64_tr_b16 v[172:173], v34 offset:15360
    ds_read_b64_tr_b16 v[186:187], v198 offset:12288
    v_mfma_f32_16x16x32_bf16 v[114:117], v[182:185], v[82:85], v[114:117]
    ds_read_b64_tr_b16 v[174:175], v35 offset:12288
    ds_read_b64_tr_b16 v[188:189], v198 offset:15360
    v_mfma_f32_16x16x32_bf16 v[118:121], v[182:185], v[86:89], v[118:121]
    ds_read_b64_tr_b16 v[176:177], v35 offset:15360
    buffer_load_dwordx4 v9, s[28:31], s81 offen offset:1024  lds
    v_mfma_f32_16x16x32_bf16 v[122:125], v[154:157], v[82:85], v[122:125]
    ds_read_b64_tr_b16 v[178:179], v34 offset:12352
    ds_read_b64_tr_b16 v[190:191], v199 offset:12288
    v_mfma_f32_16x16x32_bf16 v[126:129], v[154:157], v[86:89], v[126:129]
    ds_read_b64_tr_b16 v[180:181], v34 offset:15424
    ds_read_b64_tr_b16 v[192:193], v199 offset:15360
    s_waitcnt lgkmcnt(10)
    v_mfma_f32_16x16x32_bf16 v[130:133], v[158:161], v[82:85], v[130:133]
    ds_read_b64_tr_b16 v[182:183], v35 offset:12352
    buffer_load_dwordx4 v10, s[28:31], s81 offen offset:2048  lds
    v_mfma_f32_16x16x32_bf16 v[134:137], v[158:161], v[86:89], v[134:137]
    ds_read_b64_tr_b16 v[184:185], v35 offset:15424
    ds_read_b64_tr_b16 v[194:195], v200 offset:12288
    v_mfma_f32_16x16x32_bf16 v[138:141], v[162:165], v[82:85], v[138:141]
    ds_read_b64_tr_b16 v[154:155], v34 offset:12416
    ds_read_b64_tr_b16 v[196:197], v200 offset:15360
    v_mfma_f32_16x16x32_bf16 v[142:145], v[162:165], v[86:89], v[142:145]
    ds_read_b64_tr_b16 v[156:157], v34 offset:15488
    buffer_load_dwordx4 v11, s[28:31], s81 offen offset:3072  lds
    v_mfma_f32_16x16x32_bf16 v[146:149], v[166:169], v[82:85], v[146:149]
    ds_read_b64_tr_b16 v[158:159], v35 offset:12416
    v_mfma_f32_16x16x32_bf16 v[150:153], v[166:169], v[86:89], v[150:153]
    ds_read_b64_tr_b16 v[160:161], v35 offset:15488
    s_waitcnt lgkmcnt(3)
    v_mfma_f32_16x16x32_bf16 a[208:211], v[16:19], v[186:189], a[208:211]
    v_lshlrev_b32 v40, 7, v0
    s_lshl_b32 s76, s46, 2
    s_add_u32 s76, s76, s44
    s_lshr_b32 s77, s76, 3
    s_mul_i32 s77, s77, 45056
    s_add_u32 s77, s77, s49
    s_and_b32 s78, s76, 7
    s_mul_i32 s79, s78, 3456
    s_add_u32 s79, s79, s77
    s_add_u32 s79, s79, 180224
    s_mov_b64 exec, 0x7ffffff
    buffer_load_dword a223, v40, s[40:43], s79 offen sc1
    s_mov_b64 exec, -1
    v_mfma_f32_16x16x32_bf16 a[212:215], v[16:19], v[190:193], a[212:215]
    v_mfma_f32_16x16x32_bf16 a[216:219], v[16:19], v[194:197], a[216:219]
    v_mfma_f32_16x16x32_bf16 v[106:109], v[170:173], v[90:93], v[106:109]
    ds_read_b64_tr_b16 v[162:163], v34 offset:18432
    ds_read_b128 v[210:213], v41 offset:512
    v_mfma_f32_16x16x32_bf16 v[110:113], v[170:173], v[94:97], v[110:113]
    ds_read_b64_tr_b16 v[164:165], v34 offset:21504
    ds_read_b128 v[214:217], v41 offset:576
    v_mfma_f32_16x16x32_bf16 v[114:117], v[174:177], v[90:93], v[114:117]
    ds_read_b64_tr_b16 v[166:167], v35 offset:18432
    ds_read_b128 v[218:221], v41 offset:640
    v_mfma_f32_16x16x32_bf16 v[118:121], v[174:177], v[94:97], v[118:121]
    ds_read_b64_tr_b16 v[168:169], v35 offset:21504
    ds_read_b128 v[222:225], v41 offset:704
    v_mfma_f32_16x16x32_bf16 v[122:125], v[178:181], v[90:93], v[122:125]
    ds_read_b64_tr_b16 v[170:171], v34 offset:18496
    ds_read_b128 v[226:229], v41 offset:768
    v_mfma_f32_16x16x32_bf16 v[126:129], v[178:181], v[94:97], v[126:129]
    ds_read_b64_tr_b16 v[172:173], v34 offset:21568
    ds_read_b128 v[230:233], v41 offset:832
    s_waitcnt lgkmcnt(12)
    v_mfma_f32_16x16x32_bf16 v[130:133], v[182:185], v[90:93], v[130:133]
    ds_read_b64_tr_b16 v[174:175], v35 offset:18496
    v_accvgpr_read_b32 v37, a208
    v_mfma_f32_16x16x32_bf16 v[134:137], v[182:185], v[94:97], v[134:137]
    ds_read_b64_tr_b16 v[176:177], v35 offset:21568
    v_accvgpr_read_b32 v38, a212
    v_mfma_f32_16x16x32_bf16 v[138:141], v[154:157], v[90:93], v[138:141]
    ds_read_b64_tr_b16 v[178:179], v34 offset:18560
    v_accvgpr_read_b32 v39, a216
    v_mfma_f32_16x16x32_bf16 v[142:145], v[154:157], v[94:97], v[142:145]
    ds_read_b64_tr_b16 v[180:181], v34 offset:21632
    s_mul_i32 s68, s44, 192
    v_mfma_f32_16x16x32_bf16 v[146:149], v[158:161], v[90:93], v[146:149]
    ds_read_b64_tr_b16 v[182:183], v35 offset:18560
    s_add_u32 s68, s68, 161792
    v_mfma_f32_16x16x32_bf16 v[150:153], v[158:161], v[94:97], v[150:153]
    ds_read_b64_tr_b16 v[184:185], v35 offset:21632
    v_add_u32_e64 v36, s68, v15
    ds_write2_b32 v36, v37, v38 offset0:0 offset1:16
    ds_write_b32 v36, v39 offset:128
    s_waitcnt lgkmcnt(0)
    s_barrier
    s_waitcnt vmcnt(9)
    v_mfma_f32_16x16x32_bf16 v[106:109], v[162:165], v[98:101], v[106:109]
    v_lshlrev_b32 v42, 2, v0
    s_add_u32 m0, s96, 0
    s_add_u32 s81, s97, 98304
    buffer_load_dwordx4 v8, s[28:31], s81 offen offset:0  lds
    v_mfma_f32_16x16x32_bf16 v[110:113], v[162:165], v[102:105], v[110:113]
    v_add_u32 v42, 161792, v42
    ds_read2_b32 v[44:45], v42 offset0:0 offset1:64
    v_mfma_f32_16x16x32_bf16 v[114:117], v[166:169], v[98:101], v[114:117]
    ds_read2_b32 v[46:47], v42 offset0:96 offset1:160
    v_add_u32 v42, -2048, v42
    v_mfma_f32_16x16x32_bf16 v[118:121], v[166:169], v[102:105], v[118:121]
    buffer_load_dwordx4 v9, s[28:31], s81 offen offset:1024  lds
    v_mfma_f32_16x16x32_bf16 v[122:125], v[170:173], v[98:101], v[122:125]
    v_mfma_f32_16x16x32_bf16 v[126:129], v[170:173], v[102:105], v[126:129]
    v_mfma_f32_16x16x32_bf16 v[130:133], v[174:177], v[98:101], v[130:133]
    s_waitcnt lgkmcnt(0)
    buffer_load_dwordx4 v10, s[28:31], s81 offen offset:2048  lds
    v_mfma_f32_16x16x32_bf16 v[134:137], v[174:177], v[102:105], v[134:137]
    v_add_f32 v44, v44, v46
    v_add_f32 v45, v45, v47
    v_mfma_f32_16x16x32_bf16 v[138:141], v[178:181], v[98:101], v[138:141]
    ds_write2_b32 v42, v44, v45 offset0:0 offset1:64
    ds_read_b128 v[186:189], v41 offset:0
    v_mfma_f32_16x16x32_bf16 v[142:145], v[178:181], v[102:105], v[142:145]
    ds_read_b128 v[190:193], v41 offset:64
    buffer_load_dwordx4 v11, s[28:31], s81 offen offset:3072  lds
    v_mfma_f32_16x16x32_bf16 v[146:149], v[182:185], v[98:101], v[146:149]
    ds_read_b128 v[194:197], v41 offset:128
    ds_read_b128 v[198:201], v41 offset:192
    v_mfma_f32_16x16x32_bf16 v[150:153], v[182:185], v[102:105], v[150:153]
    ds_read_b128 v[202:205], v41 offset:256
    ds_read_b128 v[206:209], v41 offset:320
    s_waitcnt lgkmcnt(0)
    v_pk_fma_f32 v[138:139], v[202:203], v[234:235], v[138:139] op_sel:[0,1,0] op_sel_hi:[1,1,1]
    v_pk_fma_f32 v[138:139], v[138:139], v[234:235], v[226:227] op_sel_hi:[1,0,1]
    v_pk_fma_f32 v[140:141], v[204:205], v[234:235], v[140:141] op_sel:[0,1,0] op_sel_hi:[1,1,1]
    v_exp_f32 v82, v138
    v_pk_fma_f32 v[140:141], v[140:141], v[234:235], v[228:229] op_sel_hi:[1,0,1]
    v_exp_f32 v83, v139
    v_pk_fma_f32 v[146:147], v[206:207], v[234:235], v[146:147] op_sel:[0,1,0] op_sel_hi:[1,1,1]
    v_exp_f32 v84, v140
    v_pk_fma_f32 v[94:95], v[82:83], 0.5, 1.0 op_sel_hi:[1,0,0]
    v_pk_fma_f32 v[146:147], v[146:147], v[234:235], v[230:231] op_sel_hi:[1,0,1]
    v_exp_f32_e64 v85, v141
    v_pk_fma_f32 v[82:83], v[82:83], v[94:95], 1.0 op_sel_hi:[1,1,0]
    v_pk_fma_f32 v[148:149], v[208:209], v[234:235], v[148:149] op_sel:[0,1,0] op_sel_hi:[1,1,1]
    v_exp_f32 v86, v146
    v_pk_fma_f32 v[96:97], v[84:85], 0.5, 1.0 op_sel_hi:[1,0,0]
    v_rcp_f32 v82, v82
    v_pk_fma_f32 v[148:149], v[148:149], v[234:235], v[232:233] op_sel_hi:[1,0,1]
    v_exp_f32 v87, v147
    v_pk_fma_f32 v[84:85], v[84:85], v[96:97], 1.0 op_sel_hi:[1,1,0]
    v_rcp_f32 v83, v83
    s_waitcnt vmcnt(9)
    ds_read_b64_tr_b16 a[64:65], v6 offset:24576
    ds_read_b64_tr_b16 a[68:69], v7 offset:24576
    ds_read_b64_tr_b16 a[72:73], v6 offset:25088
    ds_read_b64_tr_b16 a[76:77], v7 offset:25088
    ds_read_b64_tr_b16 a[66:67], v6 offset:26624
    ds_read_b64_tr_b16 a[70:71], v7 offset:26624
    ds_read_b64_tr_b16 a[74:75], v6 offset:27136
    ds_read_b64_tr_b16 a[78:79], v7 offset:27136
    v_pk_fma_f32 v[142:143], v[202:203], v[236:237], v[142:143] op_sel:[0,1,0] op_sel_hi:[1,1,1]
    v_exp_f32 v88, v148
    v_pk_fma_f32 v[98:99], v[86:87], 0.5, 1.0 op_sel_hi:[1,0,0]
    v_rcp_f32 v84, v84
    v_pk_fma_f32 v[138:139], v[138:139], v[82:83], v[138:139] neg_lo:[1,0,0] neg_hi:[1,0,0]
    v_pk_fma_f32 v[142:143], v[142:143], v[236:237], v[226:227] op_sel_hi:[1,0,1]
    v_exp_f32 v89, v149
    v_pk_fma_f32 v[86:87], v[86:87], v[98:99], 1.0 op_sel_hi:[1,1,0]
    v_rcp_f32 v85, v85
    v_cvt_pk_bf16_f32 v162, v138, v139
    s_waitcnt lgkmcnt(0)
    s_add_u32 m0, s96, 24576
    s_add_u32 s81, s97, 131072
    buffer_load_dwordx4 v8, s[28:31], s81 offen offset:0  lds
    v_pk_fma_f32 v[144:145], v[204:205], v[236:237], v[144:145] op_sel:[0,1,0] op_sel_hi:[1,1,1]
    v_exp_f32_e64 v90, v142
    v_pk_fma_f32 v[100:101], v[88:89], 0.5, 1.0 op_sel_hi:[1,0,0]
    v_rcp_f32 v86, v86
    v_pk_fma_f32 v[140:141], v[140:141], v[84:85], v[140:141] neg_lo:[1,0,0] neg_hi:[1,0,0]
    v_pk_fma_f32 v[144:145], v[144:145], v[236:237], v[228:229] op_sel_hi:[1,0,1]
    v_exp_f32 v91, v143
    v_pk_fma_f32 v[88:89], v[88:89], v[100:101], 1.0 op_sel_hi:[1,1,0]
    v_rcp_f32_e64 v87, v87
    v_cvt_pk_bf16_f32 v163, v140, v141
    buffer_load_dwordx4 v9, s[28:31], s81 offen offset:1024  lds
    v_pk_fma_f32 v[150:151], v[206:207], v[236:237], v[150:151] op_sel:[0,1,0] op_sel_hi:[1,1,1]
    v_exp_f32 v92, v144
    v_pk_fma_f32 v[102:103], v[90:91], 0.5, 1.0 op_sel_hi:[1,0,0]
    v_rcp_f32 v88, v88
    v_pk_fma_f32 v[146:147], v[146:147], v[86:87], v[146:147] neg_lo:[1,0,0] neg_hi:[1,0,0]
    v_pk_fma_f32 v[150:151], v[150:151], v[236:237], v[230:231] op_sel_hi:[1,0,1]
    v_exp_f32 v93, v145
    v_pk_fma_f32 v[90:91], v[90:91], v[102:103], 1.0 op_sel_hi:[1,1,0]
    v_rcp_f32 v89, v89
    v_cvt_pk_bf16_f32 v164, v146, v147
    buffer_load_dwordx4 v10, s[28:31], s81 offen offset:2048  lds
    v_pk_fma_f32 v[152:153], v[208:209], v[236:237], v[152:153] op_sel:[0,1,0] op_sel_hi:[1,1,1]
    v_exp_f32 v82, v150
    v_pk_fma_f32 v[104:105], v[92:93], 0.5, 1.0 op_sel_hi:[1,0,0]
    v_rcp_f32 v90, v90
    v_pk_fma_f32 v[148:149], v[148:149], v[88:89], v[148:149] neg_lo:[1,0,0] neg_hi:[1,0,0]
    v_pk_fma_f32 v[152:153], v[152:153], v[236:237], v[232:233] op_sel_hi:[1,0,1]
    v_exp_f32 v83, v151
    v_pk_fma_f32 v[92:93], v[92:93], v[104:105], 1.0 op_sel_hi:[1,1,0]
    v_rcp_f32 v91, v91
    v_cvt_pk_bf16_f32 v165, v148, v149
    buffer_load_dwordx4 v11, s[28:31], s81 offen offset:3072  lds
    s_cmp_lg_u32 s53, 0
    s_cbranch_scc1 L_slow_30
    buffer_store_dwordx4 v[162:165], v1, s[40:43], s72 offen offset:2048
L_st_31:
    v_exp_f32 v84, v152
    v_pk_fma_f32 v[94:95], v[82:83], 0.5, 1.0 op_sel_hi:[1,0,0]
    v_rcp_f32 v92, v92
    v_pk_fma_f32 v[142:143], v[142:143], v[90:91], v[142:143] neg_lo:[1,0,0] neg_hi:[1,0,0]
    v_exp_f32_e64 v85, v153
    v_pk_fma_f32 v[82:83], v[82:83], v[94:95], 1.0 op_sel_hi:[1,1,0]
    v_rcp_f32 v93, v93
    v_cvt_pk_bf16_f32 v174, v142, v143
    v_pk_fma_f32 v[96:97], v[84:85], 0.5, 1.0 op_sel_hi:[1,0,0]
    v_rcp_f32 v82, v82
    v_pk_fma_f32 v[144:145], v[144:145], v[92:93], v[144:145] neg_lo:[1,0,0] neg_hi:[1,0,0]
    v_pk_fma_f32 v[84:85], v[84:85], v[96:97], 1.0 op_sel_hi:[1,1,0]
    v_rcp_f32 v83, v83
    v_cvt_pk_bf16_f32 v175, v144, v145
    s_waitcnt vmcnt(10)
    ds_read_b64_tr_b16 a[80:81], v6 offset:40960
    ds_read_b64_tr_b16 a[84:85], v7 offset:40960
    ds_read_b64_tr_b16 a[88:89], v6 offset:41472
    ds_read_b64_tr_b16 a[92:93], v7 offset:41472
    ds_read_b64_tr_b16 a[82:83], v6 offset:43008
    ds_read_b64_tr_b16 a[86:87], v7 offset:43008
    ds_read_b64_tr_b16 a[90:91], v6 offset:43520
    ds_read_b64_tr_b16 a[94:95], v7 offset:43520
    v_rcp_f32 v84, v84
    v_pk_fma_f32 v[150:151], v[150:151], v[82:83], v[150:151] neg_lo:[1,0,0] neg_hi:[1,0,0]
    v_rcp_f32 v85, v85
    v_cvt_pk_bf16_f32 v176, v150, v151
    v_pk_fma_f32 v[152:153], v[152:153], v[84:85], v[152:153] neg_lo:[1,0,0] neg_hi:[1,0,0]
    v_pk_fma_f32 v[106:107], v[186:187], v[234:235], v[106:107] op_sel:[0,1,0] op_sel_hi:[1,1,1]
    v_cvt_pk_bf16_f32 v177, v152, v153
    v_pk_fma_f32 v[106:107], v[106:107], v[234:235], v[210:211] op_sel_hi:[1,0,1]
    s_cmp_lg_u32 s53, 0
    s_cbranch_scc1 L_slow_32
    buffer_store_dwordx4 v[174:177], v1, s[40:43], s73 offen offset:2048
L_st_33:
    v_pk_fma_f32 v[108:109], v[188:189], v[234:235], v[108:109] op_sel:[0,1,0] op_sel_hi:[1,1,1]
    v_exp_f32 v86, v106
    s_waitcnt lgkmcnt(0)
    s_add_u32 m0, s96, 40960
    s_add_u32 s81, s97, 196608
    buffer_load_dwordx4 v8, s[28:31], s81 offen offset:0  lds
    v_pk_fma_f32 v[108:109], v[108:109], v[234:235], v[212:213] op_sel_hi:[1,0,1]
    v_exp_f32_e64 v87, v107
    v_pk_fma_f32 v[114:115], v[190:191], v[234:235], v[114:115] op_sel:[0,1,0] op_sel_hi:[1,1,1]
    v_exp_f32 v88, v108
    v_pk_fma_f32 v[98:99], v[86:87], 0.5, 1.0 op_sel_hi:[1,0,0]
    v_pk_fma_f32 v[114:115], v[114:115], v[234:235], v[214:215] op_sel_hi:[1,0,1]
    v_exp_f32 v89, v109
    v_pk_fma_f32 v[86:87], v[86:87], v[98:99], 1.0 op_sel_hi:[1,1,0]
    v_pk_fma_f32 v[116:117], v[192:193], v[234:235], v[116:117] op_sel:[0,1,0] op_sel_hi:[1,1,1]
    v_exp_f32_e64 v90, v114
    buffer_load_dwordx4 v9, s[28:31], s81 offen offset:1024  lds
L_pg4:
    s_cbranch_execz L_pg8
    v_pk_fma_f32 v[100:101], v[88:89], 0.5, 1.0 op_sel_hi:[1,0,0]
    v_rcp_f32 v86, v86
    v_pk_fma_f32 v[116:117], v[116:117], v[234:235], v[216:217] op_sel_hi:[1,0,1]
    v_exp_f32_e64 v91, v115
    v_pk_fma_f32 v[88:89], v[88:89], v[100:101], 1.0 op_sel_hi:[1,1,0]
    v_rcp_f32 v87, v87
    v_pk_fma_f32 v[110:111], v[186:187], v[236:237], v[110:111] op_sel:[0,1,0] op_sel_hi:[1,1,1]
    v_exp_f32 v92, v116
    v_pk_fma_f32 v[102:103], v[90:91], 0.5, 1.0 op_sel_hi:[1,0,0]
    v_rcp_f32 v88, v88
    buffer_load_dwordx4 v10, s[28:31], s81 offen offset:2048  lds
    v_pk_fma_f32 v[106:107], v[106:107], v[86:87], v[106:107] neg_lo:[1,0,0] neg_hi:[1,0,0]
    v_pk_fma_f32 v[110:111], v[110:111], v[236:237], v[210:211] op_sel_hi:[1,0,1]
    v_exp_f32 v93, v117
    v_pk_fma_f32 v[90:91], v[90:91], v[102:103], 1.0 op_sel_hi:[1,1,0]
    v_rcp_f32 v89, v89
    v_cvt_pk_bf16_f32 v154, v106, v107
    buffer_load_dwordx4 v11, s[28:31], s81 offen offset:3072  lds
    s_waitcnt vmcnt(10)
    ds_read_b64_tr_b16 a[112:113], v6 offset:0
    ds_read_b64_tr_b16 a[116:117], v7 offset:0
    ds_read_b64_tr_b16 a[120:121], v6 offset:512
    ds_read_b64_tr_b16 a[124:125], v7 offset:512
    ds_read_b64_tr_b16 a[114:115], v6 offset:2048
    ds_read_b64_tr_b16 a[118:119], v7 offset:2048
    ds_read_b64_tr_b16 a[122:123], v6 offset:2560
    ds_read_b64_tr_b16 a[126:127], v7 offset:2560
    v_pk_fma_f32 v[112:113], v[188:189], v[236:237], v[112:113] op_sel:[0,1,0] op_sel_hi:[1,1,1]
    v_exp_f32 v82, v110
    v_pk_fma_f32 v[104:105], v[92:93], 0.5, 1.0 op_sel_hi:[1,0,0]
    v_rcp_f32 v90, v90
    v_pk_fma_f32 v[108:109], v[108:109], v[88:89], v[108:109] neg_lo:[1,0,0] neg_hi:[1,0,0]
    v_pk_fma_f32 v[112:113], v[112:113], v[236:237], v[212:213] op_sel_hi:[1,0,1]
    v_exp_f32 v83, v111
    v_pk_fma_f32 v[92:93], v[92:93], v[104:105], 1.0 op_sel_hi:[1,1,0]
    v_rcp_f32 v91, v91
    v_cvt_pk_bf16_f32 v155, v108, v109
    s_waitcnt lgkmcnt(0)
    s_add_u32 m0, s96, 0
    s_add_u32 s81, s97, 229376
    buffer_load_dwordx4 v8, s[28:31], s81 offen offset:0  lds
    v_pk_fma_f32 v[118:119], v[190:191], v[236:237], v[118:119] op_sel:[0,1,0] op_sel_hi:[1,1,1]
    v_exp_f32 v84, v112
    v_pk_fma_f32 v[94:95], v[82:83], 0.5, 1.0 op_sel_hi:[1,0,0]
    v_rcp_f32 v92, v92
    v_pk_fma_f32 v[114:115], v[114:115], v[90:91], v[114:115] neg_lo:[1,0,0] neg_hi:[1,0,0]
    v_pk_fma_f32 v[118:119], v[118:119], v[236:237], v[214:215] op_sel_hi:[1,0,1]
    v_exp_f32 v85, v113
    v_pk_fma_f32 v[82:83], v[82:83], v[94:95], 1.0 op_sel_hi:[1,1,0]
    v_rcp_f32 v93, v93
    v_cvt_pk_bf16_f32 v156, v114, v115
    buffer_load_dwordx4 v9, s[28:31], s81 offen offset:1024  lds
    v_pk_fma_f32 v[120:121], v[192:193], v[236:237], v[120:121] op_sel:[0,1,0] op_sel_hi:[1,1,1]
    v_exp_f32 v86, v118
    v_pk_fma_f32 v[96:97], v[84:85], 0.5, 1.0 op_sel_hi:[1,0,0]
    v_rcp_f32 v82, v82
    v_pk_fma_f32 v[116:117], v[116:117], v[92:93], v[116:117] neg_lo:[1,0,0] neg_hi:[1,0,0]
    v_pk_fma_f32 v[120:121], v[120:121], v[236:237], v[216:217] op_sel_hi:[1,0,1]
    v_exp_f32 v87, v119
    v_pk_fma_f32 v[84:85], v[84:85], v[96:97], 1.0 op_sel_hi:[1,1,0]
    v_rcp_f32 v83, v83
    v_cvt_pk_bf16_f32 v157, v116, v117
    buffer_load_dwordx4 v10, s[28:31], s81 offen offset:2048  lds
    s_cmp_lg_u32 s53, 0
    s_cbranch_scc1 L_slow_34
    buffer_store_dwordx4 v[154:157], v238, s[40:43], s72 offen offset:0
L_st_35:
    v_mov_b32 v36, 5
    s_waitcnt vmcnt(8)
    s_cmp_lg_u32 s53, 0
    s_cbranch_scc1 L_slow_36
    buffer_store_dword v36, v28, s[40:43], s54 offen
L_st_37:
    v_pk_fma_f32 v[122:123], v[194:195], v[234:235], v[122:123] op_sel:[0,1,0] op_sel_hi:[1,1,1]
    v_exp_f32_e64 v88, v120
    v_pk_fma_f32 v[98:99], v[86:87], 0.5, 1.0 op_sel_hi:[1,0,0]
    v_rcp_f32 v84, v84
    v_pk_fma_f32 v[110:111], v[110:111], v[82:83], v[110:111] neg_lo:[1,0,0] neg_hi:[1,0,0]
    v_pk_fma_f32 v[122:123], v[122:123], v[234:235], v[218:219] op_sel_hi:[1,0,1]
    v_exp_f32 v89, v121
    v_pk_fma_f32 v[86:87], v[86:87], v[98:99], 1.0 op_sel_hi:[1,1,0]
    v_rcp_f32_e64 v85, v85
    buffer_load_dwordx4 v11, s[28:31], s81 offen offset:3072  lds
    v_cvt_pk_bf16_f32 v166, v110, v111
    ds_read_b64_tr_b16 a[128:129], v6 offset:24576
    ds_read_b64_tr_b16 a[132:133], v7 offset:24576
    ds_read_b64_tr_b16 a[136:137], v6 offset:25088
    ds_read_b64_tr_b16 a[140:141], v7 offset:25088
    ds_read_b64_tr_b16 a[130:131], v6 offset:26624
    ds_read_b64_tr_b16 a[134:135], v7 offset:26624
    ds_read_b64_tr_b16 a[138:139], v6 offset:27136
    ds_read_b64_tr_b16 a[142:143], v7 offset:27136
    v_pk_fma_f32 v[124:125], v[196:197], v[234:235], v[124:125] op_sel:[0,1,0] op_sel_hi:[1,1,1]
    v_exp_f32 v90, v122
    v_pk_fma_f32 v[100:101], v[88:89], 0.5, 1.0 op_sel_hi:[1,0,0]
    v_rcp_f32 v86, v86
    v_pk_fma_f32 v[112:113], v[112:113], v[84:85], v[112:113] neg_lo:[1,0,0] neg_hi:[1,0,0]
    v_pk_fma_f32 v[124:125], v[124:125], v[234:235], v[220:221] op_sel_hi:[1,0,1]
    v_exp_f32 v91, v123
    v_pk_fma_f32 v[88:89], v[88:89], v[100:101], 1.0 op_sel_hi:[1,1,0]
    v_rcp_f32 v87, v87
    v_cvt_pk_bf16_f32 v167, v112, v113
    s_waitcnt lgkmcnt(0)
    s_add_u32 m0, s96, 24576
    s_add_u32 s81, s97, 294912
    buffer_load_dwordx4 v8, s[28:31], s81 offen offset:0  lds
    v_pk_fma_f32 v[130:131], v[198:199], v[234:235], v[130:131] op_sel:[0,1,0] op_sel_hi:[1,1,1]
    v_exp_f32 v92, v124
    v_pk_fma_f32 v[102:103], v[90:91], 0.5, 1.0 op_sel_hi:[1,0,0]
    v_rcp_f32_e64 v88, v88
    v_pk_fma_f32 v[118:119], v[118:119], v[86:87], v[118:119] neg_lo:[1,0,0] neg_hi:[1,0,0]
    v_pk_fma_f32 v[130:131], v[130:131], v[234:235], v[222:223] op_sel_hi:[1,0,1]
    v_exp_f32 v93, v125
    v_pk_fma_f32 v[90:91], v[90:91], v[102:103], 1.0 op_sel_hi:[1,1,0]
    v_rcp_f32 v89, v89
    v_cvt_pk_bf16_f32 v168, v118, v119
    buffer_load_dwordx4 v9, s[28:31], s81 offen offset:1024  lds
    v_pk_fma_f32 v[132:133], v[200:201], v[234:235], v[132:133] op_sel:[0,1,0] op_sel_hi:[1,1,1]
    v_exp_f32 v82, v130
    v_pk_fma_f32 v[104:105], v[92:93], 0.5, 1.0 op_sel_hi:[1,0,0]
    v_rcp_f32 v90, v90
    v_pk_fma_f32 v[120:121], v[120:121], v[88:89], v[120:121] neg_lo:[1,0,0] neg_hi:[1,0,0]
    v_pk_fma_f32 v[132:133], v[132:133], v[234:235], v[224:225] op_sel_hi:[1,0,1]
    v_exp_f32 v83, v131
    v_pk_fma_f32 v[92:93], v[92:93], v[104:105], 1.0 op_sel_hi:[1,1,0]
    v_rcp_f32 v91, v91
    v_cvt_pk_bf16_f32 v169, v120, v121
    buffer_load_dwordx4 v10, s[28:31], s81 offen offset:2048  lds
    s_cmp_lg_u32 s53, 0
    s_cbranch_scc1 L_slow_38
    buffer_store_dwordx4 v[166:169], v238, s[40:43], s73 offen offset:0
L_st_39:
    v_pk_fma_f32 v[126:127], v[194:195], v[236:237], v[126:127] op_sel:[0,1,0] op_sel_hi:[1,1,1]
    v_exp_f32 v84, v132
    v_pk_fma_f32 v[94:95], v[82:83], 0.5, 1.0 op_sel_hi:[1,0,0]
    v_rcp_f32 v92, v92
    v_pk_fma_f32 v[122:123], v[122:123], v[90:91], v[122:123] neg_lo:[1,0,0] neg_hi:[1,0,0]
    v_pk_fma_f32 v[126:127], v[126:127], v[236:237], v[218:219] op_sel_hi:[1,0,1]
    v_exp_f32 v85, v133
    v_pk_fma_f32 v[82:83], v[82:83], v[94:95], 1.0 op_sel_hi:[1,1,0]
    v_rcp_f32 v93, v93
    v_cvt_pk_bf16_f32 v158, v122, v123
    buffer_load_dwordx4 v11, s[28:31], s81 offen offset:3072  lds
    s_waitcnt vmcnt(11)
    ds_read_b64_tr_b16 a[160:161], v6 offset:40960
    ds_read_b64_tr_b16 a[164:165], v7 offset:40960
    ds_read_b64_tr_b16 a[168:169], v6 offset:41472
    ds_read_b64_tr_b16 a[172:173], v7 offset:41472
    ds_read_b64_tr_b16 a[162:163], v6 offset:43008
    ds_read_b64_tr_b16 a[166:167], v7 offset:43008
    ds_read_b64_tr_b16 a[170:171], v6 offset:43520
    ds_read_b64_tr_b16 a[174:175], v7 offset:43520
    v_pk_fma_f32 v[128:129], v[196:197], v[236:237], v[128:129] op_sel:[0,1,0] op_sel_hi:[1,1,1]
    v_exp_f32 v86, v126
    v_pk_fma_f32 v[96:97], v[84:85], 0.5, 1.0 op_sel_hi:[1,0,0]
    v_rcp_f32 v82, v82
    v_pk_fma_f32 v[124:125], v[124:125], v[92:93], v[124:125] neg_lo:[1,0,0] neg_hi:[1,0,0]
    v_pk_fma_f32 v[128:129], v[128:129], v[236:237], v[220:221] op_sel_hi:[1,0,1]
    v_exp_f32 v87, v127
    v_pk_fma_f32 v[84:85], v[84:85], v[96:97], 1.0 op_sel_hi:[1,1,0]
    v_rcp_f32 v83, v83
    v_cvt_pk_bf16_f32 v159, v124, v125
    v_pk_fma_f32 v[134:135], v[198:199], v[236:237], v[134:135] op_sel:[0,1,0] op_sel_hi:[1,1,1]
    v_exp_f32 v88, v128
    v_pk_fma_f32 v[98:99], v[86:87], 0.5, 1.0 op_sel_hi:[1,0,0]
    v_rcp_f32 v84, v84
    v_pk_fma_f32 v[130:131], v[130:131], v[82:83], v[130:131] neg_lo:[1,0,0] neg_hi:[1,0,0]
    v_pk_fma_f32 v[134:135], v[134:135], v[236:237], v[222:223] op_sel_hi:[1,0,1]
    v_exp_f32 v89, v129
    v_pk_fma_f32 v[86:87], v[86:87], v[98:99], 1.0 op_sel_hi:[1,1,0]
    v_rcp_f32 v85, v85
    v_cvt_pk_bf16_f32 v160, v130, v131
    s_mul_i32 s64, s44, 11264
    s_add_u32 s64, s64, s51
    s_add_u32 s65, s64, 4096
    s_add_u32 s66, s64, 8192
    buffer_load_dword v38, v30, s[40:43], s56 offen sc1
    v_pk_fma_f32 v[136:137], v[200:201], v[236:237], v[136:137] op_sel:[0,1,0] op_sel_hi:[1,1,1]
    v_exp_f32_e64 v90, v134
    v_pk_fma_f32 v[100:101], v[88:89], 0.5, 1.0 op_sel_hi:[1,0,0]
    v_rcp_f32 v86, v86
    v_pk_fma_f32 v[132:133], v[132:133], v[84:85], v[132:133] neg_lo:[1,0,0] neg_hi:[1,0,0]
    v_pk_fma_f32 v[136:137], v[136:137], v[236:237], v[224:225] op_sel_hi:[1,0,1]
    v_exp_f32 v91, v135
    v_pk_fma_f32 v[88:89], v[88:89], v[100:101], 1.0 op_sel_hi:[1,1,0]
    v_rcp_f32 v87, v87
    v_cvt_pk_bf16_f32 v161, v132, v133
    s_cmp_lg_u32 s53, 0
    s_cbranch_scc1 L_slow_40
    buffer_store_dwordx4 v[158:161], v239, s[40:43], s72 offen offset:1024
L_st_41:
    v_exp_f32 v92, v136
    v_pk_fma_f32 v[102:103], v[90:91], 0.5, 1.0 op_sel_hi:[1,0,0]
    v_rcp_f32 v88, v88
    v_pk_fma_f32 v[126:127], v[126:127], v[86:87], v[126:127] neg_lo:[1,0,0] neg_hi:[1,0,0]
    v_exp_f32 v93, v137
    v_pk_fma_f32 v[90:91], v[90:91], v[102:103], 1.0 op_sel_hi:[1,1,0]
    v_rcp_f32 v89, v89
    v_cvt_pk_bf16_f32 v170, v126, v127
    v_pk_fma_f32 v[104:105], v[92:93], 0.5, 1.0 op_sel_hi:[1,0,0]
    v_rcp_f32 v90, v90
    v_pk_fma_f32 v[128:129], v[128:129], v[88:89], v[128:129] neg_lo:[1,0,0] neg_hi:[1,0,0]
    v_pk_fma_f32 v[92:93], v[92:93], v[104:105], 1.0 op_sel_hi:[1,1,0]
    v_rcp_f32 v91, v91
    v_cvt_pk_bf16_f32 v171, v128, v129
    v_rcp_f32 v92, v92
    v_pk_fma_f32 v[134:135], v[134:135], v[90:91], v[134:135] neg_lo:[1,0,0] neg_hi:[1,0,0]
    v_rcp_f32_e64 v93, v93
    v_cvt_pk_bf16_f32 v172, v134, v135
    v_pk_fma_f32 v[136:137], v[136:137], v[92:93], v[136:137] neg_lo:[1,0,0] neg_hi:[1,0,0]
    v_cvt_pk_bf16_f32 v173, v136, v137
    s_cmp_lg_u32 s53, 0
    s_cbranch_scc1 L_slow_42
    buffer_store_dwordx4 v[170:173], v239, s[40:43], s73 offen offset:1024
L_st_43:
    s_waitcnt vmcnt(2)
    v_cmp_gt_u32 vcc, 5, v38
    s_cbranch_vccnz L_fb_45
L_ok_44:
    s_add_u32 s68, s8, s64
    buffer_load_dwordx4 v[42:45], v1, s[40:43], s68 offen offset:2048 sc1
    s_add_u32 s68, s8, s65
    buffer_load_dwordx4 v[46:49], v1, s[40:43], s68 offen offset:1024 sc1
    s_add_u32 s68, s8, s66
    buffer_load_dwordx4 v[50:53], v1, s[40:43], s68 offen offset:0 sc1
    buffer_load_dwordx4 v[54:57], v29, s[40:43], s68 offen offset:2048 sc1
    s_add_u32 s68, s9, s64
    buffer_load_dwordx4 v[58:61], v1, s[40:43], s68 offen offset:2048 sc1
    s_add_u32 s68, s9, s65
    buffer_load_dwordx4 v[62:65], v1, s[40:43], s68 offen offset:1024 sc1
    v_add_u32 v39, s12, v1
    v_add_u32 v40, s13, v1
    v_add_u32 v41, s14, v1
    v_permlane16_swap_b32 v20, v22
    v_permlane16_swap_b32 v21, v23
    v_permlane16_swap_b32 v24, v26
    v_permlane16_swap_b32 v25, v27
    v_lshlrev_b32 v224, 16, v20
    v_and_b32 v225, 0xffff0000, v20
    v_lshlrev_b32 v226, 16, v21
    v_and_b32 v227, 0xffff0000, v21
    v_lshlrev_b32 v228, 16, v22
    v_and_b32 v229, 0xffff0000, v22
    v_lshlrev_b32 v230, 16, v23
    v_and_b32 v231, 0xffff0000, v23
    v_lshlrev_b32 v232, 16, v24
    v_and_b32 v233, 0xffff0000, v24
    v_lshlrev_b32 v234, 16, v25
    v_and_b32 v235, 0xffff0000, v25
    v_lshlrev_b32 v236, 16, v26
    v_and_b32 v237, 0xffff0000, v26
    v_lshlrev_b32_e64 v238, 16, v27
    v_and_b32 v239, 0xffff0000, v27
    s_mov_b32 s50, s51
    s_add_u32 s51, s51, s52
    v_add_u32 v219, s61, v1
    s_lshl_b32 s69, s6, 14
    s_lshl_b32 s70, s48, 11
    s_add_u32 s69, s69, s70
    s_add_u32 s69, s69, s51
    s_lshl_b32 s70, s6, 10
    s_add_u32 s70, s70, s7
    s_add_u32 s70, s70, s51
    s_add_u32 s70, s70, 131072
    v_bfe_u32 v220, v0, 4, 1
    v_lshrrev_b32 v221, 5, v0
    v_lshl_or_b32 v220, v220, 1, v221
    v_lshlrev_b32 v221, 2, v15
    v_lshl_or_b32 v220, v220, 8, v221
    s_waitcnt lgkmcnt(0)
    s_waitcnt vmcnt(5)
    v_mov_b32 v36, 6
    s_cmp_lg_u32 s53, 0
    s_cbranch_scc1 L_slow_46
    buffer_store_dword v36, v28, s[40:43], s54 offen
L_st_47:
    v_mfma_f32_16x16x32_bf16 v[106:109], a[96:99], v[42:45], 0
    s_add_u32 s68, s9, s66
    buffer_load_dwordx4 v[66:69], v1, s[40:43], s68 offen offset:0 sc1
    v_mfma_f32_16x16x32_bf16 v[110:113], a[100:103], v[42:45], 0
    ds_read_b64_tr_b16 a[176:177], v6 offset:0
    v_mfma_f32_16x16x32_bf16 v[114:117], a[104:107], v[42:45], 0
    ds_read_b64_tr_b16 a[180:181], v7 offset:0
    ds_read_b64_tr_b16 a[184:185], v6 offset:512
    v_mfma_f32_16x16x32_bf16 v[118:121], a[108:111], v[42:45], 0
    ds_read_b64_tr_b16 a[188:189], v7 offset:512
    ds_read_b64_tr_b16 a[178:179], v6 offset:2048
    s_waitcnt vmcnt(6)
    v_mfma_f32_16x16x32_bf16 v[106:109], a[144:147], v[46:49], v[106:109]
    buffer_load_dwordx4 v[70:73], v29, s[40:43], s68 offen offset:2048 sc1
    v_mfma_f32_16x16x32_bf16 v[110:113], a[148:151], v[46:49], v[110:113]
    ds_read_b64_tr_b16 a[182:183], v7 offset:2048
    ds_read_b64_tr_b16 a[186:187], v6 offset:2560
    v_mfma_f32_16x16x32_bf16 v[114:117], a[152:155], v[46:49], v[114:117]
    ds_read_b64_tr_b16 a[190:191], v7 offset:2560
    v_mfma_f32_16x16x32_bf16 v[118:121], a[156:159], v[46:49], v[118:121]
    ds_read_b64_tr_b16 a[208:209], v6 offset:24576
    ds_read_b64_tr_b16 a[212:213], v7 offset:24576
    s_waitcnt vmcnt(6)
    v_mfma_f32_16x16x32_bf16 v[106:109], a[192:195], v[50:53], v[106:109]
    s_add_u32 s68, s10, s64
    buffer_load_dwordx4 v[74:77], v1, s[40:43], s68 offen offset:2048 sc1
    v_mfma_f32_16x16x32_bf16 v[110:113], a[196:199], v[50:53], v[110:113]
    ds_read_b64_tr_b16 a[216:217], v6 offset:25088
    ds_read_b64_tr_b16 a[220:221], v7 offset:25088
    v_mfma_f32_16x16x32_bf16 v[114:117], a[200:203], v[50:53], v[114:117]
    ds_read_b64_tr_b16 a[210:211], v6 offset:26624
    ds_read_b64_tr_b16 a[214:215], v7 offset:26624
    v_mfma_f32_16x16x32_bf16 v[118:121], a[204:207], v[50:53], v[118:121]
    ds_read_b64_tr_b16 a[218:219], v6 offset:27136
    ds_read_b64_tr_b16 a[222:223], v7 offset:27136
    s_waitcnt vmcnt(6)
    v_mfma_f32_16x16x32_bf16 v[106:109], a[224:227], v[54:57], v[106:109]
    s_add_u32 s68, s10, s65
    buffer_load_dwordx4 v[78:81], v1, s[40:43], s68 offen offset:1024 sc1
    v_mfma_f32_16x16x32_bf16 v[110:113], a[228:231], v[54:57], v[110:113]
    v_mfma_f32_16x16x32_bf16 v[114:117], a[232:235], v[54:57], v[114:117]
    v_mfma_f32_16x16x32_bf16 v[118:121], a[236:239], v[54:57], v[118:121]
    s_waitcnt vmcnt(6)
    v_mfma_f32_16x16x32_bf16 v[122:125], a[96:99], v[58:61], 0
    s_add_u32 s68, s10, s66
    buffer_load_dwordx4 v[82:85], v1, s[40:43], s68 offen offset:0 sc1
    v_mfma_f32_16x16x32_bf16 v[126:129], a[100:103], v[58:61], 0
    v_mfma_f32_16x16x32_bf16 v[130:133], a[104:107], v[58:61], 0
    v_mfma_f32_16x16x32_bf16 v[134:137], a[108:111], v[58:61], 0
    s_waitcnt vmcnt(6)
    v_mfma_f32_16x16x32_bf16 v[122:125], a[144:147], v[62:65], v[122:125]
    buffer_load_dwordx4 v[86:89], v29, s[40:43], s68 offen offset:2048 sc1
    v_mfma_f32_16x16x32_bf16 v[126:129], a[148:151], v[62:65], v[126:129]
    buffer_load_dword v38, v30, s[40:43], s56 offen sc1
    v_mfma_f32_16x16x32_bf16 v[130:133], a[152:155], v[62:65], v[130:133]
    v_mfma_f32_16x16x32_bf16 v[134:137], a[156:159], v[62:65], v[134:137]
    s_waitcnt vmcnt(6)
    v_mfma_f32_16x16x32_bf16 v[122:125], a[192:195], v[66:69], v[122:125]
    s_add_u32 s68, s11, s64
    buffer_load_dwordx4 v[90:93], v1, s[40:43], s68 offen offset:2048 sc1
    v_mfma_f32_16x16x32_bf16 v[126:129], a[196:199], v[66:69], v[126:129]
    v_mfma_f32_16x16x32_bf16 v[130:133], a[200:203], v[66:69], v[130:133]
    v_mfma_f32_16x16x32_bf16 v[134:137], a[204:207], v[66:69], v[134:137]
    s_waitcnt vmcnt(6)
    v_mfma_f32_16x16x32_bf16 v[122:125], a[224:227], v[70:73], v[122:125]
    s_add_u32 s68, s11, s65
    buffer_load_dwordx4 v[94:97], v1, s[40:43], s68 offen offset:1024 sc1
    v_mfma_f32_16x16x32_bf16 v[126:129], a[228:231], v[70:73], v[126:129]
    v_mfma_f32_16x16x32_bf16 v[130:133], a[232:235], v[70:73], v[130:133]
    v_mfma_f32_16x16x32_bf16 v[134:137], a[236:239], v[70:73], v[134:137]
    s_waitcnt vmcnt(6)
    v_mfma_f32_16x16x32_bf16 v[138:141], a[96:99], v[74:77], 0
    s_add_u32 s68, s11, s66
    buffer_load_dwordx4 v[98:101], v1, s[40:43], s68 offen offset:0 sc1
    v_mfma_f32_16x16x32_bf16 v[142:145], a[100:103], v[74:77], 0
    v_mfma_f32_16x16x32_bf16 v[146:149], a[104:107], v[74:77], 0
    v_mfma_f32_16x16x32_bf16 v[150:153], a[108:111], v[74:77], 0
    s_waitcnt vmcnt(6)
    v_mfma_f32_16x16x32_bf16 v[138:141], a[144:147], v[78:81], v[138:141]
    buffer_load_dwordx4 v[102:105], v29, s[40:43], s68 offen offset:2048 sc1
    v_mfma_f32_16x16x32_bf16 v[142:145], a[148:151], v[78:81], v[142:145]
    v_mfma_f32_16x16x32_bf16 v[146:149], a[152:155], v[78:81], v[146:149]
    v_mfma_f32_16x16x32_bf16 v[150:153], a[156:159], v[78:81], v[150:153]
    s_waitcnt vmcnt(6)
    v_mfma_f32_16x16x32_bf16 v[138:141], a[192:195], v[82:85], v[138:141]
    s_waitcnt vmcnt(4)
    v_cmp_gt_u32 vcc, 6, v38
    s_cbranch_vccnz L_fb_49
L_ok_48:
    s_add_u32 s68, s8, s64
    buffer_load_dwordx4 v[42:45], v1, s[40:43], s68 offen offset:0 sc1
    v_mfma_f32_16x16x32_bf16 v[142:145], a[196:199], v[82:85], v[142:145]
    v_mfma_f32_16x16x32_bf16 v[146:149], a[200:203], v[82:85], v[146:149]
    v_mfma_f32_16x16x32_bf16 v[150:153], a[204:207], v[82:85], v[150:153]
    v_mfma_f32_16x16x32_bf16 v[138:141], a[224:227], v[86:89], v[138:141]
    buffer_load_dwordx4 v[46:49], v1, s[40:43], s68 offen offset:1024 sc1
    v_mfma_f32_16x16x32_bf16 v[142:145], a[228:231], v[86:89], v[142:145]
    v_mfma_f32_16x16x32_bf16 v[146:149], a[232:235], v[86:89], v[146:149]
    v_mfma_f32_16x16x32_bf16 v[150:153], a[236:239], v[86:89], v[150:153]
    s_waitcnt vmcnt(5)
    v_mfma_f32_16x16x32_bf16 v[154:157], a[96:99], v[90:93], 0
    buffer_load_dwordx4 v[50:53], v1, s[40:43], s68 offen offset:3072 sc1
    v_mfma_f32_16x16x32_bf16 v[158:161], a[100:103], v[90:93], 0
    v_mfma_f32_16x16x32_bf16 v[162:165], a[104:107], v[90:93], 0
    v_mfma_f32_16x16x32_bf16 v[166:169], a[108:111], v[90:93], 0
    s_waitcnt vmcnt(5)
    v_mfma_f32_16x16x32_bf16 v[154:157], a[144:147], v[94:97], v[154:157]
    s_add_u32 s68, s8, s65
    buffer_load_dwordx4 v[54:57], v1, s[40:43], s68 offen offset:0 sc1
    v_mfma_f32_16x16x32_bf16 v[158:161], a[148:151], v[94:97], v[158:161]
    v_mfma_f32_16x16x32_bf16 v[162:165], a[152:155], v[94:97], v[162:165]
    v_mfma_f32_16x16x32_bf16 v[166:169], a[156:159], v[94:97], v[166:169]
    s_waitcnt vmcnt(5)
    v_mfma_f32_16x16x32_bf16 v[154:157], a[192:195], v[98:101], v[154:157]
    buffer_load_dwordx4 v[58:61], v1, s[40:43], s68 offen offset:2048 sc1
    v_mfma_f32_16x16x32_bf16 v[158:161], a[196:199], v[98:101], v[158:161]
    v_mfma_f32_16x16x32_bf16 v[162:165], a[200:203], v[98:101], v[162:165]
    v_mfma_f32_16x16x32_bf16 v[166:169], a[204:207], v[98:101], v[166:169]
    s_waitcnt vmcnt(5)
    v_mfma_f32_16x16x32_bf16 v[154:157], a[224:227], v[102:105], v[154:157]
    buffer_load_dwordx4 v[62:65], v1, s[40:43], s68 offen offset:3072 sc1
    v_mfma_f32_16x16x32_bf16 v[158:161], a[228:231], v[102:105], v[158:161]
    v_mfma_f32_16x16x32_bf16 v[162:165], a[232:235], v[102:105], v[162:165]
    v_mfma_f32_16x16x32_bf16 v[166:169], a[236:239], v[102:105], v[166:169]
    s_waitcnt lgkmcnt(0)
    s_waitcnt vmcnt(5)
    v_mfma_f32_16x16x32_bf16 v[106:109], a[64:67], v[42:45], v[106:109]
    s_add_u32 s68, s8, s66
    buffer_load_dwordx4 v[66:69], v1, s[40:43], s68 offen offset:1024 sc1
    v_mfma_f32_16x16x32_bf16 v[110:113], a[68:71], v[42:45], v[110:113]
    v_mfma_f32_16x16x32_bf16 v[114:117], a[72:75], v[42:45], v[114:117]
    v_mfma_f32_16x16x32_bf16 v[118:121], a[76:79], v[42:45], v[118:121]
    s_waitcnt vmcnt(5)
    v_mfma_f32_16x16x32_bf16 v[106:109], a[80:83], v[46:49], v[106:109]
    s_add_u32 s68, s9, s64
    buffer_load_dwordx4 v[70:73], v1, s[40:43], s68 offen offset:0 sc1
    v_mfma_f32_16x16x32_bf16 v[110:113], a[84:87], v[46:49], v[110:113]
    v_mfma_f32_16x16x32_bf16 v[114:117], a[88:91], v[46:49], v[114:117]
    v_mfma_f32_16x16x32_bf16 v[118:121], a[92:95], v[46:49], v[118:121]
    s_waitcnt vmcnt(5)
    v_mfma_f32_16x16x32_bf16 v[106:109], a[112:115], v[50:53], v[106:109]
    buffer_load_dwordx4 v[74:77], v1, s[40:43], s68 offen offset:1024 sc1
    v_mfma_f32_16x16x32_bf16 v[110:113], a[116:119], v[50:53], v[110:113]
    v_mfma_f32_16x16x32_bf16 v[114:117], a[120:123], v[50:53], v[114:117]
    v_mfma_f32_16x16x32_bf16 v[118:121], a[124:127], v[50:53], v[118:121]
    s_waitcnt vmcnt(5)
    v_mfma_f32_16x16x32_bf16 v[106:109], a[128:131], v[54:57], v[106:109]
    buffer_load_dwordx4 v[78:81], v1, s[40:43], s68 offen offset:3072 sc1
    v_mfma_f32_16x16x32_bf16 v[110:113], a[132:135], v[54:57], v[110:113]
    v_mfma_f32_16x16x32_bf16 v[114:117], a[136:139], v[54:57], v[114:117]
    v_mfma_f32_16x16x32_bf16 v[118:121], a[140:143], v[54:57], v[118:121]
    s_waitcnt vmcnt(5)
    v_mfma_f32_16x16x32_bf16 v[106:109], a[160:163], v[58:61], v[106:109]
    s_add_u32 s68, s9, s65
    buffer_load_dwordx4 v[82:85], v1, s[40:43], s68 offen offset:0 sc1
    v_mfma_f32_16x16x32_bf16 v[110:113], a[164:167], v[58:61], v[110:113]
    v_mfma_f32_16x16x32_bf16 v[114:117], a[168:171], v[58:61], v[114:117]
    v_mfma_f32_16x16x32_bf16 v[118:121], a[172:175], v[58:61], v[118:121]
    s_waitcnt vmcnt(5)
    v_mfma_f32_16x16x32_bf16 v[106:109], a[176:179], v[62:65], v[106:109]
    buffer_load_dwordx4 v[86:89], v1, s[40:43], s68 offen offset:2048 sc1
    v_mfma_f32_16x16x32_bf16 v[110:113], a[180:183], v[62:65], v[110:113]
    v_mfma_f32_16x16x32_bf16 v[114:117], a[184:187], v[62:65], v[114:117]
    v_mfma_f32_16x16x32_bf16 v[118:121], a[188:191], v[62:65], v[118:121]
    s_waitcnt vmcnt(5)
    v_mfma_f32_16x16x32_bf16 v[106:109], a[208:211], v[66:69], v[106:109]
    buffer_load_dwordx4 v[90:93], v1, s[40:43], s68 offen offset:3072 sc1
    v_mfma_f32_16x16x32_bf16 v[110:113], a[212:215], v[66:69], v[110:113]
    v_mfma_f32_16x16x32_bf16 v[114:117], a[216:219], v[66:69], v[114:117]
    v_mfma_f32_16x16x32_bf16 v[118:121], a[220:223], v[66:69], v[118:121]
    s_barrier
    s_waitcnt vmcnt(5)
    v_mfma_f32_16x16x32_bf16 v[122:125], a[64:67], v[70:73], v[122:125]
    s_add_u32 s68, s9, s66
    buffer_load_dwordx4 v[94:97], v1, s[40:43], s68 offen offset:1024 sc1
    v_mfma_f32_16x16x32_bf16 v[126:129], a[68:71], v[70:73], v[126:129]
    v_mfma_f32_16x16x32_bf16 v[130:133], a[72:75], v[70:73], v[130:133]
    v_mfma_f32_16x16x32_bf16 v[134:137], a[76:79], v[70:73], v[134:137]
    ds_write_b128 v39, v[106:109] offset:0
    s_waitcnt vmcnt(5)
    v_mfma_f32_16x16x32_bf16 v[122:125], a[80:83], v[74:77], v[122:125]
    s_add_u32 s68, s10, s64
    buffer_load_dwordx4 v[98:101], v1, s[40:43], s68 offen offset:0 sc1
    v_mfma_f32_16x16x32_bf16 v[126:129], a[84:87], v[74:77], v[126:129]
    v_mfma_f32_16x16x32_bf16 v[130:133], a[88:91], v[74:77], v[130:133]
    v_mfma_f32_16x16x32_bf16 v[134:137], a[92:95], v[74:77], v[134:137]
    ds_write_b128 v39, v[110:113] offset:1024
    s_waitcnt vmcnt(5)
    v_mfma_f32_16x16x32_bf16 v[122:125], a[112:115], v[78:81], v[122:125]
    buffer_load_dwordx4 v[102:105], v1, s[40:43], s68 offen offset:1024 sc1
    v_mfma_f32_16x16x32_bf16 v[126:129], a[116:119], v[78:81], v[126:129]
    v_mfma_f32_16x16x32_bf16 v[130:133], a[120:123], v[78:81], v[130:133]
    v_mfma_f32_16x16x32_bf16 v[134:137], a[124:127], v[78:81], v[134:137]
    ds_write_b128 v39, v[114:117] offset:2048
    s_waitcnt vmcnt(5)
    v_mfma_f32_16x16x32_bf16 v[122:125], a[128:131], v[82:85], v[122:125]
    buffer_load_dwordx4 v[42:45], v1, s[40:43], s68 offen offset:3072 sc1
    v_mfma_f32_16x16x32_bf16 v[126:129], a[132:135], v[82:85], v[126:129]
    v_mfma_f32_16x16x32_bf16 v[130:133], a[136:139], v[82:85], v[130:133]
    v_mfma_f32_16x16x32_bf16 v[134:137], a[140:143], v[82:85], v[134:137]
    ds_write_b128 v39, v[118:121] offset:3072
    s_waitcnt vmcnt(5)
    v_mfma_f32_16x16x32_bf16 v[122:125], a[160:163], v[86:89], v[122:125]
    s_add_u32 s68, s10, s65
    buffer_load_dwordx4 v[46:49], v1, s[40:43], s68 offen offset:0 sc1
    v_mfma_f32_16x16x32_bf16 v[126:129], a[164:167], v[86:89], v[126:129]
    v_mfma_f32_16x16x32_bf16 v[130:133], a[168:171], v[86:89], v[130:133]
    v_mfma_f32_16x16x32_bf16 v[134:137], a[172:175], v[86:89], v[134:137]
    s_waitcnt vmcnt(5)
    v_mfma_f32_16x16x32_bf16 v[122:125], a[176:179], v[90:93], v[122:125]
    buffer_load_dwordx4 v[50:53], v1, s[40:43], s68 offen offset:2048 sc1
    v_mfma_f32_16x16x32_bf16 v[126:129], a[180:183], v[90:93], v[126:129]
    v_mfma_f32_16x16x32_bf16 v[130:133], a[184:187], v[90:93], v[130:133]
    v_mfma_f32_16x16x32_bf16 v[134:137], a[188:191], v[90:93], v[134:137]
    s_waitcnt vmcnt(5)
    v_mfma_f32_16x16x32_bf16 v[122:125], a[208:211], v[94:97], v[122:125]
    buffer_load_dwordx4 v[54:57], v1, s[40:43], s68 offen offset:3072 sc1
    v_mfma_f32_16x16x32_bf16 v[126:129], a[212:215], v[94:97], v[126:129]
    v_mfma_f32_16x16x32_bf16 v[130:133], a[216:219], v[94:97], v[130:133]
    v_mfma_f32_16x16x32_bf16 v[134:137], a[220:223], v[94:97], v[134:137]
    s_waitcnt vmcnt(5)
    v_mfma_f32_16x16x32_bf16 v[138:141], a[64:67], v[98:101], v[138:141]
    s_add_u32 s68, s10, s66
    buffer_load_dwordx4 v[58:61], v1, s[40:43], s68 offen offset:1024 sc1
    v_mfma_f32_16x16x32_bf16 v[142:145], a[68:71], v[98:101], v[142:145]
    v_mfma_f32_16x16x32_bf16 v[146:149], a[72:75], v[98:101], v[146:149]
    v_mfma_f32_16x16x32_bf16 v[150:153], a[76:79], v[98:101], v[150:153]
    ds_write_b128 v40, v[122:125] offset:0
    s_waitcnt lgkmcnt(1)
    s_barrier
    s_waitcnt vmcnt(5)
    v_mfma_f32_16x16x32_bf16 v[138:141], a[80:83], v[102:105], v[138:141]
    s_add_u32 s68, s11, s64
    buffer_load_dwordx4 v[62:65], v1, s[40:43], s68 offen offset:0 sc1
    v_mfma_f32_16x16x32_bf16 v[142:145], a[84:87], v[102:105], v[142:145]
    ds_read_b128 v[170:173], v219 offset:0
    ds_read_b128 v[174:177], v219 offset:1024
    v_mfma_f32_16x16x32_bf16 v[146:149], a[88:91], v[102:105], v[146:149]
    ds_read_b128 v[178:181], v219 offset:2048
    ds_read_b128 v[182:185], v219 offset:3072
    v_mfma_f32_16x16x32_bf16 v[150:153], a[92:95], v[102:105], v[150:153]
    ds_write_b128 v40, v[126:129] offset:1024
    s_waitcnt vmcnt(5)
    v_mfma_f32_16x16x32_bf16 v[138:141], a[112:115], v[42:45], v[138:141]
    buffer_load_dwordx4 v[66:69], v1, s[40:43], s68 offen offset:1024 sc1
    v_mfma_f32_16x16x32_bf16 v[142:145], a[116:119], v[42:45], v[142:145]
    v_mfma_f32_16x16x32_bf16 v[146:149], a[120:123], v[42:45], v[146:149]
    v_mfma_f32_16x16x32_bf16 v[150:153], a[124:127], v[42:45], v[150:153]
    ds_write_b128 v40, v[130:133] offset:2048
    s_waitcnt vmcnt(5)
    v_mfma_f32_16x16x32_bf16 v[138:141], a[128:131], v[46:49], v[138:141]
    buffer_load_dwordx4 v[70:73], v1, s[40:43], s68 offen offset:3072 sc1
    v_mfma_f32_16x16x32_bf16 v[142:145], a[132:135], v[46:49], v[142:145]
    s_waitcnt lgkmcnt(2)
    v_fmac_f32_e64 v224, s99, v170
    v_mfma_f32_16x16x32_bf16 v[146:149], a[136:139], v[46:49], v[146:149]
    v_fmac_f32 v225, s99, v171
    v_fmac_f32 v226, s99, v172
    v_mfma_f32_16x16x32_bf16 v[150:153], a[140:143], v[46:49], v[150:153]
    ds_write_b128 v40, v[134:137] offset:3072
    s_waitcnt vmcnt(5)
    v_mfma_f32_16x16x32_bf16 v[138:141], a[160:163], v[50:53], v[138:141]
    s_add_u32 s68, s11, s65
    buffer_load_dwordx4 v[74:77], v1, s[40:43], s68 offen offset:0 sc1
    v_mfma_f32_16x16x32_bf16 v[142:145], a[164:167], v[50:53], v[142:145]
    v_fmac_f32 v227, s99, v173
    v_fmac_f32 v228, s99, v174
    v_mfma_f32_16x16x32_bf16 v[146:149], a[168:171], v[50:53], v[146:149]
    v_fmac_f32 v229, s99, v175
    v_fmac_f32 v230, s99, v176
    v_mfma_f32_16x16x32_bf16 v[150:153], a[172:175], v[50:53], v[150:153]
    v_fmac_f32 v231, s99, v177
    v_fmac_f32 v232, s99, v178
    s_waitcnt vmcnt(5)
    v_mfma_f32_16x16x32_bf16 v[138:141], a[176:179], v[54:57], v[138:141]
    buffer_load_dwordx4 v[78:81], v1, s[40:43], s68 offen offset:2048 sc1
    v_mfma_f32_16x16x32_bf16 v[142:145], a[180:183], v[54:57], v[142:145]
    v_fmac_f32 v233, s99, v179
    v_fmac_f32 v234, s99, v180
    v_mfma_f32_16x16x32_bf16 v[146:149], a[184:187], v[54:57], v[146:149]
    v_fmac_f32 v235, s99, v181
    v_fmac_f32_e64 v236, s99, v182
    v_mfma_f32_16x16x32_bf16 v[150:153], a[188:191], v[54:57], v[150:153]
    v_fmac_f32 v237, s99, v183
    v_fmac_f32 v238, s99, v184
    s_waitcnt vmcnt(5)
    v_mfma_f32_16x16x32_bf16 v[138:141], a[208:211], v[58:61], v[138:141]
    buffer_load_dwordx4 v[82:85], v1, s[40:43], s68 offen offset:3072 sc1
    v_mfma_f32_16x16x32_bf16 v[142:145], a[212:215], v[58:61], v[142:145]
    v_fmac_f32 v239, s99, v185
    v_mfma_f32_16x16x32_bf16 v[146:149], a[216:219], v[58:61], v[146:149]
    v_mfma_f32_16x16x32_bf16 v[150:153], a[220:223], v[58:61], v[150:153]
    s_waitcnt vmcnt(5)
    v_mfma_f32_16x16x32_bf16 v[154:157], a[64:67], v[62:65], v[154:157]
    s_add_u32 s68, s11, s66
    buffer_load_dwordx4 v[86:89], v1, s[40:43], s68 offen offset:1024 sc1
    v_mfma_f32_16x16x32_bf16 v[158:161], a[68:71], v[62:65], v[158:161]
    v_mfma_f32_16x16x32_bf16 v[162:165], a[72:75], v[62:65], v[162:165]
    ds_write_b128 v41, v[138:141] offset:0
    v_mfma_f32_16x16x32_bf16 v[166:169], a[76:79], v[62:65], v[166:169]
    s_waitcnt lgkmcnt(1)
    s_barrier
    s_waitcnt vmcnt(5)
    v_mfma_f32_16x16x32_bf16 v[154:157], a[80:83], v[66:69], v[154:157]
    ds_read_b128 v[186:189], v219 offset:4096
    ds_read_b128 v[190:193], v219 offset:5120
    v_mfma_f32_16x16x32_bf16 v[158:161], a[84:87], v[66:69], v[158:161]
    ds_write_b128 v41, v[142:145] offset:1024
    v_mfma_f32_16x16x32_bf16 v[162:165], a[88:91], v[66:69], v[162:165]
    ds_read_b128 v[194:197], v219 offset:6144
    ds_read_b128 v[198:201], v219 offset:7168
    v_mfma_f32_16x16x32_bf16 v[166:169], a[92:95], v[66:69], v[166:169]
    s_waitcnt vmcnt(4)
    v_mfma_f32_16x16x32_bf16 v[154:157], a[112:115], v[70:73], v[154:157]
    ds_write_b128 v41, v[146:149] offset:2048
    v_mfma_f32_16x16x32_bf16 v[158:161], a[116:119], v[70:73], v[158:161]
    v_mfma_f32_16x16x32_bf16 v[162:165], a[120:123], v[70:73], v[162:165]
    s_waitcnt lgkmcnt(1)
    v_fmac_f32 v224, s99, v186
    v_mfma_f32_16x16x32_bf16 v[166:169], a[124:127], v[70:73], v[166:169]
    ds_write_b128 v41, v[150:153] offset:3072
    s_waitcnt vmcnt(3)
    v_mfma_f32_16x16x32_bf16 v[154:157], a[128:131], v[74:77], v[154:157]
    v_fmac_f32 v225, s99, v187
    v_fmac_f32_e64 v226, s99, v188
    v_mfma_f32_16x16x32_bf16 v[158:161], a[132:135], v[74:77], v[158:161]
    v_fmac_f32 v227, s99, v189
    v_fmac_f32 v228, s99, v190
    v_mfma_f32_16x16x32_bf16 v[162:165], a[136:139], v[74:77], v[162:165]
    v_fmac_f32 v229, s99, v191
    v_fmac_f32 v230, s99, v192
    v_mfma_f32_16x16x32_bf16 v[166:169], a[140:143], v[74:77], v[166:169]
    v_fmac_f32 v231, s99, v193
    v_fmac_f32 v232, s99, v194
    s_waitcnt lgkmcnt(0)
    s_barrier
    s_waitcnt vmcnt(2)
    v_mfma_f32_16x16x32_bf16 v[154:157], a[160:163], v[78:81], v[154:157]
    ds_read_b128 v[202:205], v219 offset:8192
    ds_read_b128 v[206:209], v219 offset:9216
    v_mfma_f32_16x16x32_bf16 v[158:161], a[164:167], v[78:81], v[158:161]
    ds_read_b128 v[210:213], v219 offset:10240
    ds_read_b128 v[214:217], v219 offset:11264
    v_mfma_f32_16x16x32_bf16 v[162:165], a[168:171], v[78:81], v[162:165]
    v_fmac_f32 v233, s99, v195
    v_fmac_f32_e64 v234, s99, v196
L_pg5:
    s_cbranch_execz L_pg9
    v_mfma_f32_16x16x32_bf16 v[166:169], a[172:175], v[78:81], v[166:169]
    v_fmac_f32 v235, s99, v197
    v_fmac_f32 v236, s99, v198
    s_waitcnt vmcnt(1)
    v_mfma_f32_16x16x32_bf16 v[154:157], a[176:179], v[82:85], v[154:157]
    v_fmac_f32 v237, s99, v199
    v_fmac_f32 v238, s99, v200
    v_mfma_f32_16x16x32_bf16 v[158:161], a[180:183], v[82:85], v[158:161]
    v_fmac_f32 v239, s99, v201
    s_waitcnt lgkmcnt(0)
    v_mfma_f32_16x16x32_bf16 v[162:165], a[184:187], v[82:85], v[162:165]
    v_fmac_f32 v224, s99, v202
    v_fmac_f32 v225, s99, v203
    v_mfma_f32_16x16x32_bf16 v[166:169], a[188:191], v[82:85], v[166:169]
    v_fmac_f32 v226, s99, v204
    v_fmac_f32 v227, s99, v205
    s_waitcnt vmcnt(0)
    v_mfma_f32_16x16x32_bf16 v[154:157], a[208:211], v[86:89], v[154:157]
    v_fmac_f32 v228, s99, v206
    v_fmac_f32 v229, s99, v207
    v_mfma_f32_16x16x32_bf16 v[158:161], a[212:215], v[86:89], v[158:161]
    v_fmac_f32 v230, s99, v208
    v_fmac_f32_e64 v231, s99, v209
    v_mfma_f32_16x16x32_bf16 v[162:165], a[216:219], v[86:89], v[162:165]
    v_fmac_f32 v232, s99, v210
    v_fmac_f32 v233, s99, v211
    v_mfma_f32_16x16x32_bf16 v[166:169], a[220:223], v[86:89], v[166:169]
    v_fmac_f32 v234, s99, v212
    v_fmac_f32 v235, s99, v213
    v_fmac_f32 v236, s99, v214
    v_fmac_f32 v237, s99, v215
    v_fmac_f32 v238, s99, v216
    v_fmac_f32 v239, s99, v217
    s_lshl_b32 s64, s44, 15
    s_add_u32 s64, s64, s51
    s_add_u32 s65, s64, 16384
    s_mov_b32 s78, s64
    v_lshlrev_b32 v241, 10, v0
    v_pk_fma_f32 v[154:155], v[154:155], s[98:99], v[224:225] op_sel:[0,1,0]
    v_pk_fma_f32 v[156:157], v[156:157], s[98:99], v[226:227] op_sel:[0,1,0]
    v_pk_fma_f32 v[158:159], v[158:159], s[98:99], v[228:229] op_sel:[0,1,0]
    v_pk_fma_f32 v[160:161], v[160:161], s[98:99], v[230:231] op_sel:[0,1,0]
    v_cvt_pk_bf16_f32 v20, v154, v155
    v_cvt_pk_bf16_f32 v21, v156, v157
    v_cvt_pk_bf16_f32 v22, v158, v159
    v_cvt_pk_bf16_f32 v23, v160, v161
    s_nop 0
    v_permlane16_swap_b32 v20, v22
    v_permlane16_swap_b32 v21, v23
    s_cmp_lg_u32 s53, 0
    s_cbranch_scc1 L_slow_50
    buffer_store_dwordx4 v[20:23], v220, s[40:43], s69 offen offset:0
L_st_51:
    v_pk_fma_f32 v[162:163], v[162:163], s[98:99], v[232:233] op_sel:[0,1,0]
    v_pk_fma_f32 v[164:165], v[164:165], s[98:99], v[234:235] op_sel:[0,1,0]
    v_pk_fma_f32 v[166:167], v[166:167], s[98:99], v[236:237] op_sel:[0,1,0]
    v_pk_fma_f32 v[168:169], v[168:169], s[98:99], v[238:239] op_sel:[0,1,0]
    v_cvt_pk_bf16_f32 v24, v162, v163
    v_cvt_pk_bf16_f32 v25, v164, v165
    v_cvt_pk_bf16_f32 v26, v166, v167
    v_cvt_pk_bf16_f32 v27, v168, v169
    s_nop 0
    v_permlane16_swap_b32 v24, v26
    v_permlane16_swap_b32 v25, v27
    s_cmp_lg_u32 s53, 0
    s_cbranch_scc1 L_slow_52
    buffer_store_dwordx4 v[24:27], v220, s[40:43], s69 offen offset:1024
L_st_53:
    v_mfma_f32_16x16x32_bf16 v[110:113], v[20:23], v[20:23], 0
    v_mfma_f32_16x16x32_bf16 v[106:109], v[16:19], v[20:23], 0
    v_mfma_f32_16x16x32_bf16 v[110:113], v[24:27], v[24:27], v[110:113]
    v_mfma_f32_16x16x32_bf16 v[106:109], v[16:19], v[24:27], v[106:109]
    s_or_b64 vcc, s[90:91], s[92:93]
    s_nop 5
    v_cndmask_b32 v110, v110, v111, s[88:89]
    v_cndmask_b32 v112, v112, v113, s[92:93]
    v_cndmask_b32 v107, v110, v112, vcc
    s_mov_b64 exec, s[94:95]
    s_cmp_lg_u32 s53, 0
    s_cbranch_scc1 L_slow_54
    buffer_store_dwordx2 v[106:107], v221, s[40:43], s70 offen
L_st_55:
    s_mov_b64 exec, -1
    s_mov_b32 s50, s51
    s_add_u32 s51, s51, s52
    s_lshl_b32 s67, s44, 11
    s_add_u32 s67, s67, s50
    s_add_u32 s67, s67, 131072
    v_add_u32 v240, 61440, v33
    s_cmp_lg_u32 s62, 0
    s_cselect_b32 s69, 0, 0x40000000
    s_cselect_b32 s66, 524288, 0
    s_sub_u32 s66, s49, s66
    s_add_u32 s70, s66, 139520
    s_add_u32 s71, s66, 159744
    s_lshl_b32 s68, s44, 1
    s_add_u32 s68, s68, s0
    s_and_b32 s68, s68, 7
    s_lshl_b32 s68, s68, 11
    s_add_u32 s66, s66, s68
    s_add_u32 s66, s66, 143360
    s_cmp_eq_u32 s6, 7
    s_cselect_b32 s73, 0, 0x40000000
    v_add_u32 v228, s73, v220
    v_lshl_add_u32 v229, v15, 1, s73
    v_mov_b32 v230, v106
    v_mov_b32 v231, v107
    v_subrev_u32 v34, 98304, v34
    v_subrev_u32 v35, 98304, v35
    v_add_u32 v6, 49152, v34
    v_add_u32 v7, 49152, v35
    v_mov_b32 v36, 7
    s_waitcnt vmcnt(1)
    s_cmp_lg_u32 s53, 0
    s_cbranch_scc1 L_slow_56
    buffer_store_dword v36, v28, s[40:43], s55 offen
L_st_57:
    ds_read_b64_tr_b16 v[186:187], v2 offset:0
    ds_read_b64_tr_b16 v[188:189], v2 offset:3072
    ds_read_b64_tr_b16 v[190:191], v3 offset:0
    ds_read_b64_tr_b16 v[192:193], v3 offset:3072
    ds_read_b64_tr_b16 v[194:195], v2 offset:1024
    ds_read_b64_tr_b16 v[196:197], v2 offset:4096
    ds_read_b64_tr_b16 v[198:199], v3 offset:1024
    ds_read_b64_tr_b16 v[200:201], v3 offset:4096
    ds_read_b64_tr_b16 v[202:203], v2 offset:2048
    ds_read_b64_tr_b16 v[204:205], v2 offset:5120
    ds_read_b64_tr_b16 v[206:207], v3 offset:2048
    ds_read_b64_tr_b16 v[208:209], v3 offset:5120
    v_lshrrev_b32 v236, 1, v32
    v_lshrrev_b32 v232, 1, v15
    v_and_b32 v232, 24, v232
    v_xor_b32 v232, v232, v236
    v_lshl_or_b32 v232, v15, 3, v232
    v_lshrrev_b32 v235, 1, v1
    v_xor_b32 v235, v235, v236
    s_add_u32 s68, s63, 144384
    s_cmp_eq_u32 s44, 0
    s_cselect_b32 s68, 161792, s68
    v_add_u32 v234, s68, v232
    v_add_u32 v236, s68, v235
    s_lshl_b32 s68, s44, 9
    s_add_u32 s68, s68, 161792
    v_add_u32 v233, s68, v232
    s_add_u32 s68, s63, 147456
    v_add_u32 v232, s68, v232
    v_add_u32_e64 v235, s68, v235
    buffer_load_dword v38, v15, s[40:43], s57 offen sc1
    ds_read_b64_tr_b16 a[240:241], v33 offset:0
    ds_read_b64_tr_b16 a[242:243], v33 offset:3072
    ds_read_b64_tr_b16 a[244:245], v33 offset:6144
    ds_read_b64_tr_b16 a[246:247], v33 offset:9216
    ds_read_b64_tr_b16 a[248:249], v33 offset:12288
    ds_read_b64_tr_b16 a[250:251], v33 offset:15360
    ds_read_b64_tr_b16 a[252:253], v33 offset:18432
    ds_read_b64_tr_b16 a[254:255], v33 offset:21504
    ds_read_b64_tr_b16 v[90:91], v33 offset:24576
    ds_read_b64_tr_b16 v[92:93], v33 offset:27648
    ds_read_b64_tr_b16 v[94:95], v33 offset:30720
    ds_read_b64_tr_b16 v[96:97], v33 offset:33792
    ds_read_b64_tr_b16 v[98:99], v33 offset:36864
    ds_read_b64_tr_b16 v[100:101], v33 offset:39936
    ds_read_b64_tr_b16 v[102:103], v33 offset:43008
    ds_read_b64_tr_b16 v[104:105], v33 offset:46080
    s_mov_b32 s85, 0
L_poll_58:
    buffer_load_dword v37, v15, s[40:43], s57 offen sc1
    s_add_u32 s85, s85, 1
    s_cmp_lt_u32 s85, 131072
    s_cbranch_scc0 L_got_59
    s_waitcnt vmcnt(1)
    v_cmp_gt_u32 vcc, 7, v38
    s_cbranch_vccz L_got_59
    buffer_load_dword v38, v15, s[40:43], s57 offen sc1
    s_waitcnt vmcnt(1)
    v_cmp_gt_u32 vcc, 7, v37
    s_cbranch_vccnz L_poll_58
L_got_59:
    buffer_load_dwordx4 v[42:45], v1, s[40:43], s64 offen offset:0 sc1
    buffer_load_dwordx4 v[46:49], v1, s[40:43], s65 offen offset:0 sc1
    buffer_load_dwordx4 v[50:53], v1, s[40:43], s64 offen offset:1024 sc1
    buffer_load_dwordx4 v[54:57], v1, s[40:43], s65 offen offset:1024 sc1
    v_mov_b32 v36, 8
    s_cmp_lg_u32 s53, 0
    s_cbranch_scc1 L_slow_60
    buffer_store_dword v36, v28, s[40:43], s55 offen
L_st_61:
    ds_read_b64_tr_b16 v[106:107], v33 offset:49152
    ds_read_b64_tr_b16 v[108:109], v33 offset:52224
    ds_read_b64_tr_b16 v[110:111], v33 offset:55296
    ds_read_b64_tr_b16 v[112:113], v33 offset:58368
    ds_read_b64_tr_b16 v[114:115], v240 offset:0
    ds_read_b64_tr_b16 v[116:117], v240 offset:3072
    ds_read_b64_tr_b16 v[118:119], v240 offset:6144
    ds_read_b64_tr_b16 v[120:121], v240 offset:9216
    ds_read_b64_tr_b16 v[122:123], v240 offset:12288
    ds_read_b64_tr_b16 v[124:125], v240 offset:15360
    ds_read_b64_tr_b16 v[126:127], v240 offset:18432
    ds_read_b64_tr_b16 v[128:129], v240 offset:21504
    ds_read_b64_tr_b16 v[130:131], v240 offset:24576
    ds_read_b64_tr_b16 v[132:133], v240 offset:27648
    ds_read_b64_tr_b16 v[134:135], v240 offset:30720
    ds_read_b64_tr_b16 v[136:137], v240 offset:33792
    v_and_b32 v39, 28, v15
    v_add_u32 v241, s69, v1
    v_lshl_add_u32 v41, v15, 1, s69
    v_lshl_add_u32 v41, v32, 4, v41
    s_waitcnt vmcnt(3) lgkmcnt(14)
    v_mfma_f32_16x16x32_bf16 v[138:141], v[186:189], v[42:45], 0
    ds_read_b64_tr_b16 v[210:211], v2 offset:6144
    buffer_load_dwordx4 v[58:61], v1, s[40:43], s64 offen offset:2048 sc1
    v_mfma_f32_16x16x32_bf16 v[142:145], v[186:189], v[46:49], 0
    ds_read_b64_tr_b16 v[212:213], v2 offset:9216
    v_mfma_f32_16x16x32_bf16 v[146:149], v[190:193], v[42:45], 0
    ds_read_b64_tr_b16 v[214:215], v3 offset:6144
    v_mfma_f32_16x16x32_bf16 v[150:153], v[190:193], v[46:49], 0
    ds_read_b64_tr_b16 v[216:217], v3 offset:9216
    v_mfma_f32_16x16x32_bf16 v[154:157], v[194:197], v[42:45], 0
    ds_read_b64_tr_b16 v[186:187], v2 offset:7168
    buffer_load_dwordx4 v[62:65], v1, s[40:43], s65 offen offset:2048 sc1
    v_mfma_f32_16x16x32_bf16 v[158:161], v[194:197], v[46:49], 0
    ds_read_b64_tr_b16 v[188:189], v2 offset:10240
    v_mfma_f32_16x16x32_bf16 v[162:165], v[198:201], v[42:45], 0
    ds_read_b64_tr_b16 v[190:191], v3 offset:7168
    v_mfma_f32_16x16x32_bf16 v[166:169], v[198:201], v[46:49], 0
    ds_read_b64_tr_b16 v[192:193], v3 offset:10240
    v_mfma_f32_16x16x32_bf16 v[170:173], v[202:205], v[42:45], 0
    ds_read_b64_tr_b16 v[194:195], v2 offset:8192
    v_mfma_f32_16x16x32_bf16 v[174:177], v[202:205], v[46:49], 0
    ds_read_b64_tr_b16 v[196:197], v2 offset:11264
    v_mfma_f32_16x16x32_bf16 v[178:181], v[206:209], v[42:45], 0
    ds_read_b64_tr_b16 v[198:199], v3 offset:8192
    v_mfma_f32_16x16x32_bf16 v[182:185], v[206:209], v[46:49], 0
    ds_read_b64_tr_b16 v[200:201], v3 offset:11264
    s_waitcnt vmcnt(3) lgkmcnt(6)
    v_mfma_f32_16x16x32_bf16 v[138:141], v[210:213], v[50:53], v[138:141]
    ds_read_b64_tr_b16 v[202:203], v2 offset:12288
    buffer_load_dwordx4 v[66:69], v1, s[40:43], s64 offen offset:3072 sc1
    v_mfma_f32_16x16x32_bf16 v[142:145], v[210:213], v[54:57], v[142:145]
    ds_read_b64_tr_b16 v[204:205], v2 offset:15360
    buffer_store_dwordx4 v[20:23], v228, s[40:43], s3 offen offset:0 sc1
    buffer_store_dwordx4 v[24:27], v228, s[40:43], s3 offen offset:1024 sc1
    s_mov_b64 exec, s[94:95]
    buffer_store_dwordx2 v[230:231], v229, s[40:43], s4 offen sc1
    s_mov_b64 exec, -1
    v_mfma_f32_16x16x32_bf16 v[146:149], v[214:217], v[50:53], v[146:149]
    ds_read_b64_tr_b16 v[206:207], v3 offset:12288
    buffer_load_dword v38, v15, s[40:43], s57 offen sc1
    v_mfma_f32_16x16x32_bf16 v[150:153], v[214:217], v[54:57], v[150:153]
    ds_read_b64_tr_b16 v[208:209], v3 offset:15360
    v_mfma_f32_16x16x32_bf16 v[154:157], v[186:189], v[50:53], v[154:157]
    ds_read_b64_tr_b16 v[210:211], v2 offset:13312
    buffer_load_dwordx4 v[70:73], v1, s[40:43], s65 offen offset:3072 sc1
    v_mfma_f32_16x16x32_bf16 v[158:161], v[186:189], v[54:57], v[158:161]
    ds_read_b64_tr_b16 v[212:213], v2 offset:16384
    s_waitcnt lgkmcnt(6)
    v_mfma_f32_16x16x32_bf16 v[162:165], v[190:193], v[50:53], v[162:165]
    ds_read_b64_tr_b16 v[214:215], v3 offset:13312
    s_add_u32 s64, s64, 4096
    v_mfma_f32_16x16x32_bf16 v[166:169], v[190:193], v[54:57], v[166:169]
    ds_read_b64_tr_b16 v[216:217], v3 offset:16384
    s_add_u32 s65, s65, 4096
    v_mfma_f32_16x16x32_bf16 v[170:173], v[194:197], v[50:53], v[170:173]
    ds_read_b64_tr_b16 v[186:187], v2 offset:14336
    buffer_load_dwordx4 v[74:77], v1, s[40:43], s64 offen offset:0 sc1
    v_mfma_f32_16x16x32_bf16 v[174:177], v[194:197], v[54:57], v[174:177]
    ds_read_b64_tr_b16 v[188:189], v2 offset:17408
    v_mfma_f32_16x16x32_bf16 v[178:181], v[198:201], v[50:53], v[178:181]
    ds_read_b64_tr_b16 v[190:191], v3 offset:14336
    v_mfma_f32_16x16x32_bf16 v[182:185], v[198:201], v[54:57], v[182:185]
    ds_read_b64_tr_b16 v[192:193], v3 offset:17408
    s_waitcnt vmcnt(7) lgkmcnt(6)
    v_mfma_f32_16x16x32_bf16 v[138:141], v[202:205], v[58:61], v[138:141]
    ds_read_b64_tr_b16 v[194:195], v2 offset:18432
    buffer_load_dwordx4 v[78:81], v1, s[40:43], s65 offen offset:0 sc1
    v_mfma_f32_16x16x32_bf16 v[142:145], v[202:205], v[62:65], v[142:145]
    ds_read_b64_tr_b16 v[196:197], v2 offset:21504
    v_mfma_f32_16x16x32_bf16 v[146:149], v[206:209], v[58:61], v[146:149]
    ds_read_b64_tr_b16 v[198:199], v3 offset:18432
    v_mfma_f32_16x16x32_bf16 v[150:153], v[206:209], v[62:65], v[150:153]
    ds_read_b64_tr_b16 v[200:201], v3 offset:21504
    v_mfma_f32_16x16x32_bf16 v[154:157], v[210:213], v[58:61], v[154:157]
    ds_read_b64_tr_b16 v[202:203], v2 offset:19456
    buffer_load_dwordx4 v[82:85], v1, s[40:43], s64 offen offset:1024 sc1
    v_mfma_f32_16x16x32_bf16 v[158:161], v[210:213], v[62:65], v[158:161]
    ds_read_b64_tr_b16 v[204:205], v2 offset:22528
    s_waitcnt lgkmcnt(6)
    v_mfma_f32_16x16x32_bf16 v[162:165], v[214:217], v[58:61], v[162:165]
    ds_read_b64_tr_b16 v[206:207], v3 offset:19456
    v_mfma_f32_16x16x32_bf16 v[166:169], v[214:217], v[62:65], v[166:169]
    ds_read_b64_tr_b16 v[208:209], v3 offset:22528
    v_mfma_f32_16x16x32_bf16 v[170:173], v[186:189], v[58:61], v[170:173]
    ds_read_b64_tr_b16 v[210:211], v2 offset:20480
    buffer_load_dwordx4 v[86:89], v1, s[40:43], s65 offen offset:1024 sc1
    v_mfma_f32_16x16x32_bf16 v[174:177], v[186:189], v[62:65], v[174:177]
    ds_read_b64_tr_b16 v[212:213], v2 offset:23552
    v_mfma_f32_16x16x32_bf16 v[178:181], v[190:193], v[58:61], v[178:181]
    ds_read_b64_tr_b16 v[214:215], v3 offset:20480
    v_mfma_f32_16x16x32_bf16 v[182:185], v[190:193], v[62:65], v[182:185]
    ds_read_b64_tr_b16 v[216:217], v3 offset:23552
    s_waitcnt vmcnt(5)
    v_cmp_gt_u32 vcc, 8, v38
    s_cbranch_vccnz L_fb_63
L_ok_62:
    s_waitcnt vmcnt(4) lgkmcnt(6)
    v_mfma_f32_16x16x32_bf16 v[138:141], v[194:197], v[66:69], v[138:141]
    ds_read_b64_tr_b16 v[186:187], v2 offset:24576
    buffer_load_dwordx4 v[228:231], v1, s[40:43], s67 offen offset:1024 sc1
    v_mfma_f32_16x16x32_bf16 v[142:145], v[194:197], v[70:73], v[142:145]
    ds_read_b64_tr_b16 v[188:189], v2 offset:27648
    v_mfma_f32_16x16x32_bf16 v[146:149], v[198:201], v[66:69], v[146:149]
    ds_read_b64_tr_b16 v[190:191], v3 offset:24576
    v_mfma_f32_16x16x32_bf16 v[150:153], v[198:201], v[70:73], v[150:153]
    ds_read_b64_tr_b16 v[192:193], v3 offset:27648
    v_mfma_f32_16x16x32_bf16 v[154:157], v[202:205], v[66:69], v[154:157]
    ds_read_b64_tr_b16 v[194:195], v2 offset:25600
    buffer_load_dwordx4 v[224:227], v1, s[40:43], s67 offen offset:0 sc1
    v_mfma_f32_16x16x32_bf16 v[158:161], v[202:205], v[70:73], v[158:161]
    ds_read_b64_tr_b16 v[196:197], v2 offset:28672
    s_waitcnt lgkmcnt(6)
    v_mfma_f32_16x16x32_bf16 v[162:165], v[206:209], v[66:69], v[162:165]
    ds_read_b64_tr_b16 v[198:199], v3 offset:25600
    v_mfma_f32_16x16x32_bf16 v[166:169], v[206:209], v[70:73], v[166:169]
    ds_read_b64_tr_b16 v[200:201], v3 offset:28672
    v_mfma_f32_16x16x32_bf16 v[170:173], v[210:213], v[66:69], v[170:173]
    ds_read_b64_tr_b16 v[202:203], v2 offset:26624
    buffer_load_dwordx4 v[42:45], v1, s[40:43], s64 offen offset:2048 sc1
    v_mfma_f32_16x16x32_bf16 v[174:177], v[210:213], v[70:73], v[174:177]
    ds_read_b64_tr_b16 v[204:205], v2 offset:29696
    v_mfma_f32_16x16x32_bf16 v[178:181], v[214:217], v[66:69], v[178:181]
    ds_read_b64_tr_b16 v[206:207], v3 offset:26624
    v_mfma_f32_16x16x32_bf16 v[182:185], v[214:217], v[70:73], v[182:185]
    ds_read_b64_tr_b16 v[208:209], v3 offset:29696
    s_waitcnt vmcnt(5) lgkmcnt(6)
    v_mfma_f32_16x16x32_bf16 v[138:141], v[186:189], v[74:77], v[138:141]
    ds_read_b64_tr_b16 v[210:211], v2 offset:30720
    buffer_load_dwordx4 v[46:49], v1, s[40:43], s65 offen offset:2048 sc1
    v_mfma_f32_16x16x32_bf16 v[142:145], v[186:189], v[78:81], v[142:145]
    ds_read_b64_tr_b16 v[212:213], v2 offset:33792
    v_mfma_f32_16x16x32_bf16 v[146:149], v[190:193], v[74:77], v[146:149]
    ds_read_b64_tr_b16 v[214:215], v3 offset:30720
    v_mfma_f32_16x16x32_bf16 v[150:153], v[190:193], v[78:81], v[150:153]
    ds_read_b64_tr_b16 v[216:217], v3 offset:33792
    v_mfma_f32_16x16x32_bf16 v[154:157], v[194:197], v[74:77], v[154:157]
    ds_read_b64_tr_b16 v[186:187], v2 offset:31744
    buffer_load_dwordx4 v[50:53], v1, s[40:43], s64 offen offset:3072 sc1
    v_mfma_f32_16x16x32_bf16 v[158:161], v[194:197], v[78:81], v[158:161]
    ds_read_b64_tr_b16 v[188:189], v2 offset:34816
    s_waitcnt lgkmcnt(6)
    v_mfma_f32_16x16x32_bf16 v[162:165], v[198:201], v[74:77], v[162:165]
    ds_read_b64_tr_b16 v[190:191], v3 offset:31744
    v_mfma_f32_16x16x32_bf16 v[166:169], v[198:201], v[78:81], v[166:169]
    ds_read_b64_tr_b16 v[192:193], v3 offset:34816
    v_mfma_f32_16x16x32_bf16 v[170:173], v[202:205], v[74:77], v[170:173]
    ds_read_b64_tr_b16 v[194:195], v2 offset:32768
    buffer_load_dwordx4 v[54:57], v1, s[40:43], s65 offen offset:3072 sc1
    v_mfma_f32_16x16x32_bf16 v[174:177], v[202:205], v[78:81], v[174:177]
    ds_read_b64_tr_b16 v[196:197], v2 offset:35840
    s_add_u32 s64, s64, 4096
    v_mfma_f32_16x16x32_bf16 v[178:181], v[206:209], v[74:77], v[178:181]
    ds_read_b64_tr_b16 v[198:199], v3 offset:32768
    s_add_u32 s65, s65, 4096
    v_mfma_f32_16x16x32_bf16 v[182:185], v[206:209], v[78:81], v[182:185]
    ds_read_b64_tr_b16 v[200:201], v3 offset:35840
    s_waitcnt vmcnt(6) lgkmcnt(6)
    v_mfma_f32_16x16x32_bf16 v[138:141], v[210:213], v[82:85], v[138:141]
    ds_read_b64_tr_b16 v[202:203], v2 offset:36864
    buffer_load_dwordx4 v[58:61], v1, s[40:43], s64 offen offset:0 sc1
    v_mfma_f32_16x16x32_bf16 v[142:145], v[210:213], v[86:89], v[142:145]
    ds_read_b64_tr_b16 v[204:205], v2 offset:39936
    s_waitcnt vmcnt(5)
    v_mfma_f32_16x16x32_bf16 v[146:149], v[214:217], v[82:85], v[146:149]
    ds_read_b64_tr_b16 v[206:207], v3 offset:36864
    v_add_f32 v218, v224, v226
    v_mfma_f32_16x16x32_bf16 v[150:153], v[214:217], v[86:89], v[150:153]
    ds_read_b64_tr_b16 v[208:209], v3 offset:39936
    v_add_f32 v219, v225, v227
    v_mfma_f32_16x16x32_bf16 v[154:157], v[186:189], v[82:85], v[154:157]
    ds_read_b64_tr_b16 v[210:211], v2 offset:37888
    buffer_load_dwordx4 v[62:65], v1, s[40:43], s65 offen offset:0 sc1
    v_mfma_f32_16x16x32_bf16 v[158:161], v[186:189], v[86:89], v[158:161]
    ds_read_b64_tr_b16 v[212:213], v2 offset:40960
    s_waitcnt lgkmcnt(6)
    v_mfma_f32_16x16x32_bf16 v[162:165], v[190:193], v[82:85], v[162:165]
    ds_read_b64_tr_b16 v[214:215], v3 offset:37888
    v_add_f32 v220, v228, v230
    v_mfma_f32_16x16x32_bf16 v[166:169], v[190:193], v[86:89], v[166:169]
    ds_read_b64_tr_b16 v[216:217], v3 offset:40960
    v_add_f32_e64 v221, v229, v231
    v_mfma_f32_16x16x32_bf16 v[170:173], v[194:197], v[82:85], v[170:173]
    ds_read_b64_tr_b16 v[186:187], v2 offset:38912
    buffer_load_dwordx4 v[66:69], v1, s[40:43], s64 offen offset:1024 sc1
    v_mfma_f32_16x16x32_bf16 v[174:177], v[194:197], v[86:89], v[174:177]
    ds_read_b64_tr_b16 v[188:189], v2 offset:41984
    v_permlane16_swap_b32 v218, v219
    v_mfma_f32_16x16x32_bf16 v[178:181], v[198:201], v[82:85], v[178:181]
    ds_read_b64_tr_b16 v[190:191], v3 offset:38912
    v_permlane16_swap_b32 v220, v221
    v_mfma_f32_16x16x32_bf16 v[182:185], v[198:201], v[86:89], v[182:185]
    ds_read_b64_tr_b16 v[192:193], v3 offset:41984
    s_waitcnt vmcnt(5) lgkmcnt(6)
    v_mfma_f32_16x16x32_bf16 v[138:141], v[202:205], v[42:45], v[138:141]
    ds_read_b64_tr_b16 v[194:195], v2 offset:43008
    buffer_load_dwordx4 v[70:73], v1, s[40:43], s65 offen offset:1024 sc1
    v_mfma_f32_16x16x32_bf16 v[142:145], v[202:205], v[46:49], v[142:145]
    ds_read_b64_tr_b16 v[196:197], v2 offset:46080
    v_mov_b32 v36, 1
    v_mov_b32 v37, s73
    s_mov_b64 exec, 1
    buffer_store_dword v36, v37, s[40:43], s5 offen sc1
    s_mov_b64 exec, -1
    v_mfma_f32_16x16x32_bf16 v[146:149], v[206:209], v[42:45], v[146:149]
    ds_read_b64_tr_b16 v[198:199], v3 offset:43008
    v_add_f32 v218, v218, v219
    v_mfma_f32_16x16x32_bf16 v[150:153], v[206:209], v[46:49], v[150:153]
    ds_read_b64_tr_b16 v[200:201], v3 offset:46080
    v_add_f32_e64 v220, v220, v221
    v_mfma_f32_16x16x32_bf16 v[154:157], v[210:213], v[42:45], v[154:157]
    ds_read_b64_tr_b16 v[202:203], v2 offset:44032
    buffer_load_dwordx4 v[74:77], v1, s[40:43], s64 offen offset:2048 sc1
    v_mfma_f32_16x16x32_bf16 v[158:161], v[210:213], v[46:49], v[158:161]
    ds_read_b64_tr_b16 v[204:205], v2 offset:47104
    s_waitcnt lgkmcnt(6)
    v_mfma_f32_16x16x32_bf16 v[162:165], v[214:217], v[42:45], v[162:165]
    ds_read_b64_tr_b16 v[206:207], v3 offset:44032
    v_permlane32_swap_b32 v218, v220
    v_mfma_f32_16x16x32_bf16 v[166:169], v[214:217], v[46:49], v[166:169]
    ds_read_b64_tr_b16 v[208:209], v3 offset:47104
    v_add_f32_e64 v218, v218, v220
    v_mfma_f32_16x16x32_bf16 v[170:173], v[186:189], v[42:45], v[170:173]
    ds_read_b64_tr_b16 v[210:211], v2 offset:45056
    buffer_load_dwordx4 v[78:81], v1, s[40:43], s65 offen offset:2048 sc1
    v_mfma_f32_16x16x32_bf16 v[174:177], v[186:189], v[46:49], v[174:177]
    ds_read_b64_tr_b16 v[212:213], v2 offset:48128
    v_mul_f32_e64 v219, -s84, v218
    v_mfma_f32_16x16x32_bf16 v[178:181], v[190:193], v[42:45], v[178:181]
    ds_read_b64_tr_b16 v[214:215], v3 offset:45056
    v_mul_f32_e64 v224, -s84, v218
    v_mfma_f32_16x16x32_bf16 v[182:185], v[190:193], v[46:49], v[182:185]
    ds_read_b64_tr_b16 v[216:217], v3 offset:48128
    s_waitcnt vmcnt(7) lgkmcnt(6)
    v_mfma_f32_16x16x32_bf16 v[138:141], v[194:197], v[50:53], v[138:141]
    ds_read_b64_tr_b16 v[186:187], v2 offset:49152
    buffer_load_dwordx4 v[82:85], v1, s[40:43], s64 offen offset:3072 sc1
    v_mfma_f32_16x16x32_bf16 v[142:145], v[194:197], v[54:57], v[142:145]
    ds_read_b64_tr_b16 v[188:189], v2 offset:52224
    v_permlane16_swap_b32 v219, v224
    v_mfma_f32_16x16x32_bf16 v[146:149], v[198:201], v[50:53], v[146:149]
    ds_read_b64_tr_b16 v[190:191], v3 offset:49152
    v_fma_f32 v224, -v219, v219, -v224
    v_mfma_f32_16x16x32_bf16 v[150:153], v[198:201], v[54:57], v[150:153]
    ds_read_b64_tr_b16 v[192:193], v3 offset:52224
    v_max_f32_e64 v224, 0, v224
    v_mfma_f32_16x16x32_bf16 v[154:157], v[202:205], v[50:53], v[154:157]
    ds_read_b64_tr_b16 v[194:195], v2 offset:50176
    buffer_load_dwordx4 v[86:89], v1, s[40:43], s65 offen offset:3072 sc1
    v_mfma_f32_16x16x32_bf16 v[158:161], v[202:205], v[54:57], v[158:161]
    ds_read_b64_tr_b16 v[196:197], v2 offset:53248
    s_waitcnt lgkmcnt(6)
    v_mfma_f32_16x16x32_bf16 v[162:165], v[206:209], v[50:53], v[162:165]
    ds_read_b64_tr_b16 v[198:199], v3 offset:50176
    v_add_f32 v224, 0x3727c5ac, v224
    v_mfma_f32_16x16x32_bf16 v[166:169], v[206:209], v[54:57], v[166:169]
    ds_read_b64_tr_b16 v[200:201], v3 offset:53248
    v_mov_b32 v221, v219
    v_mfma_f32_16x16x32_bf16 v[170:173], v[210:213], v[50:53], v[170:173]
    ds_read_b64_tr_b16 v[202:203], v2 offset:51200
    v_rsq_f32 v218, v224
    v_mfma_f32_16x16x32_bf16 v[174:177], v[210:213], v[54:57], v[174:177]
    ds_read_b64_tr_b16 v[204:205], v2 offset:54272
    v_permlane32_swap_b32 v219, v221
    v_mfma_f32_16x16x32_bf16 v[178:181], v[214:217], v[50:53], v[178:181]
    ds_read_b64_tr_b16 v[206:207], v3 offset:51200
    v_mov_b32_e64 v220, v218
    v_mfma_f32_16x16x32_bf16 v[182:185], v[214:217], v[54:57], v[182:185]
    ds_read_b64_tr_b16 v[208:209], v3 offset:54272
    s_waitcnt vmcnt(7) lgkmcnt(6)
    v_mfma_f32_16x16x32_bf16 v[138:141], v[186:189], v[58:61], v[138:141]
    ds_read_b64_tr_b16 v[210:211], v2 offset:55296
    s_add_u32 s64, s64, 4096
    v_mfma_f32_16x16x32_bf16 v[142:145], v[186:189], v[62:65], v[142:145]
    ds_read_b64_tr_b16 v[212:213], v2 offset:58368
    s_add_u32 s65, s65, 4096
    v_mfma_f32_16x16x32_bf16 v[146:149], v[190:193], v[58:61], v[146:149]
    ds_read_b64_tr_b16 v[214:215], v3 offset:55296
    buffer_load_dwordx4 v[42:45], v1, s[40:43], s64 offen offset:0 sc1
    v_mfma_f32_16x16x32_bf16 v[150:153], v[190:193], v[62:65], v[150:153]
    ds_read_b64_tr_b16 v[216:217], v3 offset:58368
    v_permlane32_swap_b32 v218, v220
    v_mfma_f32_16x16x32_bf16 v[154:157], v[194:197], v[58:61], v[154:157]
    ds_read_b64_tr_b16 v[186:187], v2 offset:56320
    v_mfma_f32_16x16x32_bf16 v[158:161], v[194:197], v[62:65], v[158:161]
    ds_read_b64_tr_b16 v[188:189], v2 offset:59392
    s_waitcnt lgkmcnt(6)
    v_mfma_f32_16x16x32_bf16 v[162:165], v[198:201], v[58:61], v[162:165]
    ds_read_b64_tr_b16 v[190:191], v3 offset:56320
    buffer_load_dwordx4 v[46:49], v1, s[40:43], s65 offen offset:0 sc1
    v_mfma_f32_16x16x32_bf16 v[166:169], v[198:201], v[62:65], v[166:169]
    ds_read_b64_tr_b16 v[192:193], v3 offset:59392
    v_mfma_f32_16x16x32_bf16 v[170:173], v[202:205], v[58:61], v[170:173]
    ds_read_b64_tr_b16 v[194:195], v2 offset:57344
    v_mfma_f32_16x16x32_bf16 v[174:177], v[202:205], v[62:65], v[174:177]
    ds_read_b64_tr_b16 v[196:197], v2 offset:60416
    v_mfma_f32_16x16x32_bf16 v[178:181], v[206:209], v[58:61], v[178:181]
    ds_read_b64_tr_b16 v[198:199], v3 offset:57344
    v_mfma_f32_16x16x32_bf16 v[182:185], v[206:209], v[62:65], v[182:185]
    ds_read_b64_tr_b16 v[200:201], v3 offset:60416
    s_waitcnt vmcnt(7) lgkmcnt(6)
    v_mfma_f32_16x16x32_bf16 v[138:141], v[210:213], v[66:69], v[138:141]
    ds_read_b64_tr_b16 v[202:203], v2 offset:61440
    buffer_load_dwordx4 v[50:53], v1, s[40:43], s64 offen offset:1024 sc1
    v_mfma_f32_16x16x32_bf16 v[142:145], v[210:213], v[70:73], v[142:145]
    ds_read_b64_tr_b16 v[204:205], v2 offset:64512
    v_mfma_f32_16x16x32_bf16 v[146:149], v[214:217], v[66:69], v[146:149]
    ds_read_b64_tr_b16 v[206:207], v3 offset:61440
    v_mfma_f32_16x16x32_bf16 v[150:153], v[214:217], v[70:73], v[150:153]
    ds_read_b64_tr_b16 v[208:209], v3 offset:64512
    v_mfma_f32_16x16x32_bf16 v[154:157], v[186:189], v[66:69], v[154:157]
    ds_read_b64_tr_b16 v[210:211], v2 offset:62464
    buffer_load_dwordx4 v[54:57], v1, s[40:43], s65 offen offset:1024 sc1
    v_mfma_f32_16x16x32_bf16 v[158:161], v[186:189], v[70:73], v[158:161]
    ds_read_b64_tr_b16 v[212:213], v4 offset:0
    s_waitcnt lgkmcnt(6)
    v_mfma_f32_16x16x32_bf16 v[162:165], v[190:193], v[66:69], v[162:165]
    ds_read_b64_tr_b16 v[214:215], v3 offset:62464
    v_mfma_f32_16x16x32_bf16 v[166:169], v[190:193], v[70:73], v[166:169]
    ds_read_b64_tr_b16 v[216:217], v5 offset:0
    v_mfma_f32_16x16x32_bf16 v[170:173], v[194:197], v[66:69], v[170:173]
    ds_read_b64_tr_b16 v[186:187], v2 offset:63488
    v_mfma_f32_16x16x32_bf16 v[174:177], v[194:197], v[70:73], v[174:177]
    ds_read_b64_tr_b16 v[188:189], v4 offset:1024
    v_mfma_f32_16x16x32_bf16 v[178:181], v[198:201], v[66:69], v[178:181]
    ds_read_b64_tr_b16 v[190:191], v3 offset:63488
    v_mfma_f32_16x16x32_bf16 v[182:185], v[198:201], v[70:73], v[182:185]
    ds_read_b64_tr_b16 v[192:193], v5 offset:1024
    s_waitcnt vmcnt(6) lgkmcnt(6)
    v_mfma_f32_16x16x32_bf16 v[138:141], v[202:205], v[74:77], v[138:141]
    ds_read_b64_tr_b16 v[194:195], v4 offset:2048
    buffer_load_dwordx4 v[58:61], v1, s[40:43], s64 offen offset:2048 sc1
    v_mfma_f32_16x16x32_bf16 v[142:145], v[202:205], v[78:81], v[142:145]
    ds_read_b64_tr_b16 v[196:197], v4 offset:5120
    v_mfma_f32_16x16x32_bf16 v[146:149], v[206:209], v[74:77], v[146:149]
    ds_read_b64_tr_b16 v[198:199], v5 offset:2048
    v_mfma_f32_16x16x32_bf16 v[150:153], v[206:209], v[78:81], v[150:153]
    ds_read_b64_tr_b16 v[200:201], v5 offset:5120
    v_mfma_f32_16x16x32_bf16 v[154:157], v[210:213], v[74:77], v[154:157]
    ds_read_b64_tr_b16 v[202:203], v4 offset:3072
    buffer_load_dwordx4 v[62:65], v1, s[40:43], s65 offen offset:2048 sc1
    v_mfma_f32_16x16x32_bf16 v[158:161], v[210:213], v[78:81], v[158:161]
    ds_read_b64_tr_b16 v[204:205], v4 offset:6144
    s_waitcnt lgkmcnt(6)
    v_mfma_f32_16x16x32_bf16 v[162:165], v[214:217], v[74:77], v[162:165]
    ds_read_b64_tr_b16 v[206:207], v5 offset:3072
    v_mfma_f32_16x16x32_bf16 v[166:169], v[214:217], v[78:81], v[166:169]
    ds_read_b64_tr_b16 v[208:209], v5 offset:6144
    v_mfma_f32_16x16x32_bf16 v[170:173], v[186:189], v[74:77], v[170:173]
    ds_read_b64_tr_b16 v[210:211], v4 offset:4096
    v_mfma_f32_16x16x32_bf16 v[174:177], v[186:189], v[78:81], v[174:177]
    ds_read_b64_tr_b16 v[212:213], v4 offset:7168
    v_mfma_f32_16x16x32_bf16 v[178:181], v[190:193], v[74:77], v[178:181]
    ds_read_b64_tr_b16 v[214:215], v5 offset:4096
    v_mfma_f32_16x16x32_bf16 v[182:185], v[190:193], v[78:81], v[182:185]
    ds_read_b64_tr_b16 v[216:217], v5 offset:7168
    s_barrier
    s_waitcnt vmcnt(6) lgkmcnt(6)
    v_mfma_f32_16x16x32_bf16 v[138:141], v[194:197], v[82:85], v[138:141]
    ds_read_b64_tr_b16 v[186:187], v4 offset:8192
    buffer_load_dwordx4 v[66:69], v1, s[40:43], s64 offen offset:3072 sc1
    v_mfma_f32_16x16x32_bf16 v[142:145], v[194:197], v[86:89], v[142:145]
    ds_read_b64_tr_b16 v[188:189], v4 offset:11264
    v_mfma_f32_16x16x32_bf16 v[146:149], v[198:201], v[82:85], v[146:149]
    ds_read_b64_tr_b16 v[190:191], v5 offset:8192
    v_mfma_f32_16x16x32_bf16 v[150:153], v[198:201], v[86:89], v[150:153]
    ds_read_b64_tr_b16 v[192:193], v5 offset:11264
    v_mfma_f32_16x16x32_bf16 v[154:157], v[202:205], v[82:85], v[154:157]
    ds_read_b64_tr_b16 v[194:195], v4 offset:9216
    buffer_load_dwordx4 v[70:73], v1, s[40:43], s65 offen offset:3072 sc1
    v_mfma_f32_16x16x32_bf16 v[158:161], v[202:205], v[86:89], v[158:161]
    ds_read_b64_tr_b16 v[196:197], v4 offset:12288
    s_waitcnt lgkmcnt(6)
    v_mfma_f32_16x16x32_bf16 v[162:165], v[206:209], v[82:85], v[162:165]
    ds_read_b64_tr_b16 v[198:199], v5 offset:9216
    s_add_u32 m0, s63, 0
    v_mfma_f32_16x16x32_bf16 v[166:169], v[206:209], v[86:89], v[166:169]
    ds_read_b64_tr_b16 v[200:201], v5 offset:12288
    s_add_u32 s80, s83, 0
    v_mfma_f32_16x16x32_bf16 v[170:173], v[210:213], v[82:85], v[170:173]
    ds_read_b64_tr_b16 v[202:203], v4 offset:10240
    buffer_load_dwordx4 v12, s[20:23], s80 offen offset:0  lds
L_pg6:
    s_cbranch_execz L_walked1
    v_mfma_f32_16x16x32_bf16 v[174:177], v[210:213], v[86:89], v[174:177]
    ds_read_b64_tr_b16 v[204:205], v4 offset:13312
    v_mfma_f32_16x16x32_bf16 v[178:181], v[214:217], v[82:85], v[178:181]
    ds_read_b64_tr_b16 v[206:207], v5 offset:10240
    v_mfma_f32_16x16x32_bf16 v[182:185], v[214:217], v[86:89], v[182:185]
    ds_read_b64_tr_b16 v[208:209], v5 offset:13312
    buffer_load_dword v38, v39, s[40:43], s70 offen sc1
    s_waitcnt vmcnt(8) lgkmcnt(6)
    v_mfma_f32_16x16x32_bf16 v[138:141], v[186:189], v[42:45], v[138:141]
    ds_read_b64_tr_b16 v[210:211], v4 offset:14336
    buffer_load_dwordx4 v13, s[20:23], s80 offen offset:1024  lds
    v_mfma_f32_16x16x32_bf16 v[142:145], v[186:189], v[46:49], v[142:145]
    ds_read_b64_tr_b16 v[212:213], v4 offset:17408
    v_mfma_f32_16x16x32_bf16 v[146:149], v[190:193], v[42:45], v[146:149]
    ds_read_b64_tr_b16 v[214:215], v5 offset:14336
    v_mfma_f32_16x16x32_bf16 v[150:153], v[190:193], v[46:49], v[150:153]
    ds_read_b64_tr_b16 v[216:217], v5 offset:17408
    v_mfma_f32_16x16x32_bf16 v[154:157], v[194:197], v[42:45], v[154:157]
    ds_read_b64_tr_b16 v[186:187], v4 offset:15360
    buffer_load_dwordx4 v14, s[20:23], s80 offen offset:2048  lds
    v_mfma_f32_16x16x32_bf16 v[158:161], v[194:197], v[46:49], v[158:161]
    ds_read_b64_tr_b16 v[188:189], v4 offset:18432
    s_waitcnt lgkmcnt(6)
    v_mfma_f32_16x16x32_bf16 v[162:165], v[198:201], v[42:45], v[162:165]
    ds_read_b64_tr_b16 v[190:191], v5 offset:15360
    s_add_u32 m0, s63, 12288
    v_mfma_f32_16x16x32_bf16 v[166:169], v[198:201], v[46:49], v[166:169]
    ds_read_b64_tr_b16 v[192:193], v5 offset:18432
    s_add_u32 s80, s83, 176128
    v_mfma_f32_16x16x32_bf16 v[170:173], v[202:205], v[42:45], v[170:173]
    ds_read_b64_tr_b16 v[194:195], v4 offset:16384
    buffer_load_dwordx4 v12, s[20:23], s80 offen offset:0  lds
    v_mfma_f32_16x16x32_bf16 v[174:177], v[202:205], v[46:49], v[174:177]
    ds_read_b64_tr_b16 v[196:197], v4 offset:19456
    v_mfma_f32_16x16x32_bf16 v[178:181], v[206:209], v[42:45], v[178:181]
    ds_read_b64_tr_b16 v[198:199], v5 offset:16384
    v_mfma_f32_16x16x32_bf16 v[182:185], v[206:209], v[46:49], v[182:185]
    ds_read_b64_tr_b16 v[200:201], v5 offset:19456
    s_waitcnt vmcnt(9) lgkmcnt(6)
    v_mfma_f32_16x16x32_bf16 v[138:141], v[210:213], v[50:53], v[138:141]
    ds_read_b64_tr_b16 v[202:203], v4 offset:20480
    buffer_load_dwordx4 v13, s[20:23], s80 offen offset:1024  lds
    v_mfma_f32_16x16x32_bf16 v[142:145], v[210:213], v[54:57], v[142:145]
    ds_read_b64_tr_b16 v[204:205], v4 offset:23552
    s_lshl_b32 s68, s44, 6
    v_mfma_f32_16x16x32_bf16 v[146:149], v[214:217], v[50:53], v[146:149]
    ds_read_b64_tr_b16 v[206:207], v5 offset:20480
    s_add_u32 s68, s68, 160896
    v_mfma_f32_16x16x32_bf16 v[150:153], v[214:217], v[54:57], v[150:153]
    ds_read_b64_tr_b16 v[208:209], v5 offset:23552
    v_add_u32 v40, s68, v32
    v_mfma_f32_16x16x32_bf16 v[154:157], v[186:189], v[50:53], v[154:157]
    ds_read_b64_tr_b16 v[210:211], v4 offset:21504
    buffer_load_dwordx4 v14, s[20:23], s80 offen offset:2048  lds
    v_mfma_f32_16x16x32_bf16 v[158:161], v[186:189], v[54:57], v[158:161]
    ds_read_b64_tr_b16 v[212:213], v4 offset:24576
    s_waitcnt lgkmcnt(6)
    v_mfma_f32_16x16x32_bf16 v[162:165], v[190:193], v[50:53], v[162:165]
    ds_read_b64_tr_b16 v[214:215], v5 offset:21504
    s_add_u32 m0, s63, 24576
    v_mfma_f32_16x16x32_bf16 v[166:169], v[190:193], v[54:57], v[166:169]
    ds_read_b64_tr_b16 v[216:217], v5 offset:24576
    s_add_u32 s80, s83, 352256
    v_mfma_f32_16x16x32_bf16 v[170:173], v[194:197], v[50:53], v[170:173]
    ds_read_b64_tr_b16 v[186:187], v4 offset:22528
    buffer_load_dwordx4 v12, s[20:23], s80 offen offset:0  lds
    v_mfma_f32_16x16x32_bf16 v[174:177], v[194:197], v[54:57], v[174:177]
    ds_read_b64_tr_b16 v[188:189], v4 offset:25600
    ds_read_b128 v[228:231], v40
    v_mfma_f32_16x16x32_bf16 v[178:181], v[198:201], v[50:53], v[178:181]
    ds_read_b64_tr_b16 v[190:191], v5 offset:22528
    v_mfma_f32_16x16x32_bf16 v[182:185], v[198:201], v[54:57], v[182:185]
    ds_read_b64_tr_b16 v[192:193], v5 offset:25600
    s_waitcnt vmcnt(6)
    v_cmp_gt_u32 vcc, s62, v38
    s_cbranch_vccnz L_fb_65
L_ok_64:
    buffer_load_dwordx4 v13, s[20:23], s80 offen offset:1024  lds
    buffer_load_dwordx4 v14, s[20:23], s80 offen offset:2048  lds
    s_waitcnt lgkmcnt(7)
    v_mfma_f32_16x16x32_bf16 v[138:141], v[202:205], v[58:61], v[138:141]
    ds_read_b64_tr_b16 v[194:195], v4 offset:26624
    buffer_load_dwordx2 v[224:225], v41, s[40:43], s71 offen offset:0 sc1
    buffer_load_dwordx2 v[226:227], v41, s[40:43], s71 offen offset:128 sc1
    v_mfma_f32_16x16x32_bf16 v[142:145], v[202:205], v[62:65], v[142:145]
    ds_read_b64_tr_b16 v[196:197], v4 offset:29696
    s_add_u32 m0, s61, 0
    v_mfma_f32_16x16x32_bf16 v[146:149], v[206:209], v[58:61], v[146:149]
    ds_read_b64_tr_b16 v[198:199], v5 offset:26624
    v_mfma_f32_16x16x32_bf16 v[150:153], v[206:209], v[62:65], v[150:153]
    ds_read_b64_tr_b16 v[200:201], v5 offset:29696
    v_mfma_f32_16x16x32_bf16 v[154:157], v[210:213], v[58:61], v[154:157]
    ds_read_b64_tr_b16 v[202:203], v4 offset:27648
    buffer_load_dwordx4 v241, s[40:43], s66 offen offset:0 sc1 lds
    v_mfma_f32_16x16x32_bf16 v[158:161], v[210:213], v[62:65], v[158:161]
    ds_read_b64_tr_b16 v[204:205], v4 offset:30720
    s_waitcnt lgkmcnt(6)
    v_mfma_f32_16x16x32_bf16 v[162:165], v[214:217], v[58:61], v[162:165]
    ds_read_b64_tr_b16 v[206:207], v5 offset:27648
    v_mfma_f32_16x16x32_bf16 v[166:169], v[214:217], v[62:65], v[166:169]
    ds_read_b64_tr_b16 v[208:209], v5 offset:30720
    v_mfma_f32_16x16x32_bf16 v[170:173], v[186:189], v[58:61], v[170:173]
    ds_read_b64_tr_b16 v[210:211], v4 offset:28672
    buffer_load_dwordx4 v241, s[40:43], s66 offen offset:1024 sc1 lds
    v_mfma_f32_16x16x32_bf16 v[174:177], v[186:189], v[62:65], v[174:177]
    ds_read_b64_tr_b16 v[212:213], v4 offset:31744
    v_mfma_f32_16x16x32_bf16 v[178:181], v[190:193], v[58:61], v[178:181]
    ds_read_b64_tr_b16 v[214:215], v5 offset:28672
    v_mfma_f32_16x16x32_bf16 v[182:185], v[190:193], v[62:65], v[182:185]
    ds_read_b64_tr_b16 v[216:217], v5 offset:31744
    s_waitcnt lgkmcnt(6)
    v_mfma_f32_16x16x32_bf16 v[138:141], v[194:197], v[66:69], v[138:141]
    buffer_load_dwordx4 v241, s[40:43], s66 offen offset:2048 sc1 lds
    v_mfma_f32_16x16x32_bf16 v[142:145], v[194:197], v[70:73], v[142:145]
    v_add_u32 v40, 160768, v32
    ds_read_b128 v[186:189], v40 offset:0
    v_mfma_f32_16x16x32_bf16 v[146:149], v[198:201], v[66:69], v[146:149]
    v_mfma_f32_16x16x32_bf16 v[150:153], v[198:201], v[70:73], v[150:153]
    ds_read_b128 v[190:193], v40 offset:64
    v_mfma_f32_16x16x32_bf16 v[154:157], v[202:205], v[66:69], v[154:157]
    buffer_load_dwordx4 v241, s[40:43], s66 offen offset:3072 sc1 lds
    s_add_u32 m0, s63, 36864
    v_mfma_f32_16x16x32_bf16 v[158:161], v[202:205], v[70:73], v[158:161]
    s_add_u32 s80, s83, 528384
    ds_read_b128 v[194:197], v40 offset:128
    s_waitcnt lgkmcnt(3)
    v_mfma_f32_16x16x32_bf16 v[162:165], v[206:209], v[66:69], v[162:165]
    v_mfma_f32_16x16x32_bf16 v[166:169], v[206:209], v[70:73], v[166:169]
    ds_read_b128 v[198:201], v40 offset:192
    v_mfma_f32_16x16x32_bf16 v[170:173], v[210:213], v[66:69], v[170:173]
    buffer_load_dwordx4 v12, s[20:23], s80 offen offset:0  lds
    v_mfma_f32_16x16x32_bf16 v[174:177], v[210:213], v[70:73], v[174:177]
    ds_read_b128 v[202:205], v40 offset:256
    v_mfma_f32_16x16x32_bf16 v[178:181], v[214:217], v[66:69], v[178:181]
    v_mfma_f32_16x16x32_bf16 v[182:185], v[214:217], v[70:73], v[182:185]
    ds_read_b128 v[206:209], v40 offset:320
    s_waitcnt lgkmcnt(5)
    v_pk_fma_f32 v[138:139], v[186:187], v[218:219], v[138:139] op_sel:[0,1,0] op_sel_hi:[1,1,1]
    v_pk_fma_f32 v[140:141], v[188:189], v[218:219], v[140:141] op_sel:[0,1,0] op_sel_hi:[1,1,1]
    v_pk_fma_f32 v[142:143], v[186:187], v[220:221], v[142:143] op_sel:[0,1,0] op_sel_hi:[1,1,1]
    v_pk_fma_f32 v[144:145], v[188:189], v[220:221], v[144:145] op_sel:[0,1,0] op_sel_hi:[1,1,1]
    s_waitcnt lgkmcnt(4)
    v_pk_fma_f32 v[146:147], v[190:191], v[218:219], v[146:147] op_sel:[0,1,0] op_sel_hi:[1,1,1]
    v_pk_fma_f32 v[148:149], v[192:193], v[218:219], v[148:149] op_sel:[0,1,0] op_sel_hi:[1,1,1]
    v_pk_fma_f32 v[150:151], v[190:191], v[220:221], v[150:151] op_sel:[0,1,0] op_sel_hi:[1,1,1]
    v_pk_fma_f32 v[152:153], v[192:193], v[220:221], v[152:153] op_sel:[0,1,0] op_sel_hi:[1,1,1]
    s_waitcnt lgkmcnt(3)
    v_pk_fma_f32 v[154:155], v[194:195], v[218:219], v[154:155] op_sel:[0,1,0] op_sel_hi:[1,1,1]
    v_pk_fma_f32 v[156:157], v[196:197], v[218:219], v[156:157] op_sel:[0,1,0] op_sel_hi:[1,1,1]
    v_pk_fma_f32 v[158:159], v[194:195], v[220:221], v[158:159] op_sel:[0,1,0] op_sel_hi:[1,1,1]
    v_pk_fma_f32 v[160:161], v[196:197], v[220:221], v[160:161] op_sel:[0,1,0] op_sel_hi:[1,1,1]
    s_waitcnt lgkmcnt(2)
    v_pk_fma_f32 v[162:163], v[198:199], v[218:219], v[162:163] op_sel:[0,1,0] op_sel_hi:[1,1,1]
    v_pk_fma_f32 v[164:165], v[200:201], v[218:219], v[164:165] op_sel:[0,1,0] op_sel_hi:[1,1,1]
    v_pk_fma_f32 v[166:167], v[198:199], v[220:221], v[166:167] op_sel:[0,1,0] op_sel_hi:[1,1,1]
    v_pk_fma_f32 v[168:169], v[200:201], v[220:221], v[168:169] op_sel:[0,1,0] op_sel_hi:[1,1,1]
    s_waitcnt lgkmcnt(1)
    v_pk_fma_f32 v[170:171], v[202:203], v[218:219], v[170:171] op_sel:[0,1,0] op_sel_hi:[1,1,1]
    v_pk_fma_f32 v[172:173], v[204:205], v[218:219], v[172:173] op_sel:[0,1,0] op_sel_hi:[1,1,1]
    v_pk_fma_f32 v[174:175], v[202:203], v[220:221], v[174:175] op_sel:[0,1,0] op_sel_hi:[1,1,1]
    v_pk_fma_f32 v[176:177], v[204:205], v[220:221], v[176:177] op_sel:[0,1,0] op_sel_hi:[1,1,1]
    s_waitcnt lgkmcnt(0)
    v_pk_fma_f32 v[178:179], v[206:207], v[218:219], v[178:179] op_sel:[0,1,0] op_sel_hi:[1,1,1]
    v_pk_fma_f32 v[180:181], v[208:209], v[218:219], v[180:181] op_sel:[0,1,0] op_sel_hi:[1,1,1]
    v_pk_fma_f32 v[182:183], v[206:207], v[220:221], v[182:183] op_sel:[0,1,0] op_sel_hi:[1,1,1]
    v_pk_fma_f32 v[184:185], v[208:209], v[220:221], v[184:185] op_sel:[0,1,0] op_sel_hi:[1,1,1]
    v_cvt_pk_bf16_f32 v54, v138, v139
    v_cvt_pk_bf16_f32 v55, v140, v141
    v_cvt_pk_bf16_f32 v56, v142, v143
    v_cvt_pk_bf16_f32 v57, v144, v145
    v_cvt_pk_bf16_f32 v58, v146, v147
    v_cvt_pk_bf16_f32 v59, v148, v149
    v_cvt_pk_bf16_f32 v60, v150, v151
    v_cvt_pk_bf16_f32 v61, v152, v153
    v_pk_mul_f32 v[154:155], v[154:155], v[218:219] op_sel_hi:[1,0]
    v_pk_mul_f32 v[156:157], v[156:157], v[218:219] op_sel_hi:[1,0]
    v_cvt_pk_bf16_f32 v44, v154, v155
    v_cvt_pk_bf16_f32 v45, v156, v157
    v_pk_mul_f32 v[158:159], v[158:159], v[220:221] op_sel_hi:[1,0]
    v_pk_mul_f32 v[160:161], v[160:161], v[220:221] op_sel_hi:[1,0]
    v_cvt_pk_bf16_f32 v46, v158, v159
    v_cvt_pk_bf16_f32 v47, v160, v161
    ds_write_b64 v232, v[46:47] offset:0
    v_pk_mul_f32 v[162:163], v[162:163], v[218:219] op_sel_hi:[1,0]
    v_pk_mul_f32 v[164:165], v[164:165], v[218:219] op_sel_hi:[1,0]
    v_cvt_pk_bf16_f32 v50, v162, v163
    v_cvt_pk_bf16_f32 v51, v164, v165
    v_pk_mul_f32 v[166:167], v[166:167], v[220:221] op_sel_hi:[1,0]
    v_pk_mul_f32 v[168:169], v[168:169], v[220:221] op_sel_hi:[1,0]
    v_cvt_pk_bf16_f32 v52, v166, v167
    v_cvt_pk_bf16_f32 v53, v168, v169
    ds_write_b64 v232, v[52:53] offset:512
    v_pk_mul_f32 v[170:171], v[170:171], v[218:219] op_sel_hi:[1,0]
    v_pk_mul_f32 v[172:173], v[172:173], v[218:219] op_sel_hi:[1,0]
    v_pk_mul_f32 v[174:175], v[174:175], v[220:221] op_sel_hi:[1,0]
    v_pk_mul_f32 v[176:177], v[176:177], v[220:221] op_sel_hi:[1,0]
    v_pk_mul_f32 v[178:179], v[178:179], v[218:219] op_sel_hi:[1,0]
    v_pk_mul_f32 v[180:181], v[180:181], v[218:219] op_sel_hi:[1,0]
    v_pk_mul_f32 v[182:183], v[182:183], v[220:221] op_sel_hi:[1,0]
    v_pk_mul_f32 v[184:185], v[184:185], v[220:221] op_sel_hi:[1,0]
    v_mfma_f32_16x16x16_bf16 v[138:141], v[46:47], v[56:57], v[242:245]
    v_cvt_pk_bf16_f32 v170, v170, v171
    v_cvt_pk_bf16_f32 v171, v172, v173
    v_mfma_f32_16x16x16_bf16 v[142:145], v[44:45], v[56:57], v[246:249]
    ds_write_b64 v232, v[170:171] offset:2048
    v_cvt_pk_bf16_f32 v174, v174, v175
    v_mfma_f32_16x16x16_bf16 v[146:149], v[52:53], v[60:61], v[242:245]
    v_cvt_pk_bf16_f32 v175, v176, v177
    ds_write_b64 v232, v[174:175] offset:1024
    v_mfma_f32_16x16x16_bf16 v[150:153], v[50:51], v[60:61], v[246:249]
    v_cvt_pk_bf16_f32 v178, v178, v179
    v_cvt_pk_bf16_f32 v179, v180, v181
    v_mfma_f32_16x16x16_bf16 v[154:157], v[44:45], v[54:55], v[242:245]
    ds_write_b64 v232, v[178:179] offset:2560
    v_cvt_pk_bf16_f32 v182, v182, v183
    v_mfma_f32_16x16x16_bf16 v[162:165], v[50:51], v[58:59], v[242:245]
    v_cvt_pk_bf16_f32 v183, v184, v185
    ds_write_b64 v232, v[182:183] offset:1536
    ds_read_b64_tr_b16 v[66:67], v235 offset:1024
    ds_read_b64_tr_b16 v[64:65], v235 offset:2048
    ds_read_b64_tr_b16 v[72:73], v235 offset:1536
    ds_read_b64_tr_b16 v[70:71], v235 offset:2560
    v_mul_f32 v40, 0x3eb8aa3b, v218
    v_mul_f32 v41, 0x3eb8aa3b, v220
    v_add_u32 v240, 98304, v1
    v_max_f32 v138, v138, v142
    v_max_f32 v139, v139, v143
    v_max_f32 v140, v140, v144
    v_max_f32 v141, v141, v145
    v_max_f32 v146, v146, v150
    v_max_f32 v147, v147, v151
    v_max_f32 v148, v148, v152
    v_max_f32_e64 v149, v149, v153
    v_max3_f32 v142, v138, v139, v140
    v_max3_f32 v143, v146, v147, v148
    v_max_f32 v142, v142, v141
    v_max_f32 v143, v143, v149
    s_mul_i32 s67, s44, 90112
    s_lshl_b32 s68, s46, 10
    v_permlane16_swap_b32 v142, v143
    v_max_f32 v150, v142, v143
    v_max_f32 v142, v142, v143
    s_add_u32 s67, s67, s68
    s_add_u32 s67, s67, s51
    v_permlane32_swap_b32 v142, v150
    v_max_f32 v142, v142, v150
    v_mul_f32 v143, v142, v41
    v_mul_f32 v142, v142, v41
    s_add_u32 s67, s67, 163840
    s_add_u32 s68, s67, 45056
    v_permlane16_swap_b32 v142, v143
    v_pk_fma_f32 v[138:139], v[138:139], v[40:41], v[142:143] op_sel:[0,1,0] op_sel_hi:[1,1,0] neg_lo:[0,0,1] neg_hi:[0,0,1]
    v_pk_fma_f32 v[140:141], v[140:141], v[40:41], v[142:143] op_sel:[0,1,0] op_sel_hi:[1,1,0] neg_lo:[0,0,1] neg_hi:[0,0,1]
    v_pk_fma_f32 v[146:147], v[146:147], v[40:41], v[142:143] op_sel:[0,1,1] op_sel_hi:[1,1,1] neg_lo:[0,0,1] neg_hi:[0,0,1]
    v_pk_fma_f32 v[148:149], v[148:149], v[40:41], v[142:143] op_sel:[0,1,1] op_sel_hi:[1,1,1] neg_lo:[0,0,1] neg_hi:[0,0,1]
    s_waitcnt vmcnt(1)
    s_barrier
    ds_read_b128 v[186:189], v240 offset:0
    ds_read_b128 v[190:193], v240 offset:1024
    ds_read_b128 v[194:197], v240 offset:2048
    ds_read_b128 v[198:201], v240 offset:3072
    ds_read_b128 v[202:205], v240 offset:12288
    ds_read_b128 v[206:209], v240 offset:13312
    v_add_f32 v222, v224, v226
    v_add_f32 v223, v225, v227
    v_exp_f32 v138, v138
    v_exp_f32 v139, v139
    v_exp_f32 v140, v140
    v_exp_f32 v141, v141
    v_exp_f32 v146, v146
    v_exp_f32 v147, v147
    v_exp_f32 v148, v148
    v_exp_f32 v149, v149
    s_waitcnt lgkmcnt(4)
    v_mfma_f32_16x16x32_bf16 v[224:227], a[240:243], v[186:189], 0
    ds_read_b128 v[210:213], v240 offset:14336
    v_cvt_pk_bf16_f32 v138, v138, v139
    v_mfma_f32_16x16x32_bf16 v[224:227], a[244:247], v[190:193], v[224:227]
    ds_read_b128 v[214:217], v240 offset:15360
    buffer_load_dwordx4 v13, s[20:23], s80 offen offset:1024  lds
    s_waitcnt lgkmcnt(4)
    v_mfma_f32_16x16x32_bf16 v[224:227], a[248:251], v[194:197], v[224:227]
    ds_read_b128 v[186:189], v240 offset:24576
    v_permlane16_swap_b32 v222, v223
    v_mfma_f32_16x16x32_bf16 v[224:227], a[252:255], v[198:201], v[224:227]
    ds_read_b128 v[190:193], v240 offset:25600
    v_cvt_pk_bf16_f32 v139, v140, v141
    s_waitcnt lgkmcnt(4)
    v_mfma_f32_16x16x32_bf16 v[224:227], v[90:93], v[202:205], v[224:227]
    ds_read_b128 v[194:197], v240 offset:26624
    v_add_f32 v222, v222, v223
    v_mfma_f32_16x16x32_bf16 v[224:227], v[94:97], v[206:209], v[224:227]
    ds_read_b128 v[198:201], v240 offset:27648
    v_and_b32 v142, v254, v138
    s_waitcnt lgkmcnt(4)
    v_mfma_f32_16x16x32_bf16 v[224:227], v[98:101], v[210:213], v[224:227]
    ds_read_b128 v[202:205], v240 offset:36864
    buffer_load_dwordx4 v14, s[20:23], s80 offen offset:2048  lds
    v_mfma_f32_16x16x32_bf16 v[224:227], v[102:105], v[214:217], v[224:227]
    ds_read_b128 v[206:209], v240 offset:37888
    v_mov_b32 v36, v222
    s_waitcnt lgkmcnt(4)
    v_mfma_f32_16x16x32_bf16 v[224:227], v[106:109], v[186:189], v[224:227]
    ds_read_b128 v[210:213], v240 offset:38912
    v_bfi_b32 v144, v254, 0, v138
    v_mfma_f32_16x16x32_bf16 v[224:227], v[110:113], v[190:193], v[224:227]
    ds_read_b128 v[214:217], v240 offset:39936
    v_permlane32_swap_b32 v222, v36
    s_waitcnt lgkmcnt(4)
    v_mfma_f32_16x16x32_bf16 v[224:227], v[114:117], v[194:197], v[224:227]
    v_and_b32 v143, v255, v139
    v_add_f32 v222, v222, v36
    v_mfma_f32_16x16x32_bf16 v[224:227], v[118:121], v[198:201], v[224:227]
    s_add_u32 m0, s63, 49152
    s_add_u32 s80, s83, 704512
    buffer_load_dwordx4 v12, s[20:23], s80 offen offset:0  lds
    s_waitcnt lgkmcnt(2)
    v_mfma_f32_16x16x32_bf16 v[224:227], v[122:125], v[202:205], v[224:227]
    v_bfi_b32 v145, v255, 0, v139
    v_mul_f32 v222, s84, v222
    v_mfma_f32_16x16x32_bf16 v[224:227], v[126:129], v[206:209], v[224:227]
    v_cvt_pk_bf16_f32 v146, v146, v147
    v_mov_b32 v223, v222
    s_waitcnt lgkmcnt(0)
    v_mfma_f32_16x16x32_bf16 v[224:227], v[130:133], v[210:213], v[224:227]
    v_cvt_pk_bf16_f32 v147, v148, v149
    v_permlane16_swap_b32 v222, v223
    v_mfma_f32_16x16x32_bf16 v[224:227], v[134:137], v[214:217], v[224:227]
    v_and_b32 v150, v254, v146
    v_fma_f32 v36, -v222, v222, v223
    v_bfi_b32 v152, v254, 0, v146
    v_max_f32 v36, 0, v36
    v_and_b32 v151, v255, v147
    v_add_f32 v36, 0x3727c5ac, v36
    v_bfi_b32 v153, v255, 0, v147
    v_sub_f32 v223, 0, v222
    s_nop 0
    v_rsq_f32_e64 v222, v36
    v_mfma_f32_16x16x32_bf16 v[174:177], v[16:19], v[142:145], 0
    v_mfma_f32_16x16x32_bf16 v[182:185], v[16:19], v[150:153], 0
    v_mfma_f32_16x16x32_bf16 v[170:173], v[64:67], v[142:145], 0
    v_mfma_f32_16x16x32_bf16 v[178:181], v[70:73], v[150:153], 0
    v_fmac_f32 v224, v228, v223
    v_fmac_f32 v225, v229, v223
    v_fmac_f32 v226, v230, v223
    v_fmac_f32 v227, v231, v223
    buffer_load_dwordx4 v13, s[20:23], s80 offen offset:1024  lds
    v_mul_f32 v224, v224, v222
    v_mul_f32 v225, v225, v222
    v_mul_f32 v226, v226, v222
    v_mul_f32 v227, v227, v222
    v_cvt_pk_bf16_f32 v224, v224, v225
    v_cvt_pk_bf16_f32 v225, v226, v227
    ds_write_b64 v233, v[224:225]
    v_rcp_f32 v174, v174
    v_rcp_f32 v182, v182
    v_pk_mul_f32 v[170:171], v[170:171], v[174:175] op_sel_hi:[1,0]
    v_pk_mul_f32 v[172:173], v[172:173], v[174:175] op_sel_hi:[1,0]
    v_pk_mul_f32 v[178:179], v[178:179], v[182:183] op_sel_hi:[1,0]
    buffer_load_dwordx4 v14, s[20:23], s80 offen offset:2048  lds
    v_pk_mul_f32 v[180:181], v[180:181], v[182:183] op_sel_hi:[1,0]
    v_cvt_pk_bf16_f32 v78, v170, v171
    v_cvt_pk_bf16_f32 v79, v172, v173
    v_cvt_pk_bf16_f32 v80, v178, v179
    v_cvt_pk_bf16_f32 v81, v180, v181
    s_cmp_lg_u32 s53, 0
    s_cbranch_scc1 L_slow_66
    buffer_store_dwordx4 v[78:81], v1, s[40:43], s68 offen
L_st_67:
    s_waitcnt lgkmcnt(0)
    s_barrier
    ds_read_b64 v[42:43], v234 offset:0
    ds_read_b64 v[48:49], v234 offset:512
    ds_read_b64_tr_b16 v[62:63], v236 offset:1024
    ds_read_b64_tr_b16 v[68:69], v236 offset:1536
    s_mul_i32 s64, s44, 4096
    s_add_u32 s64, s64, s51
    v_permlane16_swap_b32 v20, v22
    v_permlane16_swap_b32 v21, v23
    v_permlane16_swap_b32 v24, v26
    v_permlane16_swap_b32 v25, v27
    s_mov_b32 s50, s51
    s_add_u32 s51, s51, s52
    v_add_u32 v219, s61, v1
    s_lshl_b32 s69, s6, 14
    s_lshl_b32 s70, s48, 11
    s_add_u32 s69, s69, s70
    s_add_u32 s69, s69, s51
    s_lshl_b32 s70, s6, 10
    s_add_u32 s70, s70, s7
    s_add_u32 s70, s70, s51
    s_add_u32 s70, s70, 131072
    v_bfe_u32 v220, v0, 4, 1
    s_waitcnt lgkmcnt(2)
    v_mfma_f32_16x16x16_bf16 v[158:161], v[42:43], v[54:55], v[250:253]
    v_mfma_f32_16x16x16_bf16 v[166:169], v[48:49], v[58:59], v[250:253]
    v_lshrrev_b32 v221, 5, v0
    v_lshl_or_b32 v220, v220, 1, v221
    v_lshlrev_b32 v221, 2, v15
    v_lshl_or_b32 v220, v220, 8, v221
    s_add_u32 m0, s63, 61440
    s_add_u32 s80, s83, 880640
    buffer_load_dwordx4 v12, s[20:23], s80 offen offset:0  lds
    v_max_f32 v154, v154, v158
    v_max_f32 v155, v155, v159
    v_max_f32 v156, v156, v160
    v_max_f32 v157, v157, v161
    v_max_f32 v162, v162, v166
    v_max_f32 v163, v163, v167
    v_max_f32 v164, v164, v168
    v_max_f32 v165, v165, v169
    v_max3_f32 v158, v154, v155, v156
    v_max3_f32 v159, v162, v163, v164
    v_max_f32 v158, v158, v157
    buffer_load_dwordx4 v13, s[20:23], s80 offen offset:1024  lds
    v_max_f32 v159, v159, v165
    s_nop 1
    v_permlane16_swap_b32 v158, v159
    v_max_f32 v166, v158, v159
    v_max_f32 v158, v158, v159
    s_nop 1
    v_permlane32_swap_b32 v158, v166
    v_max_f32 v158, v158, v166
    v_mul_f32 v159, v158, v40
    v_mul_f32 v158, v158, v40
    s_nop 1
    v_permlane16_swap_b32 v158, v159
    v_pk_fma_f32 v[154:155], v[154:155], v[40:41], v[158:159] op_sel:[0,0,0] op_sel_hi:[1,0,0] neg_lo:[0,0,1] neg_hi:[0,0,1]
    v_pk_fma_f32 v[156:157], v[156:157], v[40:41], v[158:159] op_sel:[0,0,0] op_sel_hi:[1,0,0] neg_lo:[0,0,1] neg_hi:[0,0,1]
    v_pk_fma_f32 v[162:163], v[162:163], v[40:41], v[158:159] op_sel:[0,0,1] op_sel_hi:[1,0,1] neg_lo:[0,0,1] neg_hi:[0,0,1]
    v_pk_fma_f32 v[164:165], v[164:165], v[40:41], v[158:159] op_sel:[0,0,1] op_sel_hi:[1,0,1] neg_lo:[0,0,1] neg_hi:[0,0,1]
    v_exp_f32 v154, v154
    buffer_load_dwordx4 v14, s[20:23], s80 offen offset:2048  lds
    v_exp_f32 v155, v155
    v_exp_f32 v156, v156
    v_exp_f32 v157, v157
    v_exp_f32 v162, v162
    v_exp_f32 v163, v163
    v_exp_f32 v164, v164
    v_exp_f32_e64 v165, v165
    v_cvt_pk_bf16_f32 v154, v154, v155
    v_cvt_pk_bf16_f32 v155, v156, v157
    v_and_b32 v158, v254, v154
    v_bfi_b32 v160, v254, 0, v154
    v_and_b32 v159, v255, v155
    v_bfi_b32 v161, v255, 0, v155
    v_cvt_pk_bf16_f32 v162, v162, v163
    v_cvt_pk_bf16_f32 v163, v164, v165
    v_and_b32 v166, v254, v162
    v_bfi_b32 v168, v254, 0, v162
    v_and_b32 v167, v255, v163
    v_bfi_b32 v169, v255, 0, v163
    s_waitcnt lgkmcnt(0)
    v_mfma_f32_16x16x32_bf16 v[174:177], v[16:19], v[158:161], 0
    v_mfma_f32_16x16x32_bf16 v[182:185], v[16:19], v[166:169], 0
    v_mfma_f32_16x16x32_bf16 v[170:173], v[62:65], v[158:161], 0
    v_mfma_f32_16x16x32_bf16 v[178:181], v[68:71], v[166:169], 0
    s_nop 4
    v_rcp_f32 v174, v174
    v_rcp_f32 v182, v182
    v_pk_mul_f32 v[170:171], v[170:171], v[174:175] op_sel_hi:[1,0]
    v_pk_mul_f32 v[172:173], v[172:173], v[174:175] op_sel_hi:[1,0]
    v_pk_mul_f32 v[178:179], v[178:179], v[182:183] op_sel_hi:[1,0]
    v_pk_mul_f32 v[180:181], v[180:181], v[182:183] op_sel_hi:[1,0]
    v_cvt_pk_bf16_f32 v74, v170, v171
    v_cvt_pk_bf16_f32 v75, v172, v173
    v_cvt_pk_bf16_f32 v76, v178, v179
    v_cvt_pk_bf16_f32 v77, v180, v181
    s_cmp_lg_u32 s53, 0
    s_cbranch_scc1 L_slow_68
    buffer_store_dwordx4 v[74:77], v1, s[40:43], s67 offen
L_st_69:
    v_mov_b32 v36, 10
    s_waitcnt vmcnt(0)
    s_cmp_lg_u32 s53, 0
    s_cbranch_scc1 L_slow_70
    buffer_store_dword v36, v28, s[40:43], s54 offen
L_st_71:
    buffer_load_dword v38, v30, s[40:43], s56 offen sc1
    v_add_u32 v39, s12, v1
    v_add_u32 v40, s13, v1
    v_add_u32 v41, s14, v1
    v_lshlrev_b32 v154, 16, v20
    v_and_b32 v155, 0xffff0000, v20
    v_lshlrev_b32 v156, 16, v21
    v_and_b32 v157, 0xffff0000, v21
    v_lshlrev_b32 v158, 16, v22
    v_and_b32 v159, 0xffff0000, v22
    v_lshlrev_b32_e64 v160, 16, v23
    v_and_b32 v161, 0xffff0000, v23
    v_lshlrev_b32 v162, 16, v24
    v_and_b32 v163, 0xffff0000, v24
    v_lshlrev_b32 v164, 16, v25
    v_and_b32 v165, 0xffff0000, v25
    v_lshlrev_b32 v166, 16, v26
    v_and_b32 v167, 0xffff0000, v26
    v_lshlrev_b32 v168, 16, v27
    v_and_b32 v169, 0xffff0000, v27
    s_mov_b32 s85, 0
L_poll_72:
    buffer_load_dword v37, v30, s[40:43], s56 offen sc1
    s_add_u32 s85, s85, 1
    s_cmp_lt_u32 s85, 131072
    s_cbranch_scc0 L_got_73
    s_waitcnt vmcnt(1)
    v_cmp_gt_u32 vcc, 10, v38
    s_cbranch_vccz L_got_73
    buffer_load_dword v38, v30, s[40:43], s56 offen sc1
    s_waitcnt vmcnt(1)
    v_cmp_gt_u32 vcc, 10, v37
    s_cbranch_vccnz L_poll_72
L_got_73:
    s_add_u32 s68, s8, s64
    buffer_load_dwordx4 v[42:45], v1, s[40:43], s68 offen offset:0 sc1
    buffer_load_dwordx4 v[46:49], v1, s[40:43], s68 offen offset:1024 sc1
    buffer_load_dwordx4 v[50:53], v1, s[40:43], s68 offen offset:2048 sc1
    buffer_load_dwordx4 v[54:57], v1, s[40:43], s68 offen offset:3072 sc1
    s_add_u32 s68, s9, s64
    buffer_load_dwordx4 v[58:61], v1, s[40:43], s68 offen offset:0 sc1
    buffer_load_dwordx4 v[62:65], v1, s[40:43], s68 offen offset:1024 sc1
    s_waitcnt vmcnt(5)
    v_mfma_f32_16x16x32_bf16 v[106:109], a[0:3], v[42:45], 0
    buffer_load_dwordx4 v[66:69], v1, s[40:43], s68 offen offset:2048 sc1
    v_mfma_f32_16x16x32_bf16 v[110:113], a[4:7], v[42:45], 0
    v_mfma_f32_16x16x32_bf16 v[114:117], a[8:11], v[42:45], 0
    v_mfma_f32_16x16x32_bf16 v[118:121], a[12:15], v[42:45], 0
    s_waitcnt vmcnt(5)
    v_mfma_f32_16x16x32_bf16 v[106:109], a[16:19], v[46:49], v[106:109]
    buffer_load_dwordx4 v[70:73], v1, s[40:43], s68 offen offset:3072 sc1
    v_mfma_f32_16x16x32_bf16 v[110:113], a[20:23], v[46:49], v[110:113]
    v_mfma_f32_16x16x32_bf16 v[114:117], a[24:27], v[46:49], v[114:117]
    v_mfma_f32_16x16x32_bf16 v[118:121], a[28:31], v[46:49], v[118:121]
    s_waitcnt vmcnt(5)
    v_mfma_f32_16x16x32_bf16 v[106:109], a[32:35], v[50:53], v[106:109]
    s_add_u32 s68, s10, s64
    buffer_load_dwordx4 v[74:77], v1, s[40:43], s68 offen offset:0 sc1
    v_mfma_f32_16x16x32_bf16 v[110:113], a[36:39], v[50:53], v[110:113]
    v_mfma_f32_16x16x32_bf16 v[114:117], a[40:43], v[50:53], v[114:117]
    v_mfma_f32_16x16x32_bf16 v[118:121], a[44:47], v[50:53], v[118:121]
    s_waitcnt vmcnt(5)
    v_mfma_f32_16x16x32_bf16 v[106:109], a[48:51], v[54:57], v[106:109]
    buffer_load_dwordx4 v[78:81], v1, s[40:43], s68 offen offset:1024 sc1
    v_mfma_f32_16x16x32_bf16 v[110:113], a[52:55], v[54:57], v[110:113]
    v_mfma_f32_16x16x32_bf16 v[114:117], a[56:59], v[54:57], v[114:117]
    v_mfma_f32_16x16x32_bf16 v[118:121], a[60:63], v[54:57], v[118:121]
    s_waitcnt vmcnt(5)
    v_mfma_f32_16x16x32_bf16 v[122:125], a[0:3], v[58:61], 0
    buffer_load_dwordx4 v[82:85], v1, s[40:43], s68 offen offset:2048 sc1
    v_mfma_f32_16x16x32_bf16 v[126:129], a[4:7], v[58:61], 0
    v_mfma_f32_16x16x32_bf16 v[130:133], a[8:11], v[58:61], 0
    ds_write_b128 v39, v[106:109] offset:0
    v_mfma_f32_16x16x32_bf16 v[134:137], a[12:15], v[58:61], 0
    s_waitcnt vmcnt(5)
    v_mfma_f32_16x16x32_bf16 v[122:125], a[16:19], v[62:65], v[122:125]
    buffer_load_dwordx4 v[86:89], v1, s[40:43], s68 offen offset:3072 sc1
    v_mfma_f32_16x16x32_bf16 v[126:129], a[20:23], v[62:65], v[126:129]
    ds_write_b128 v39, v[110:113] offset:1024
    v_mfma_f32_16x16x32_bf16 v[130:133], a[24:27], v[62:65], v[130:133]
    v_mfma_f32_16x16x32_bf16 v[134:137], a[28:31], v[62:65], v[134:137]
    s_waitcnt vmcnt(5)
    v_mfma_f32_16x16x32_bf16 v[122:125], a[32:35], v[66:69], v[122:125]
    s_add_u32 s68, s11, s64
    buffer_load_dwordx4 v[90:93], v1, s[40:43], s68 offen offset:0 sc1
    v_mfma_f32_16x16x32_bf16 v[126:129], a[36:39], v[66:69], v[126:129]
    ds_write_b128 v39, v[114:117] offset:2048
    v_mfma_f32_16x16x32_bf16 v[130:133], a[40:43], v[66:69], v[130:133]
    v_mfma_f32_16x16x32_bf16 v[134:137], a[44:47], v[66:69], v[134:137]
    s_waitcnt vmcnt(5)
    v_mfma_f32_16x16x32_bf16 v[122:125], a[48:51], v[70:73], v[122:125]
    buffer_load_dwordx4 v[94:97], v1, s[40:43], s68 offen offset:1024 sc1
    v_mfma_f32_16x16x32_bf16 v[126:129], a[52:55], v[70:73], v[126:129]
    ds_write_b128 v39, v[118:121] offset:3072
    v_mfma_f32_16x16x32_bf16 v[130:133], a[56:59], v[70:73], v[130:133]
    v_mfma_f32_16x16x32_bf16 v[134:137], a[60:63], v[70:73], v[134:137]
    s_waitcnt vmcnt(5)
    v_mfma_f32_16x16x32_bf16 v[138:141], a[0:3], v[74:77], 0
    buffer_load_dwordx4 v[98:101], v1, s[40:43], s68 offen offset:2048 sc1
    v_mfma_f32_16x16x32_bf16 v[142:145], a[4:7], v[74:77], 0
    v_mfma_f32_16x16x32_bf16 v[146:149], a[8:11], v[74:77], 0
    ds_write_b128 v40, v[122:125] offset:0
    v_mfma_f32_16x16x32_bf16 v[150:153], a[12:15], v[74:77], 0
    s_waitcnt vmcnt(5)
    v_mfma_f32_16x16x32_bf16 v[138:141], a[16:19], v[78:81], v[138:141]
    buffer_load_dwordx4 v[102:105], v1, s[40:43], s68 offen offset:3072 sc1
    v_mfma_f32_16x16x32_bf16 v[142:145], a[20:23], v[78:81], v[142:145]
    ds_write_b128 v40, v[126:129] offset:1024
    v_mfma_f32_16x16x32_bf16 v[146:149], a[24:27], v[78:81], v[146:149]
    s_add_u32 m0, s63, 73728
    s_add_u32 s80, s83, 1056768
    buffer_load_dwordx4 v12, s[20:23], s80 offen offset:0  lds
    v_mfma_f32_16x16x32_bf16 v[150:153], a[28:31], v[78:81], v[150:153]
    s_waitcnt vmcnt(6)
    v_mfma_f32_16x16x32_bf16 v[138:141], a[32:35], v[82:85], v[138:141]
    ds_write_b128 v40, v[130:133] offset:2048
    v_mfma_f32_16x16x32_bf16 v[142:145], a[36:39], v[82:85], v[142:145]
    v_mfma_f32_16x16x32_bf16 v[146:149], a[40:43], v[82:85], v[146:149]
    v_mfma_f32_16x16x32_bf16 v[150:153], a[44:47], v[82:85], v[150:153]
    ds_write_b128 v40, v[134:137] offset:3072
    s_waitcnt vmcnt(5)
    v_mfma_f32_16x16x32_bf16 v[138:141], a[48:51], v[86:89], v[138:141]
    buffer_load_dwordx4 v13, s[20:23], s80 offen offset:1024  lds
    v_mfma_f32_16x16x32_bf16 v[142:145], a[52:55], v[86:89], v[142:145]
    v_mfma_f32_16x16x32_bf16 v[146:149], a[56:59], v[86:89], v[146:149]
    v_mfma_f32_16x16x32_bf16 v[150:153], a[60:63], v[86:89], v[150:153]
    s_waitcnt vmcnt(5)
    v_mfma_f32_16x16x32_bf16 v[154:157], a[0:3], v[90:93], v[154:157]
    buffer_load_dwordx4 v14, s[20:23], s80 offen offset:2048  lds
    v_mfma_f32_16x16x32_bf16 v[158:161], a[4:7], v[90:93], v[158:161]
    v_mfma_f32_16x16x32_bf16 v[162:165], a[8:11], v[90:93], v[162:165]
    ds_write_b128 v41, v[138:141] offset:0
L_pg7:
    s_cbranch_execz L_walked1
    v_mfma_f32_16x16x32_bf16 v[166:169], a[12:15], v[90:93], v[166:169]
    s_waitcnt lgkmcnt(1)
    s_barrier
    s_waitcnt vmcnt(5)
    v_mfma_f32_16x16x32_bf16 v[154:157], a[16:19], v[94:97], v[154:157]
    ds_read_b128 v[170:173], v219 offset:0
    ds_read_b128 v[174:177], v219 offset:1024
    v_mfma_f32_16x16x32_bf16 v[158:161], a[20:23], v[94:97], v[158:161]
    ds_write_b128 v41, v[142:145] offset:1024
    v_mfma_f32_16x16x32_bf16 v[162:165], a[24:27], v[94:97], v[162:165]
    s_add_u32 m0, s63, 86016
    s_add_u32 s80, s83, 1232896
    buffer_load_dwordx4 v12, s[20:23], s80 offen offset:0  lds
    v_mfma_f32_16x16x32_bf16 v[166:169], a[28:31], v[94:97], v[166:169]
    ds_read_b128 v[178:181], v219 offset:2048
    ds_read_b128 v[182:185], v219 offset:3072
    s_waitcnt vmcnt(5)
    v_mfma_f32_16x16x32_bf16 v[154:157], a[32:35], v[98:101], v[154:157]
    ds_write_b128 v41, v[146:149] offset:2048
    v_mfma_f32_16x16x32_bf16 v[158:161], a[36:39], v[98:101], v[158:161]
    ds_read_b128 v[186:189], v219 offset:4096
    ds_read_b128 v[190:193], v219 offset:5120
    v_mfma_f32_16x16x32_bf16 v[162:165], a[40:43], v[98:101], v[162:165]
    ds_read_b128 v[194:197], v219 offset:6144
    ds_read_b128 v[198:201], v219 offset:7168
    v_mfma_f32_16x16x32_bf16 v[166:169], a[44:47], v[98:101], v[166:169]
    ds_write_b128 v41, v[150:153] offset:3072
    s_waitcnt lgkmcnt(1)
    s_waitcnt lgkmcnt(0)
    s_barrier
    s_waitcnt vmcnt(4)
    v_mfma_f32_16x16x32_bf16 v[154:157], a[48:51], v[102:105], v[154:157]
    buffer_load_dwordx4 v13, s[20:23], s80 offen offset:1024  lds
    v_mfma_f32_16x16x32_bf16 v[158:161], a[52:55], v[102:105], v[158:161]
    ds_read_b128 v[202:205], v219 offset:8192
    ds_read_b128 v[206:209], v219 offset:9216
    v_mfma_f32_16x16x32_bf16 v[162:165], a[56:59], v[102:105], v[162:165]
    ds_read_b128 v[210:213], v219 offset:10240
    ds_read_b128 v[214:217], v219 offset:11264
    v_mfma_f32_16x16x32_bf16 v[166:169], a[60:63], v[102:105], v[166:169]
    s_lshl_b32 s64, s44, 15
    s_add_u32 s64, s64, s51
    s_add_u32 s65, s64, 16384
    s_mov_b32 s78, s64
    v_lshlrev_b32_e64 v241, 10, v0
    v_pk_add_f32 v[154:155], v[154:155], v[170:171]
    v_pk_add_f32 v[156:157], v[156:157], v[172:173]
    v_pk_add_f32 v[158:159], v[158:159], v[174:175]
    v_pk_add_f32 v[160:161], v[160:161], v[176:177]
    v_pk_add_f32 v[162:163], v[162:163], v[178:179]
    v_pk_add_f32 v[164:165], v[164:165], v[180:181]
    v_pk_add_f32 v[166:167], v[166:167], v[182:183]
    v_pk_add_f32 v[168:169], v[168:169], v[184:185]
    buffer_load_dwordx4 v14, s[20:23], s80 offen offset:2048  lds
    v_pk_add_f32 v[154:155], v[154:155], v[186:187]
    v_pk_add_f32 v[156:157], v[156:157], v[188:189]
    v_pk_add_f32 v[158:159], v[158:159], v[190:191]
    v_pk_add_f32 v[160:161], v[160:161], v[192:193]
    v_pk_add_f32 v[162:163], v[162:163], v[194:195]
    v_pk_add_f32 v[164:165], v[164:165], v[196:197]
    v_pk_add_f32 v[166:167], v[166:167], v[198:199]
    v_pk_add_f32 v[168:169], v[168:169], v[200:201]
    s_waitcnt lgkmcnt(2)
    v_pk_add_f32 v[154:155], v[154:155], v[202:203]
    v_pk_add_f32 v[156:157], v[156:157], v[204:205]
    v_pk_add_f32 v[158:159], v[158:159], v[206:207]
    v_pk_add_f32 v[160:161], v[160:161], v[208:209]
    v_cvt_pk_bf16_f32 v20, v154, v155
    v_cvt_pk_bf16_f32 v21, v156, v157
    v_cvt_pk_bf16_f32 v22, v158, v159
    v_cvt_pk_bf16_f32 v23, v160, v161
    s_nop 0
    v_permlane16_swap_b32 v20, v22
    v_permlane16_swap_b32 v21, v23
    s_cmp_lg_u32 s53, 0
    s_cbranch_scc1 L_slow_74
    buffer_store_dwordx4 v[20:23], v220, s[40:43], s69 offen offset:0
L_st_75:
    s_waitcnt lgkmcnt(0)
    v_pk_add_f32 v[162:163], v[162:163], v[210:211]
    v_pk_add_f32 v[164:165], v[164:165], v[212:213]
    v_pk_add_f32 v[166:167], v[166:167], v[214:215]
    v_pk_add_f32 v[168:169], v[168:169], v[216:217]
    v_cvt_pk_bf16_f32 v24, v162, v163
    v_cvt_pk_bf16_f32 v25, v164, v165
    v_cvt_pk_bf16_f32 v26, v166, v167
    v_cvt_pk_bf16_f32 v27, v168, v169
    s_nop 0
    v_permlane16_swap_b32 v24, v26
    v_permlane16_swap_b32 v25, v27
    s_cmp_lg_u32 s53, 0
    s_cbranch_scc1 L_slow_76
    buffer_store_dwordx4 v[24:27], v220, s[40:43], s69 offen offset:1024
L_st_77:
    v_mfma_f32_16x16x32_bf16 v[110:113], v[20:23], v[20:23], 0
    v_mfma_f32_16x16x32_bf16 v[106:109], v[16:19], v[20:23], 0
    v_mfma_f32_16x16x32_bf16 v[110:113], v[24:27], v[24:27], v[110:113]
    v_mfma_f32_16x16x32_bf16 v[106:109], v[16:19], v[24:27], v[106:109]
    s_or_b64 vcc, s[90:91], s[92:93]
    s_nop 5
    v_cndmask_b32 v110, v110, v111, s[88:89]
    v_cndmask_b32 v112, v112, v113, s[92:93]
    v_cndmask_b32 v107, v110, v112, vcc
    s_mov_b64 exec, s[94:95]
    s_cmp_lg_u32 s53, 0
    s_cbranch_scc1 L_slow_78
    buffer_store_dwordx2 v[106:107], v221, s[40:43], s70 offen
L_st_79:
    s_mov_b64 exec, -1
    s_mov_b32 s50, s51
    s_add_u32 s51, s51, s52
    s_lshl_b32 s66, s44, 11
    s_add_u32 s66, s66, s50
    s_add_u32 s66, s66, 131072
    s_mul_i32 s72, s44, 90112
    s_lshl_b32 s73, s59, 10
    s_add_u32 s72, s72, s73
    s_add_u32 s72, s72, s51
    s_add_u32 s72, s72, 163840
    s_add_u32 s73, s72, 45056
    v_add_u32 v41, 159744, v32
    s_and_b32 s68, s46, 3
    s_cmp_eq_u32 s68, 3
    s_cselect_b32 s68, 0x40000000, 0
    v_add_u32 v238, s68, v1
    s_cmp_eq_u32 s46, 15
    s_cselect_b32 s68, 0x40000000, 0
    v_add_u32_e64 v239, s68, v1
    ds_read_b128 v[186:189], v41 offset:0
    ds_read_b128 v[190:193], v41 offset:64
    ds_read_b128 v[194:197], v41 offset:128
    ds_read_b128 v[198:201], v41 offset:192
    ds_read_b128 v[202:205], v41 offset:256
    ds_read_b128 v[206:209], v41 offset:320
    v_mov_b32 v36, 11
    s_waitcnt vmcnt(1)
    s_cmp_lg_u32 s53, 0
    s_cbranch_scc1 L_slow_80
    buffer_store_dword v36, v28, s[40:43], s55 offen
L_st_81:
    s_barrier
    buffer_load_dword v38, v15, s[40:43], s57 offen sc1
    ds_read_b64_tr_b16 v[154:155], v34 offset:0
    ds_read_b64_tr_b16 v[156:157], v34 offset:3072
    ds_read_b64_tr_b16 v[158:159], v35 offset:0
    ds_read_b64_tr_b16 v[160:161], v35 offset:3072
    ds_read_b64_tr_b16 v[162:163], v34 offset:64
    ds_read_b64_tr_b16 v[164:165], v34 offset:3136
    ds_read_b64_tr_b16 v[166:167], v35 offset:64
    ds_read_b64_tr_b16 v[168:169], v35 offset:3136
    ds_read_b64_tr_b16 v[170:171], v34 offset:128
    ds_read_b64_tr_b16 v[172:173], v34 offset:3200
    ds_read_b64_tr_b16 v[174:175], v35 offset:128
    ds_read_b64_tr_b16 v[176:177], v35 offset:3200
    s_mov_b32 s85, 0
L_poll_82:
    buffer_load_dword v37, v15, s[40:43], s57 offen sc1
    s_add_u32 s85, s85, 1
    s_cmp_lt_u32 s85, 131072
    s_cbranch_scc0 L_got_83
    s_waitcnt vmcnt(1)
    v_cmp_gt_u32 vcc, 11, v38
    s_cbranch_vccz L_got_83
    buffer_load_dword v38, v15, s[40:43], s57 offen sc1
    s_waitcnt vmcnt(1)
    v_cmp_gt_u32 vcc, 11, v37
    s_cbranch_vccnz L_poll_82
L_got_83:
    buffer_load_dwordx4 v[42:45], v1, s[40:43], s64 offen offset:0 sc1
    buffer_load_dwordx4 v[46:49], v1, s[40:43], s65 offen offset:0 sc1
    buffer_load_dwordx4 v[50:53], v1, s[40:43], s64 offen offset:1024 sc1
    buffer_load_dwordx4 v[54:57], v1, s[40:43], s65 offen offset:1024 sc1
    v_mov_b32 v36, 12
    s_cmp_lg_u32 s53, 0
    s_cbranch_scc1 L_slow_84
    buffer_store_dword v36, v28, s[40:43], s55 offen
L_st_85:
    s_waitcnt vmcnt(3) lgkmcnt(6)
    v_mfma_f32_16x16x32_bf16 v[106:109], v[154:157], v[42:45], 0
    ds_read_b64_tr_b16 v[178:179], v34 offset:6144
    buffer_load_dwordx4 v[58:61], v1, s[40:43], s64 offen offset:2048 sc1
    v_mfma_f32_16x16x32_bf16 v[110:113], v[154:157], v[46:49], 0
    ds_read_b64_tr_b16 v[180:181], v34 offset:9216
    v_mfma_f32_16x16x32_bf16 v[114:117], v[158:161], v[42:45], 0
    ds_read_b64_tr_b16 v[182:183], v35 offset:6144
    v_mfma_f32_16x16x32_bf16 v[118:121], v[158:161], v[46:49], 0
    ds_read_b64_tr_b16 v[184:185], v35 offset:9216
    v_mfma_f32_16x16x32_bf16 v[122:125], v[162:165], v[42:45], 0
    ds_read_b64_tr_b16 v[154:155], v34 offset:6208
    buffer_load_dwordx4 v[62:65], v1, s[40:43], s65 offen offset:2048 sc1
    v_mfma_f32_16x16x32_bf16 v[126:129], v[162:165], v[46:49], 0
    ds_read_b64_tr_b16 v[156:157], v34 offset:9280
    s_waitcnt lgkmcnt(6)
    v_mfma_f32_16x16x32_bf16 v[130:133], v[166:169], v[42:45], 0
    ds_read_b64_tr_b16 v[158:159], v35 offset:6208
    v_mfma_f32_16x16x32_bf16 v[134:137], v[166:169], v[46:49], 0
    ds_read_b64_tr_b16 v[160:161], v35 offset:9280
    v_mfma_f32_16x16x32_bf16 v[138:141], v[170:173], v[42:45], 0
    ds_read_b64_tr_b16 v[162:163], v34 offset:6272
    v_mfma_f32_16x16x32_bf16 v[142:145], v[170:173], v[46:49], 0
    ds_read_b64_tr_b16 v[164:165], v34 offset:9344
    v_mfma_f32_16x16x32_bf16 v[146:149], v[174:177], v[42:45], 0
    ds_read_b64_tr_b16 v[166:167], v35 offset:6272
    v_mfma_f32_16x16x32_bf16 v[150:153], v[174:177], v[46:49], 0
    ds_read_b64_tr_b16 v[168:169], v35 offset:9344
    s_waitcnt vmcnt(3) lgkmcnt(6)
    v_mfma_f32_16x16x32_bf16 v[106:109], v[178:181], v[50:53], v[106:109]
    ds_read_b64_tr_b16 v[170:171], v34 offset:12288
    buffer_load_dwordx4 v[66:69], v1, s[40:43], s64 offen offset:3072 sc1
    v_mfma_f32_16x16x32_bf16 v[110:113], v[178:181], v[54:57], v[110:113]
    ds_read_b64_tr_b16 v[172:173], v34 offset:15360
    v_mfma_f32_16x16x32_bf16 v[114:117], v[182:185], v[50:53], v[114:117]
    ds_read_b64_tr_b16 v[174:175], v35 offset:12288
    v_mfma_f32_16x16x32_bf16 v[118:121], v[182:185], v[54:57], v[118:121]
    ds_read_b64_tr_b16 v[176:177], v35 offset:15360
    v_mfma_f32_16x16x32_bf16 v[122:125], v[154:157], v[50:53], v[122:125]
    ds_read_b64_tr_b16 v[178:179], v34 offset:12352
    buffer_load_dwordx4 v[70:73], v1, s[40:43], s65 offen offset:3072 sc1
    v_mfma_f32_16x16x32_bf16 v[126:129], v[154:157], v[54:57], v[126:129]
    ds_read_b64_tr_b16 v[180:181], v34 offset:15424
    s_waitcnt lgkmcnt(6)
    v_mfma_f32_16x16x32_bf16 v[130:133], v[158:161], v[50:53], v[130:133]
    ds_read_b64_tr_b16 v[182:183], v35 offset:12352
    s_add_u32 s64, s64, 4096
    v_mfma_f32_16x16x32_bf16 v[134:137], v[158:161], v[54:57], v[134:137]
    ds_read_b64_tr_b16 v[184:185], v35 offset:15424
    s_add_u32 s65, s65, 4096
    v_mfma_f32_16x16x32_bf16 v[138:141], v[162:165], v[50:53], v[138:141]
    ds_read_b64_tr_b16 v[154:155], v34 offset:12416
    buffer_load_dwordx4 v[74:77], v1, s[40:43], s64 offen offset:0 sc1
    v_mfma_f32_16x16x32_bf16 v[142:145], v[162:165], v[54:57], v[142:145]
    ds_read_b64_tr_b16 v[156:157], v34 offset:15488
    v_mfma_f32_16x16x32_bf16 v[146:149], v[166:169], v[50:53], v[146:149]
    ds_read_b64_tr_b16 v[158:159], v35 offset:12416
    v_mfma_f32_16x16x32_bf16 v[150:153], v[166:169], v[54:57], v[150:153]
    ds_read_b64_tr_b16 v[160:161], v35 offset:15488
    s_waitcnt vmcnt(3) lgkmcnt(6)
    v_mfma_f32_16x16x32_bf16 v[106:109], v[170:173], v[58:61], v[106:109]
    ds_read_b64_tr_b16 v[162:163], v34 offset:18432
    buffer_load_dwordx4 v[78:81], v1, s[40:43], s65 offen offset:0 sc1
    v_mfma_f32_16x16x32_bf16 v[110:113], v[170:173], v[62:65], v[110:113]
    ds_read_b64_tr_b16 v[164:165], v34 offset:21504
    buffer_load_dword v38, v15, s[40:43], s57 offen sc1
    v_mfma_f32_16x16x32_bf16 v[114:117], v[174:177], v[58:61], v[114:117]
    ds_read_b64_tr_b16 v[166:167], v35 offset:18432
    v_mfma_f32_16x16x32_bf16 v[118:121], v[174:177], v[62:65], v[118:121]
    ds_read_b64_tr_b16 v[168:169], v35 offset:21504
    v_mfma_f32_16x16x32_bf16 v[122:125], v[178:181], v[58:61], v[122:125]
    ds_read_b64_tr_b16 v[170:171], v34 offset:18496
    buffer_load_dwordx4 v[82:85], v1, s[40:43], s64 offen offset:1024 sc1
    v_mfma_f32_16x16x32_bf16 v[126:129], v[178:181], v[62:65], v[126:129]
    ds_read_b64_tr_b16 v[172:173], v34 offset:21568
    s_waitcnt lgkmcnt(6)
    v_mfma_f32_16x16x32_bf16 v[130:133], v[182:185], v[58:61], v[130:133]
    ds_read_b64_tr_b16 v[174:175], v35 offset:18496
    v_mfma_f32_16x16x32_bf16 v[134:137], v[182:185], v[62:65], v[134:137]
    ds_read_b64_tr_b16 v[176:177], v35 offset:21568
    v_mfma_f32_16x16x32_bf16 v[138:141], v[154:157], v[58:61], v[138:141]
    ds_read_b64_tr_b16 v[178:179], v34 offset:18560
    buffer_load_dwordx4 v[86:89], v1, s[40:43], s65 offen offset:1024 sc1
    v_mfma_f32_16x16x32_bf16 v[142:145], v[154:157], v[62:65], v[142:145]
    ds_read_b64_tr_b16 v[180:181], v34 offset:21632
    v_mfma_f32_16x16x32_bf16 v[146:149], v[158:161], v[58:61], v[146:149]
    ds_read_b64_tr_b16 v[182:183], v35 offset:18560
    v_mfma_f32_16x16x32_bf16 v[150:153], v[158:161], v[62:65], v[150:153]
    ds_read_b64_tr_b16 v[184:185], v35 offset:21632
    s_waitcnt vmcnt(5) lgkmcnt(6)
    v_mfma_f32_16x16x32_bf16 v[106:109], v[162:165], v[66:69], v[106:109]
    ds_read_b64_tr_b16 v[154:155], v34 offset:24576
    buffer_load_dwordx4 v[90:93], v1, s[40:43], s64 offen offset:2048 sc1
    v_mfma_f32_16x16x32_bf16 v[110:113], v[162:165], v[70:73], v[110:113]
    ds_read_b64_tr_b16 v[156:157], v34 offset:27648
    v_mfma_f32_16x16x32_bf16 v[114:117], v[166:169], v[66:69], v[114:117]
    ds_read_b64_tr_b16 v[158:159], v35 offset:24576
    v_mfma_f32_16x16x32_bf16 v[118:121], v[166:169], v[70:73], v[118:121]
    ds_read_b64_tr_b16 v[160:161], v35 offset:27648
    v_mfma_f32_16x16x32_bf16 v[122:125], v[170:173], v[66:69], v[122:125]
    ds_read_b64_tr_b16 v[162:163], v34 offset:24640
    buffer_load_dwordx4 v[94:97], v1, s[40:43], s65 offen offset:2048 sc1
    v_mfma_f32_16x16x32_bf16 v[126:129], v[170:173], v[70:73], v[126:129]
    ds_read_b64_tr_b16 v[164:165], v34 offset:27712
    s_waitcnt lgkmcnt(6)
    v_mfma_f32_16x16x32_bf16 v[130:133], v[174:177], v[66:69], v[130:133]
    ds_read_b64_tr_b16 v[166:167], v35 offset:24640
    v_mfma_f32_16x16x32_bf16 v[134:137], v[174:177], v[70:73], v[134:137]
    ds_read_b64_tr_b16 v[168:169], v35 offset:27712
    v_mfma_f32_16x16x32_bf16 v[138:141], v[178:181], v[66:69], v[138:141]
    ds_read_b64_tr_b16 v[170:171], v34 offset:24704
    buffer_load_dwordx4 v[98:101], v1, s[40:43], s64 offen offset:3072 sc1
    v_mfma_f32_16x16x32_bf16 v[142:145], v[178:181], v[70:73], v[142:145]
    ds_read_b64_tr_b16 v[172:173], v34 offset:27776
    v_mfma_f32_16x16x32_bf16 v[146:149], v[182:185], v[66:69], v[146:149]
    ds_read_b64_tr_b16 v[174:175], v35 offset:24704
    v_mfma_f32_16x16x32_bf16 v[150:153], v[182:185], v[70:73], v[150:153]
    ds_read_b64_tr_b16 v[176:177], v35 offset:27776
    s_waitcnt vmcnt(5)
    v_cmp_gt_u32 vcc, 12, v38
    s_cbranch_vccnz L_fb_87
L_ok_86:
    s_waitcnt lgkmcnt(6)
    v_mfma_f32_16x16x32_bf16 v[106:109], v[154:157], v[74:77], v[106:109]
    ds_read_b64_tr_b16 v[178:179], v34 offset:30720
    buffer_load_dwordx4 v[102:105], v1, s[40:43], s65 offen offset:3072 sc1
    v_mfma_f32_16x16x32_bf16 v[110:113], v[154:157], v[78:81], v[110:113]
    ds_read_b64_tr_b16 v[180:181], v34 offset:33792
    s_add_u32 s64, s64, 4096
    v_mfma_f32_16x16x32_bf16 v[114:117], v[158:161], v[74:77], v[114:117]
    ds_read_b64_tr_b16 v[182:183], v35 offset:30720
    s_add_u32 s65, s65, 4096
    v_mfma_f32_16x16x32_bf16 v[118:121], v[158:161], v[78:81], v[118:121]
    ds_read_b64_tr_b16 v[184:185], v35 offset:33792
    v_mfma_f32_16x16x32_bf16 v[122:125], v[162:165], v[74:77], v[122:125]
    ds_read_b64_tr_b16 v[154:155], v34 offset:30784
    buffer_load_dwordx4 v[42:45], v1, s[40:43], s64 offen offset:0 sc1
    v_mfma_f32_16x16x32_bf16 v[126:129], v[162:165], v[78:81], v[126:129]
    ds_read_b64_tr_b16 v[156:157], v34 offset:33856
    s_waitcnt lgkmcnt(6)
    v_mfma_f32_16x16x32_bf16 v[130:133], v[166:169], v[74:77], v[130:133]
    ds_read_b64_tr_b16 v[158:159], v35 offset:30784
    v_mfma_f32_16x16x32_bf16 v[134:137], v[166:169], v[78:81], v[134:137]
    ds_read_b64_tr_b16 v[160:161], v35 offset:33856
    v_mfma_f32_16x16x32_bf16 v[138:141], v[170:173], v[74:77], v[138:141]
    ds_read_b64_tr_b16 v[162:163], v34 offset:30848
    buffer_load_dwordx4 v[46:49], v1, s[40:43], s65 offen offset:0 sc1
    v_mfma_f32_16x16x32_bf16 v[142:145], v[170:173], v[78:81], v[142:145]
    ds_read_b64_tr_b16 v[164:165], v34 offset:33920
    v_mfma_f32_16x16x32_bf16 v[146:149], v[174:177], v[74:77], v[146:149]
    ds_read_b64_tr_b16 v[166:167], v35 offset:30848
    v_mfma_f32_16x16x32_bf16 v[150:153], v[174:177], v[78:81], v[150:153]
    ds_read_b64_tr_b16 v[168:169], v35 offset:33920
    s_waitcnt vmcnt(6) lgkmcnt(6)
    v_mfma_f32_16x16x32_bf16 v[106:109], v[178:181], v[82:85], v[106:109]
    ds_read_b64_tr_b16 v[170:171], v34 offset:36864
    buffer_load_dwordx4 v[210:213], v1, s[40:43], s66 offen offset:0 sc1
    v_mfma_f32_16x16x32_bf16 v[110:113], v[178:181], v[86:89], v[110:113]
    ds_read_b64_tr_b16 v[172:173], v34 offset:39936
    v_mfma_f32_16x16x32_bf16 v[114:117], v[182:185], v[82:85], v[114:117]
    ds_read_b64_tr_b16 v[174:175], v35 offset:36864
    v_mfma_f32_16x16x32_bf16 v[118:121], v[182:185], v[86:89], v[118:121]
    ds_read_b64_tr_b16 v[176:177], v35 offset:39936
    v_mfma_f32_16x16x32_bf16 v[122:125], v[154:157], v[82:85], v[122:125]
    ds_read_b64_tr_b16 v[178:179], v34 offset:36928
    buffer_load_dwordx4 v[214:217], v1, s[40:43], s66 offen offset:1024 sc1
    v_mfma_f32_16x16x32_bf16 v[126:129], v[154:157], v[86:89], v[126:129]
    ds_read_b64_tr_b16 v[180:181], v34 offset:40000
    s_waitcnt lgkmcnt(6)
    v_mfma_f32_16x16x32_bf16 v[130:133], v[158:161], v[82:85], v[130:133]
    ds_read_b64_tr_b16 v[182:183], v35 offset:36928
    v_mfma_f32_16x16x32_bf16 v[134:137], v[158:161], v[86:89], v[134:137]
    ds_read_b64_tr_b16 v[184:185], v35 offset:40000
    v_mfma_f32_16x16x32_bf16 v[138:141], v[162:165], v[82:85], v[138:141]
    ds_read_b64_tr_b16 v[154:155], v34 offset:36992
    buffer_load_dwordx4 v[50:53], v1, s[40:43], s64 offen offset:1024 sc1
    v_mfma_f32_16x16x32_bf16 v[142:145], v[162:165], v[86:89], v[142:145]
    ds_read_b64_tr_b16 v[156:157], v34 offset:40064
    v_mfma_f32_16x16x32_bf16 v[146:149], v[166:169], v[82:85], v[146:149]
    ds_read_b64_tr_b16 v[158:159], v35 offset:36992
    v_mfma_f32_16x16x32_bf16 v[150:153], v[166:169], v[86:89], v[150:153]
    ds_read_b64_tr_b16 v[160:161], v35 offset:40064
    s_waitcnt vmcnt(7) lgkmcnt(6)
    v_mfma_f32_16x16x32_bf16 v[106:109], v[170:173], v[90:93], v[106:109]
    ds_read_b64_tr_b16 v[162:163], v34 offset:43008
    buffer_load_dwordx4 v[54:57], v1, s[40:43], s65 offen offset:1024 sc1
    v_mfma_f32_16x16x32_bf16 v[110:113], v[170:173], v[94:97], v[110:113]
    ds_read_b64_tr_b16 v[164:165], v34 offset:46080
    v_mfma_f32_16x16x32_bf16 v[114:117], v[174:177], v[90:93], v[114:117]
    ds_read_b64_tr_b16 v[166:167], v35 offset:43008
    v_mfma_f32_16x16x32_bf16 v[118:121], v[174:177], v[94:97], v[118:121]
    ds_read_b64_tr_b16 v[168:169], v35 offset:46080
    v_mfma_f32_16x16x32_bf16 v[122:125], v[178:181], v[90:93], v[122:125]
    ds_read_b64_tr_b16 v[170:171], v34 offset:43072
    buffer_load_dwordx4 v[58:61], v1, s[40:43], s64 offen offset:2048 sc1
    v_mfma_f32_16x16x32_bf16 v[126:129], v[178:181], v[94:97], v[126:129]
    ds_read_b64_tr_b16 v[172:173], v34 offset:46144
    s_waitcnt lgkmcnt(6)
    v_mfma_f32_16x16x32_bf16 v[130:133], v[182:185], v[90:93], v[130:133]
    ds_read_b64_tr_b16 v[174:175], v35 offset:43072
    v_mfma_f32_16x16x32_bf16 v[134:137], v[182:185], v[94:97], v[134:137]
    ds_read_b64_tr_b16 v[176:177], v35 offset:46144
    v_mfma_f32_16x16x32_bf16 v[138:141], v[154:157], v[90:93], v[138:141]
    ds_read_b64_tr_b16 v[178:179], v34 offset:43136
    buffer_load_dwordx4 v[62:65], v1, s[40:43], s65 offen offset:2048 sc1
    v_mfma_f32_16x16x32_bf16 v[142:145], v[154:157], v[94:97], v[142:145]
    ds_read_b64_tr_b16 v[180:181], v34 offset:46208
    v_mfma_f32_16x16x32_bf16 v[146:149], v[158:161], v[90:93], v[146:149]
    ds_read_b64_tr_b16 v[182:183], v35 offset:43136
    v_mfma_f32_16x16x32_bf16 v[150:153], v[158:161], v[94:97], v[150:153]
    ds_read_b64_tr_b16 v[184:185], v35 offset:46208
    s_waitcnt vmcnt(8) lgkmcnt(6)
    v_mfma_f32_16x16x32_bf16 v[106:109], v[162:165], v[98:101], v[106:109]
    ds_read_b64_tr_b16 v[154:155], v6 offset:0
    buffer_load_dwordx4 v[66:69], v1, s[40:43], s64 offen offset:3072 sc1
    v_mfma_f32_16x16x32_bf16 v[110:113], v[162:165], v[102:105], v[110:113]
    ds_read_b64_tr_b16 v[156:157], v6 offset:3072
    s_waitcnt vmcnt(5)
    v_mfma_f32_16x16x32_bf16 v[114:117], v[166:169], v[98:101], v[114:117]
    ds_read_b64_tr_b16 v[158:159], v7 offset:0
    v_add_f32_e64 v234, v210, v212
    v_mfma_f32_16x16x32_bf16 v[118:121], v[166:169], v[102:105], v[118:121]
    ds_read_b64_tr_b16 v[160:161], v7 offset:3072
    v_add_f32_e64 v235, v211, v213
    v_mfma_f32_16x16x32_bf16 v[122:125], v[170:173], v[98:101], v[122:125]
    ds_read_b64_tr_b16 v[162:163], v6 offset:64
    buffer_load_dwordx4 v[70:73], v1, s[40:43], s65 offen offset:3072 sc1
    v_mfma_f32_16x16x32_bf16 v[126:129], v[170:173], v[102:105], v[126:129]
    ds_read_b64_tr_b16 v[164:165], v6 offset:3136
    s_waitcnt lgkmcnt(6)
    v_mfma_f32_16x16x32_bf16 v[130:133], v[174:177], v[98:101], v[130:133]
    ds_read_b64_tr_b16 v[166:167], v7 offset:64
    s_add_u32 s64, s64, 4096
    v_mfma_f32_16x16x32_bf16 v[134:137], v[174:177], v[102:105], v[134:137]
    ds_read_b64_tr_b16 v[168:169], v7 offset:3136
    s_add_u32 s65, s65, 4096
    v_mfma_f32_16x16x32_bf16 v[138:141], v[178:181], v[98:101], v[138:141]
    ds_read_b64_tr_b16 v[170:171], v6 offset:128
    buffer_load_dwordx4 v[74:77], v1, s[40:43], s64 offen offset:0 sc1
    v_mfma_f32_16x16x32_bf16 v[142:145], v[178:181], v[102:105], v[142:145]
    ds_read_b64_tr_b16 v[172:173], v6 offset:3200
    v_add_f32 v236, v214, v216
    v_mfma_f32_16x16x32_bf16 v[146:149], v[182:185], v[98:101], v[146:149]
    ds_read_b64_tr_b16 v[174:175], v7 offset:128
    v_add_f32 v237, v215, v217
    v_mfma_f32_16x16x32_bf16 v[150:153], v[182:185], v[102:105], v[150:153]
    ds_read_b64_tr_b16 v[176:177], v7 offset:3200
    s_waitcnt lgkmcnt(6)
    v_mfma_f32_16x16x32_bf16 v[106:109], v[154:157], v[42:45], v[106:109]
    ds_read_b64_tr_b16 v[178:179], v6 offset:6144
    buffer_load_dwordx4 v[78:81], v1, s[40:43], s65 offen offset:0 sc1
    v_mfma_f32_16x16x32_bf16 v[110:113], v[154:157], v[46:49], v[110:113]
    ds_read_b64_tr_b16 v[180:181], v6 offset:9216
    v_permlane16_swap_b32 v234, v235
    v_mfma_f32_16x16x32_bf16 v[114:117], v[158:161], v[42:45], v[114:117]
    ds_read_b64_tr_b16 v[182:183], v7 offset:6144
    v_permlane16_swap_b32 v236, v237
    v_mfma_f32_16x16x32_bf16 v[118:121], v[158:161], v[46:49], v[118:121]
    ds_read_b64_tr_b16 v[184:185], v7 offset:9216
    v_add_f32_e64 v234, v234, v235
    v_mfma_f32_16x16x32_bf16 v[122:125], v[162:165], v[42:45], v[122:125]
    ds_read_b64_tr_b16 v[154:155], v6 offset:6208
    buffer_load_dwordx4 v[82:85], v1, s[40:43], s64 offen offset:1024 sc1
    v_mfma_f32_16x16x32_bf16 v[126:129], v[162:165], v[46:49], v[126:129]
    ds_read_b64_tr_b16 v[156:157], v6 offset:9280
    s_waitcnt lgkmcnt(6)
    v_mfma_f32_16x16x32_bf16 v[130:133], v[166:169], v[42:45], v[130:133]
    ds_read_b64_tr_b16 v[158:159], v7 offset:6208
    v_add_f32 v236, v236, v237
    v_mfma_f32_16x16x32_bf16 v[134:137], v[166:169], v[46:49], v[134:137]
    ds_read_b64_tr_b16 v[160:161], v7 offset:9280
    v_permlane32_swap_b32 v234, v236
    v_mfma_f32_16x16x32_bf16 v[138:141], v[170:173], v[42:45], v[138:141]
    ds_read_b64_tr_b16 v[162:163], v6 offset:6272
    buffer_load_dwordx4 v[86:89], v1, s[40:43], s65 offen offset:1024 sc1
    v_mfma_f32_16x16x32_bf16 v[142:145], v[170:173], v[46:49], v[142:145]
    ds_read_b64_tr_b16 v[164:165], v6 offset:9344
    v_add_f32 v234, v234, v236
    v_mfma_f32_16x16x32_bf16 v[146:149], v[174:177], v[42:45], v[146:149]
    ds_read_b64_tr_b16 v[166:167], v7 offset:6272
    v_mul_f32_e64 v235, -s84, v234
    v_mfma_f32_16x16x32_bf16 v[150:153], v[174:177], v[46:49], v[150:153]
    ds_read_b64_tr_b16 v[168:169], v7 offset:9344
    s_waitcnt vmcnt(8) lgkmcnt(6)
    v_mfma_f32_16x16x32_bf16 v[106:109], v[178:181], v[50:53], v[106:109]
    ds_read_b64_tr_b16 v[170:171], v6 offset:12288
    buffer_load_dwordx4 v[90:93], v1, s[40:43], s64 offen offset:2048 sc1
    v_mfma_f32_16x16x32_bf16 v[110:113], v[178:181], v[54:57], v[110:113]
    ds_read_b64_tr_b16 v[172:173], v6 offset:15360
    v_mul_f32_e64 v210, -s84, v234
    v_mfma_f32_16x16x32_bf16 v[114:117], v[182:185], v[50:53], v[114:117]
    ds_read_b64_tr_b16 v[174:175], v7 offset:12288
    v_permlane16_swap_b32 v235, v210
    v_mfma_f32_16x16x32_bf16 v[118:121], v[182:185], v[54:57], v[118:121]
    ds_read_b64_tr_b16 v[176:177], v7 offset:15360
    v_fma_f32 v210, -v235, v235, -v210
    v_mfma_f32_16x16x32_bf16 v[122:125], v[154:157], v[50:53], v[122:125]
    ds_read_b64_tr_b16 v[178:179], v6 offset:12352
    buffer_load_dwordx4 v[94:97], v1, s[40:43], s65 offen offset:2048 sc1
    v_mfma_f32_16x16x32_bf16 v[126:129], v[154:157], v[54:57], v[126:129]
    ds_read_b64_tr_b16 v[180:181], v6 offset:15424
    s_waitcnt lgkmcnt(6)
    v_mfma_f32_16x16x32_bf16 v[130:133], v[158:161], v[50:53], v[130:133]
    ds_read_b64_tr_b16 v[182:183], v7 offset:12352
    v_max_f32 v210, 0, v210
    v_mfma_f32_16x16x32_bf16 v[134:137], v[158:161], v[54:57], v[134:137]
    ds_read_b64_tr_b16 v[184:185], v7 offset:15424
    v_add_f32 v210, 0x3727c5ac, v210
    v_mfma_f32_16x16x32_bf16 v[138:141], v[162:165], v[50:53], v[138:141]
    ds_read_b64_tr_b16 v[154:155], v6 offset:12416
    v_mov_b32 v237, v235
    v_mfma_f32_16x16x32_bf16 v[142:145], v[162:165], v[54:57], v[142:145]
    ds_read_b64_tr_b16 v[156:157], v6 offset:15488
    v_rsq_f32 v234, v210
    v_mfma_f32_16x16x32_bf16 v[146:149], v[166:169], v[50:53], v[146:149]
    ds_read_b64_tr_b16 v[158:159], v7 offset:12416
    v_permlane32_swap_b32 v235, v237
    v_mfma_f32_16x16x32_bf16 v[150:153], v[166:169], v[54:57], v[150:153]
    ds_read_b64_tr_b16 v[160:161], v7 offset:15488
    s_waitcnt vmcnt(8) lgkmcnt(6)
    v_mfma_f32_16x16x32_bf16 v[106:109], v[170:173], v[58:61], v[106:109]
    ds_read_b64_tr_b16 v[162:163], v6 offset:18432
    buffer_load_dwordx4 v[98:101], v1, s[40:43], s64 offen offset:3072 sc1
    v_mfma_f32_16x16x32_bf16 v[110:113], v[170:173], v[62:65], v[110:113]
    ds_read_b64_tr_b16 v[164:165], v6 offset:21504
    v_mul_f32_e64 v236, s98, v234
    v_mfma_f32_16x16x32_bf16 v[114:117], v[174:177], v[58:61], v[114:117]
    ds_read_b64_tr_b16 v[166:167], v7 offset:18432
    v_mul_f32 v234, s98, v234
    v_mfma_f32_16x16x32_bf16 v[118:121], v[174:177], v[62:65], v[118:121]
    ds_read_b64_tr_b16 v[168:169], v7 offset:21504
    v_permlane32_swap_b32 v234, v236
    v_mfma_f32_16x16x32_bf16 v[122:125], v[178:181], v[58:61], v[122:125]
    ds_read_b64_tr_b16 v[170:171], v6 offset:18496
    buffer_load_dwordx4 v[102:105], v1, s[40:43], s65 offen offset:3072 sc1
    v_mfma_f32_16x16x32_bf16 v[126:129], v[178:181], v[62:65], v[126:129]
    ds_read_b64_tr_b16 v[172:173], v6 offset:21568
    s_waitcnt lgkmcnt(6)
    v_mfma_f32_16x16x32_bf16 v[130:133], v[182:185], v[58:61], v[130:133]
    ds_read_b64_tr_b16 v[174:175], v7 offset:18496
    v_mfma_f32_16x16x32_bf16 v[134:137], v[182:185], v[62:65], v[134:137]
    ds_read_b64_tr_b16 v[176:177], v7 offset:21568
    v_mfma_f32_16x16x32_bf16 v[138:141], v[154:157], v[58:61], v[138:141]
    ds_read_b64_tr_b16 v[178:179], v6 offset:18560
    v_mfma_f32_16x16x32_bf16 v[142:145], v[154:157], v[62:65], v[142:145]
    ds_read_b64_tr_b16 v[180:181], v6 offset:21632
    v_mfma_f32_16x16x32_bf16 v[146:149], v[158:161], v[58:61], v[146:149]
    ds_read_b64_tr_b16 v[182:183], v7 offset:18560
    v_mfma_f32_16x16x32_bf16 v[150:153], v[158:161], v[62:65], v[150:153]
    ds_read_b64_tr_b16 v[184:185], v7 offset:21632
    s_waitcnt vmcnt(8) lgkmcnt(6)
    v_mfma_f32_16x16x32_bf16 v[106:109], v[162:165], v[66:69], v[106:109]
    ds_read_b64_tr_b16 v[154:155], v6 offset:24576
    v_mfma_f32_16x16x32_bf16 v[110:113], v[162:165], v[70:73], v[110:113]
    ds_read_b64_tr_b16 v[156:157], v6 offset:27648
    v_mfma_f32_16x16x32_bf16 v[114:117], v[166:169], v[66:69], v[114:117]
    ds_read_b64_tr_b16 v[158:159], v7 offset:24576
    v_mfma_f32_16x16x32_bf16 v[118:121], v[166:169], v[70:73], v[118:121]
    ds_read_b64_tr_b16 v[160:161], v7 offset:27648
    v_mfma_f32_16x16x32_bf16 v[122:125], v[170:173], v[66:69], v[122:125]
    ds_read_b64_tr_b16 v[162:163], v6 offset:24640
    v_mfma_f32_16x16x32_bf16 v[126:129], v[170:173], v[70:73], v[126:129]
    ds_read_b64_tr_b16 v[164:165], v6 offset:27712
    s_waitcnt lgkmcnt(6)
    v_mfma_f32_16x16x32_bf16 v[130:133], v[174:177], v[66:69], v[130:133]
    ds_read_b64_tr_b16 v[166:167], v7 offset:24640
    v_mfma_f32_16x16x32_bf16 v[134:137], v[174:177], v[70:73], v[134:137]
    ds_read_b64_tr_b16 v[168:169], v7 offset:27712
    v_mfma_f32_16x16x32_bf16 v[138:141], v[178:181], v[66:69], v[138:141]
    ds_read_b64_tr_b16 v[170:171], v6 offset:24704
    v_mfma_f32_16x16x32_bf16 v[142:145], v[178:181], v[70:73], v[142:145]
    ds_read_b64_tr_b16 v[172:173], v6 offset:27776
    v_mfma_f32_16x16x32_bf16 v[146:149], v[182:185], v[66:69], v[146:149]
    ds_read_b64_tr_b16 v[174:175], v7 offset:24704
    v_mfma_f32_16x16x32_bf16 v[150:153], v[182:185], v[70:73], v[150:153]
    ds_read_b64_tr_b16 v[176:177], v7 offset:27776
    s_waitcnt vmcnt(6) lgkmcnt(6)
    v_mfma_f32_16x16x32_bf16 v[106:109], v[154:157], v[74:77], v[106:109]
    ds_read_b64_tr_b16 v[178:179], v6 offset:30720
    v_mfma_f32_16x16x32_bf16 v[110:113], v[154:157], v[78:81], v[110:113]
    ds_read_b64_tr_b16 v[180:181], v6 offset:33792
    v_mfma_f32_16x16x32_bf16 v[114:117], v[158:161], v[74:77], v[114:117]
    ds_read_b64_tr_b16 v[182:183], v7 offset:30720
    v_mfma_f32_16x16x32_bf16 v[118:121], v[158:161], v[78:81], v[118:121]
    ds_read_b64_tr_b16 v[184:185], v7 offset:33792
    v_mfma_f32_16x16x32_bf16 v[122:125], v[162:165], v[74:77], v[122:125]
    ds_read_b64_tr_b16 v[154:155], v6 offset:30784
    v_mfma_f32_16x16x32_bf16 v[126:129], v[162:165], v[78:81], v[126:129]
    ds_read_b64_tr_b16 v[156:157], v6 offset:33856
    s_waitcnt lgkmcnt(6)
    v_mfma_f32_16x16x32_bf16 v[130:133], v[166:169], v[74:77], v[130:133]
    ds_read_b64_tr_b16 v[158:159], v7 offset:30784
    v_mfma_f32_16x16x32_bf16 v[134:137], v[166:169], v[78:81], v[134:137]
    ds_read_b64_tr_b16 v[160:161], v7 offset:33856
    v_mfma_f32_16x16x32_bf16 v[138:141], v[170:173], v[74:77], v[138:141]
L_pg8:
    s_cbranch_execz L_walked1
    ds_read_b64_tr_b16 v[162:163], v6 offset:30848
    v_mfma_f32_16x16x32_bf16 v[142:145], v[170:173], v[78:81], v[142:145]
    ds_read_b64_tr_b16 v[164:165], v6 offset:33920
    v_mfma_f32_16x16x32_bf16 v[146:149], v[174:177], v[74:77], v[146:149]
    ds_read_b64_tr_b16 v[166:167], v7 offset:30848
    v_mfma_f32_16x16x32_bf16 v[150:153], v[174:177], v[78:81], v[150:153]
    ds_read_b64_tr_b16 v[168:169], v7 offset:33920
    s_waitcnt vmcnt(4) lgkmcnt(6)
    v_mfma_f32_16x16x32_bf16 v[106:109], v[178:181], v[82:85], v[106:109]
    ds_read_b64_tr_b16 v[170:171], v6 offset:36864
    v_mfma_f32_16x16x32_bf16 v[110:113], v[178:181], v[86:89], v[110:113]
    ds_read_b64_tr_b16 v[172:173], v6 offset:39936
    v_mfma_f32_16x16x32_bf16 v[114:117], v[182:185], v[82:85], v[114:117]
    ds_read_b64_tr_b16 v[174:175], v7 offset:36864
    v_mfma_f32_16x16x32_bf16 v[118:121], v[182:185], v[86:89], v[118:121]
    ds_read_b64_tr_b16 v[176:177], v7 offset:39936
    v_mfma_f32_16x16x32_bf16 v[122:125], v[154:157], v[82:85], v[122:125]
    ds_read_b64_tr_b16 v[178:179], v6 offset:36928
    v_mfma_f32_16x16x32_bf16 v[126:129], v[154:157], v[86:89], v[126:129]
    ds_read_b64_tr_b16 v[180:181], v6 offset:40000
    s_waitcnt lgkmcnt(6)
    v_mfma_f32_16x16x32_bf16 v[130:133], v[158:161], v[82:85], v[130:133]
    ds_read_b64_tr_b16 v[182:183], v7 offset:36928
    v_mfma_f32_16x16x32_bf16 v[134:137], v[158:161], v[86:89], v[134:137]
    ds_read_b64_tr_b16 v[184:185], v7 offset:40000
    v_mfma_f32_16x16x32_bf16 v[138:141], v[162:165], v[82:85], v[138:141]
    ds_read_b64_tr_b16 v[154:155], v6 offset:36992
    v_mfma_f32_16x16x32_bf16 v[142:145], v[162:165], v[86:89], v[142:145]
    ds_read_b64_tr_b16 v[156:157], v6 offset:40064
    v_mfma_f32_16x16x32_bf16 v[146:149], v[166:169], v[82:85], v[146:149]
    ds_read_b64_tr_b16 v[158:159], v7 offset:36992
    v_mfma_f32_16x16x32_bf16 v[150:153], v[166:169], v[86:89], v[150:153]
    ds_read_b64_tr_b16 v[160:161], v7 offset:40064
    s_waitcnt vmcnt(2) lgkmcnt(6)
    v_mfma_f32_16x16x32_bf16 v[106:109], v[170:173], v[90:93], v[106:109]
    ds_read_b64_tr_b16 v[162:163], v6 offset:43008
    v_mfma_f32_16x16x32_bf16 v[110:113], v[170:173], v[94:97], v[110:113]
    ds_read_b64_tr_b16 v[164:165], v6 offset:46080
    v_mfma_f32_16x16x32_bf16 v[114:117], v[174:177], v[90:93], v[114:117]
    ds_read_b64_tr_b16 v[166:167], v7 offset:43008
    v_mfma_f32_16x16x32_bf16 v[118:121], v[174:177], v[94:97], v[118:121]
    ds_read_b64_tr_b16 v[168:169], v7 offset:46080
    v_mfma_f32_16x16x32_bf16 v[122:125], v[178:181], v[90:93], v[122:125]
    ds_read_b64_tr_b16 v[170:171], v6 offset:43072
    v_mfma_f32_16x16x32_bf16 v[126:129], v[178:181], v[94:97], v[126:129]
    ds_read_b64_tr_b16 v[172:173], v6 offset:46144
    s_waitcnt lgkmcnt(6)
    v_mfma_f32_16x16x32_bf16 v[130:133], v[182:185], v[90:93], v[130:133]
    ds_read_b64_tr_b16 v[174:175], v7 offset:43072
    v_mfma_f32_16x16x32_bf16 v[134:137], v[182:185], v[94:97], v[134:137]
    ds_read_b64_tr_b16 v[176:177], v7 offset:46144
    v_mfma_f32_16x16x32_bf16 v[138:141], v[154:157], v[90:93], v[138:141]
    ds_read_b64_tr_b16 v[178:179], v6 offset:43136
    v_mfma_f32_16x16x32_bf16 v[142:145], v[154:157], v[94:97], v[142:145]
    ds_read_b64_tr_b16 v[180:181], v6 offset:46208
    v_mfma_f32_16x16x32_bf16 v[146:149], v[158:161], v[90:93], v[146:149]
    ds_read_b64_tr_b16 v[182:183], v7 offset:43136
    v_mfma_f32_16x16x32_bf16 v[150:153], v[158:161], v[94:97], v[150:153]
    ds_read_b64_tr_b16 v[184:185], v7 offset:46208
    s_waitcnt vmcnt(0) lgkmcnt(6)
    v_mfma_f32_16x16x32_bf16 v[106:109], v[162:165], v[98:101], v[106:109]
    ds_read_b128 v[210:213], v41 offset:512
    ds_read_b128 v[214:217], v41 offset:576
    v_mfma_f32_16x16x32_bf16 v[110:113], v[162:165], v[102:105], v[110:113]
    ds_read_b128 v[218:221], v41 offset:640
    ds_read_b128 v[222:225], v41 offset:704
    v_mfma_f32_16x16x32_bf16 v[114:117], v[166:169], v[98:101], v[114:117]
    ds_read_b128 v[226:229], v41 offset:768
    ds_read_b128 v[230:233], v41 offset:832
    v_mfma_f32_16x16x32_bf16 v[118:121], v[166:169], v[102:105], v[118:121]
    v_mfma_f32_16x16x32_bf16 v[122:125], v[170:173], v[98:101], v[122:125]
    v_mfma_f32_16x16x32_bf16 v[126:129], v[170:173], v[102:105], v[126:129]
    s_waitcnt lgkmcnt(6)
    v_mfma_f32_16x16x32_bf16 v[130:133], v[174:177], v[98:101], v[130:133]
    v_mfma_f32_16x16x32_bf16 v[134:137], v[174:177], v[102:105], v[134:137]
    v_mfma_f32_16x16x32_bf16 v[138:141], v[178:181], v[98:101], v[138:141]
    v_mfma_f32_16x16x32_bf16 v[142:145], v[178:181], v[102:105], v[142:145]
    v_mfma_f32_16x16x32_bf16 v[146:149], v[182:185], v[98:101], v[146:149]
    v_mfma_f32_16x16x32_bf16 v[150:153], v[182:185], v[102:105], v[150:153]
    s_waitcnt lgkmcnt(0)
    s_nop 3
    v_pk_fma_f32 v[138:139], v[202:203], v[234:235], v[138:139] op_sel:[0,1,0] op_sel_hi:[1,1,1]
    v_pk_fma_f32 v[138:139], v[138:139], v[234:235], v[226:227] op_sel_hi:[1,0,1]
    v_pk_fma_f32 v[140:141], v[204:205], v[234:235], v[140:141] op_sel:[0,1,0] op_sel_hi:[1,1,1]
    v_exp_f32 v82, v138
    v_pk_fma_f32 v[140:141], v[140:141], v[234:235], v[228:229] op_sel_hi:[1,0,1]
    v_exp_f32 v83, v139
    v_pk_fma_f32 v[146:147], v[206:207], v[234:235], v[146:147] op_sel:[0,1,0] op_sel_hi:[1,1,1]
    v_exp_f32 v84, v140
    v_pk_fma_f32 v[94:95], v[82:83], 0.5, 1.0 op_sel_hi:[1,0,0]
    v_pk_fma_f32 v[146:147], v[146:147], v[234:235], v[230:231] op_sel_hi:[1,0,1]
    v_exp_f32 v85, v141
    v_pk_fma_f32 v[82:83], v[82:83], v[94:95], 1.0 op_sel_hi:[1,1,0]
    v_pk_fma_f32 v[148:149], v[208:209], v[234:235], v[148:149] op_sel:[0,1,0] op_sel_hi:[1,1,1]
    v_exp_f32 v86, v146
    v_pk_fma_f32 v[96:97], v[84:85], 0.5, 1.0 op_sel_hi:[1,0,0]
    v_rcp_f32 v82, v82
    v_pk_fma_f32 v[148:149], v[148:149], v[234:235], v[232:233] op_sel_hi:[1,0,1]
    v_exp_f32 v87, v147
    v_pk_fma_f32 v[84:85], v[84:85], v[96:97], 1.0 op_sel_hi:[1,1,0]
    v_rcp_f32 v83, v83
    v_pk_fma_f32 v[142:143], v[202:203], v[236:237], v[142:143] op_sel:[0,1,0] op_sel_hi:[1,1,1]
    v_exp_f32_e64 v88, v148
    v_pk_fma_f32 v[98:99], v[86:87], 0.5, 1.0 op_sel_hi:[1,0,0]
    v_rcp_f32 v84, v84
    v_pk_fma_f32 v[138:139], v[138:139], v[82:83], v[138:139] neg_lo:[1,0,0] neg_hi:[1,0,0]
    v_pk_fma_f32 v[142:143], v[142:143], v[236:237], v[226:227] op_sel_hi:[1,0,1]
    v_exp_f32 v89, v149
    v_pk_fma_f32 v[86:87], v[86:87], v[98:99], 1.0 op_sel_hi:[1,1,0]
    v_rcp_f32 v85, v85
    v_cvt_pk_bf16_f32 v162, v138, v139
    v_pk_fma_f32 v[144:145], v[204:205], v[236:237], v[144:145] op_sel:[0,1,0] op_sel_hi:[1,1,1]
    v_exp_f32 v90, v142
    v_pk_fma_f32 v[100:101], v[88:89], 0.5, 1.0 op_sel_hi:[1,0,0]
    v_rcp_f32 v86, v86
    v_pk_fma_f32 v[140:141], v[140:141], v[84:85], v[140:141] neg_lo:[1,0,0] neg_hi:[1,0,0]
    v_pk_fma_f32 v[144:145], v[144:145], v[236:237], v[228:229] op_sel_hi:[1,0,1]
    v_exp_f32 v91, v143
    v_pk_fma_f32 v[88:89], v[88:89], v[100:101], 1.0 op_sel_hi:[1,1,0]
    v_rcp_f32 v87, v87
    v_cvt_pk_bf16_f32 v163, v140, v141
    v_pk_fma_f32 v[150:151], v[206:207], v[236:237], v[150:151] op_sel:[0,1,0] op_sel_hi:[1,1,1]
    v_exp_f32 v92, v144
    v_pk_fma_f32 v[102:103], v[90:91], 0.5, 1.0 op_sel_hi:[1,0,0]
    v_rcp_f32 v88, v88
    v_pk_fma_f32 v[146:147], v[146:147], v[86:87], v[146:147] neg_lo:[1,0,0] neg_hi:[1,0,0]
    v_pk_fma_f32 v[150:151], v[150:151], v[236:237], v[230:231] op_sel_hi:[1,0,1]
    v_exp_f32 v93, v145
    v_pk_fma_f32 v[90:91], v[90:91], v[102:103], 1.0 op_sel_hi:[1,1,0]
    v_rcp_f32 v89, v89
    v_cvt_pk_bf16_f32 v164, v146, v147
    v_pk_fma_f32 v[152:153], v[208:209], v[236:237], v[152:153] op_sel:[0,1,0] op_sel_hi:[1,1,1]
    v_exp_f32 v82, v150
    v_pk_fma_f32 v[104:105], v[92:93], 0.5, 1.0 op_sel_hi:[1,0,0]
    v_rcp_f32 v90, v90
    v_pk_fma_f32 v[148:149], v[148:149], v[88:89], v[148:149] neg_lo:[1,0,0] neg_hi:[1,0,0]
    v_pk_fma_f32 v[152:153], v[152:153], v[236:237], v[232:233] op_sel_hi:[1,0,1]
    v_exp_f32 v83, v151
    v_pk_fma_f32 v[92:93], v[92:93], v[104:105], 1.0 op_sel_hi:[1,1,0]
    v_rcp_f32 v91, v91
    v_cvt_pk_bf16_f32 v165, v148, v149
    s_cmp_lg_u32 s53, 0
    s_cbranch_scc1 L_slow_88
    buffer_store_dwordx4 v[162:165], v1, s[40:43], s72 offen offset:2048
L_st_89:
    v_exp_f32 v84, v152
    v_pk_fma_f32 v[94:95], v[82:83], 0.5, 1.0 op_sel_hi:[1,0,0]
    v_rcp_f32 v92, v92
    v_pk_fma_f32 v[142:143], v[142:143], v[90:91], v[142:143] neg_lo:[1,0,0] neg_hi:[1,0,0]
    v_exp_f32 v85, v153
    v_pk_fma_f32 v[82:83], v[82:83], v[94:95], 1.0 op_sel_hi:[1,1,0]
    v_rcp_f32 v93, v93
    v_cvt_pk_bf16_f32 v174, v142, v143
    v_pk_fma_f32 v[96:97], v[84:85], 0.5, 1.0 op_sel_hi:[1,0,0]
    v_rcp_f32 v82, v82
    v_pk_fma_f32 v[144:145], v[144:145], v[92:93], v[144:145] neg_lo:[1,0,0] neg_hi:[1,0,0]
    v_pk_fma_f32 v[84:85], v[84:85], v[96:97], 1.0 op_sel_hi:[1,1,0]
    v_rcp_f32 v83, v83
    v_cvt_pk_bf16_f32 v175, v144, v145
    v_rcp_f32 v84, v84
    v_pk_fma_f32 v[150:151], v[150:151], v[82:83], v[150:151] neg_lo:[1,0,0] neg_hi:[1,0,0]
    v_rcp_f32_e64 v85, v85
    v_cvt_pk_bf16_f32 v176, v150, v151
    v_pk_fma_f32 v[152:153], v[152:153], v[84:85], v[152:153] neg_lo:[1,0,0] neg_hi:[1,0,0]
    v_pk_fma_f32 v[106:107], v[186:187], v[234:235], v[106:107] op_sel:[0,1,0] op_sel_hi:[1,1,1]
    v_cvt_pk_bf16_f32 v177, v152, v153
    v_pk_fma_f32 v[106:107], v[106:107], v[234:235], v[210:211] op_sel_hi:[1,0,1]
    s_cmp_lg_u32 s53, 0
    s_cbranch_scc1 L_slow_90
    buffer_store_dwordx4 v[174:177], v1, s[40:43], s73 offen offset:2048
L_st_91:
    v_pk_fma_f32 v[108:109], v[188:189], v[234:235], v[108:109] op_sel:[0,1,0] op_sel_hi:[1,1,1]
    v_exp_f32 v86, v106
    v_pk_fma_f32 v[108:109], v[108:109], v[234:235], v[212:213] op_sel_hi:[1,0,1]
    v_exp_f32 v87, v107
    v_pk_fma_f32 v[114:115], v[190:191], v[234:235], v[114:115] op_sel:[0,1,0] op_sel_hi:[1,1,1]
    v_exp_f32 v88, v108
    v_pk_fma_f32 v[98:99], v[86:87], 0.5, 1.0 op_sel_hi:[1,0,0]
    v_pk_fma_f32 v[114:115], v[114:115], v[234:235], v[214:215] op_sel_hi:[1,0,1]
    v_exp_f32 v89, v109
    v_pk_fma_f32 v[86:87], v[86:87], v[98:99], 1.0 op_sel_hi:[1,1,0]
    v_pk_fma_f32 v[116:117], v[192:193], v[234:235], v[116:117] op_sel:[0,1,0] op_sel_hi:[1,1,1]
    v_exp_f32 v90, v114
    v_pk_fma_f32 v[100:101], v[88:89], 0.5, 1.0 op_sel_hi:[1,0,0]
    v_rcp_f32 v86, v86
    v_pk_fma_f32 v[116:117], v[116:117], v[234:235], v[216:217] op_sel_hi:[1,0,1]
    v_exp_f32 v91, v115
    v_pk_fma_f32 v[88:89], v[88:89], v[100:101], 1.0 op_sel_hi:[1,1,0]
    v_rcp_f32 v87, v87
    v_pk_fma_f32 v[110:111], v[186:187], v[236:237], v[110:111] op_sel:[0,1,0] op_sel_hi:[1,1,1]
    v_exp_f32 v92, v116
    v_pk_fma_f32 v[102:103], v[90:91], 0.5, 1.0 op_sel_hi:[1,0,0]
    v_rcp_f32 v88, v88
    v_pk_fma_f32 v[106:107], v[106:107], v[86:87], v[106:107] neg_lo:[1,0,0] neg_hi:[1,0,0]
    v_pk_fma_f32 v[110:111], v[110:111], v[236:237], v[210:211] op_sel_hi:[1,0,1]
    v_exp_f32 v93, v117
    v_pk_fma_f32 v[90:91], v[90:91], v[102:103], 1.0 op_sel_hi:[1,1,0]
    v_rcp_f32 v89, v89
    v_cvt_pk_bf16_f32 v154, v106, v107
    v_pk_fma_f32 v[112:113], v[188:189], v[236:237], v[112:113] op_sel:[0,1,0] op_sel_hi:[1,1,1]
    v_exp_f32 v82, v110
    v_pk_fma_f32 v[104:105], v[92:93], 0.5, 1.0 op_sel_hi:[1,0,0]
    v_rcp_f32 v90, v90
    v_pk_fma_f32 v[108:109], v[108:109], v[88:89], v[108:109] neg_lo:[1,0,0] neg_hi:[1,0,0]
    v_pk_fma_f32 v[112:113], v[112:113], v[236:237], v[212:213] op_sel_hi:[1,0,1]
    v_exp_f32 v83, v111
    v_pk_fma_f32 v[92:93], v[92:93], v[104:105], 1.0 op_sel_hi:[1,1,0]
    v_rcp_f32 v91, v91
    v_cvt_pk_bf16_f32 v155, v108, v109
    v_pk_fma_f32 v[118:119], v[190:191], v[236:237], v[118:119] op_sel:[0,1,0] op_sel_hi:[1,1,1]
    v_exp_f32 v84, v112
    v_pk_fma_f32 v[94:95], v[82:83], 0.5, 1.0 op_sel_hi:[1,0,0]
    v_rcp_f32 v92, v92
    v_pk_fma_f32 v[114:115], v[114:115], v[90:91], v[114:115] neg_lo:[1,0,0] neg_hi:[1,0,0]
    v_pk_fma_f32 v[118:119], v[118:119], v[236:237], v[214:215] op_sel_hi:[1,0,1]
    v_exp_f32 v85, v113
    v_pk_fma_f32 v[82:83], v[82:83], v[94:95], 1.0 op_sel_hi:[1,1,0]
    v_rcp_f32 v93, v93
    v_cvt_pk_bf16_f32 v156, v114, v115
    v_pk_fma_f32 v[120:121], v[192:193], v[236:237], v[120:121] op_sel:[0,1,0] op_sel_hi:[1,1,1]
    v_exp_f32 v86, v118
    v_pk_fma_f32 v[96:97], v[84:85], 0.5, 1.0 op_sel_hi:[1,0,0]
    v_rcp_f32 v82, v82
    v_pk_fma_f32 v[116:117], v[116:117], v[92:93], v[116:117] neg_lo:[1,0,0] neg_hi:[1,0,0]
    v_pk_fma_f32 v[120:121], v[120:121], v[236:237], v[216:217] op_sel_hi:[1,0,1]
    v_exp_f32 v87, v119
    v_pk_fma_f32 v[84:85], v[84:85], v[96:97], 1.0 op_sel_hi:[1,1,0]
    v_rcp_f32 v83, v83
    v_cvt_pk_bf16_f32 v157, v116, v117
    s_cmp_lg_u32 s53, 0
    s_cbranch_scc1 L_slow_92
    buffer_store_dwordx4 v[154:157], v238, s[40:43], s72 offen offset:0
L_st_93:
    v_mov_b32 v36, 13
    s_waitcnt vmcnt(1)
    s_cmp_lg_u32 s53, 0
    s_cbranch_scc1 L_slow_94
    buffer_store_dword v36, v28, s[40:43], s54 offen
L_st_95:
    v_pk_fma_f32 v[122:123], v[194:195], v[234:235], v[122:123] op_sel:[0,1,0] op_sel_hi:[1,1,1]
    v_exp_f32 v88, v120
    v_pk_fma_f32 v[98:99], v[86:87], 0.5, 1.0 op_sel_hi:[1,0,0]
    v_rcp_f32 v84, v84
    v_pk_fma_f32 v[110:111], v[110:111], v[82:83], v[110:111] neg_lo:[1,0,0] neg_hi:[1,0,0]
    v_pk_fma_f32 v[122:123], v[122:123], v[234:235], v[218:219] op_sel_hi:[1,0,1]
    v_exp_f32 v89, v121
    v_pk_fma_f32 v[86:87], v[86:87], v[98:99], 1.0 op_sel_hi:[1,1,0]
    v_rcp_f32 v85, v85
    v_cvt_pk_bf16_f32 v166, v110, v111
    v_pk_fma_f32 v[124:125], v[196:197], v[234:235], v[124:125] op_sel:[0,1,0] op_sel_hi:[1,1,1]
    v_exp_f32 v90, v122
    v_pk_fma_f32 v[100:101], v[88:89], 0.5, 1.0 op_sel_hi:[1,0,0]
    v_rcp_f32 v86, v86
    v_pk_fma_f32 v[112:113], v[112:113], v[84:85], v[112:113] neg_lo:[1,0,0] neg_hi:[1,0,0]
    v_pk_fma_f32 v[124:125], v[124:125], v[234:235], v[220:221] op_sel_hi:[1,0,1]
    v_exp_f32 v91, v123
    v_pk_fma_f32 v[88:89], v[88:89], v[100:101], 1.0 op_sel_hi:[1,1,0]
    v_rcp_f32 v87, v87
    v_cvt_pk_bf16_f32 v167, v112, v113
    v_pk_fma_f32 v[130:131], v[198:199], v[234:235], v[130:131] op_sel:[0,1,0] op_sel_hi:[1,1,1]
    v_exp_f32 v92, v124
    v_pk_fma_f32 v[102:103], v[90:91], 0.5, 1.0 op_sel_hi:[1,0,0]
    v_rcp_f32 v88, v88
    v_pk_fma_f32 v[118:119], v[118:119], v[86:87], v[118:119] neg_lo:[1,0,0] neg_hi:[1,0,0]
    v_pk_fma_f32 v[130:131], v[130:131], v[234:235], v[222:223] op_sel_hi:[1,0,1]
    v_exp_f32 v93, v125
    v_pk_fma_f32 v[90:91], v[90:91], v[102:103], 1.0 op_sel_hi:[1,1,0]
    v_rcp_f32 v89, v89
    v_cvt_pk_bf16_f32 v168, v118, v119
    v_pk_fma_f32 v[132:133], v[200:201], v[234:235], v[132:133] op_sel:[0,1,0] op_sel_hi:[1,1,1]
    v_exp_f32 v82, v130
    v_pk_fma_f32 v[104:105], v[92:93], 0.5, 1.0 op_sel_hi:[1,0,0]
    v_rcp_f32 v90, v90
    v_pk_fma_f32 v[120:121], v[120:121], v[88:89], v[120:121] neg_lo:[1,0,0] neg_hi:[1,0,0]
    v_pk_fma_f32 v[132:133], v[132:133], v[234:235], v[224:225] op_sel_hi:[1,0,1]
    v_exp_f32 v83, v131
    v_pk_fma_f32 v[92:93], v[92:93], v[104:105], 1.0 op_sel_hi:[1,1,0]
    v_rcp_f32 v91, v91
    v_cvt_pk_bf16_f32 v169, v120, v121
    s_cmp_lg_u32 s53, 0
    s_cbranch_scc1 L_slow_96
    buffer_store_dwordx4 v[166:169], v238, s[40:43], s73 offen offset:0
L_st_97:
    v_pk_fma_f32 v[126:127], v[194:195], v[236:237], v[126:127] op_sel:[0,1,0] op_sel_hi:[1,1,1]
    v_exp_f32_e64 v84, v132
    v_pk_fma_f32 v[94:95], v[82:83], 0.5, 1.0 op_sel_hi:[1,0,0]
    v_rcp_f32 v92, v92
    v_pk_fma_f32 v[122:123], v[122:123], v[90:91], v[122:123] neg_lo:[1,0,0] neg_hi:[1,0,0]
    v_pk_fma_f32 v[126:127], v[126:127], v[236:237], v[218:219] op_sel_hi:[1,0,1]
    v_exp_f32 v85, v133
    v_pk_fma_f32 v[82:83], v[82:83], v[94:95], 1.0 op_sel_hi:[1,1,0]
    v_rcp_f32 v93, v93
    v_cvt_pk_bf16_f32 v158, v122, v123
    v_pk_fma_f32 v[128:129], v[196:197], v[236:237], v[128:129] op_sel:[0,1,0] op_sel_hi:[1,1,1]
    v_exp_f32 v86, v126
    v_pk_fma_f32 v[96:97], v[84:85], 0.5, 1.0 op_sel_hi:[1,0,0]
    v_rcp_f32 v82, v82
    v_pk_fma_f32 v[124:125], v[124:125], v[92:93], v[124:125] neg_lo:[1,0,0] neg_hi:[1,0,0]
    v_pk_fma_f32 v[128:129], v[128:129], v[236:237], v[220:221] op_sel_hi:[1,0,1]
    v_exp_f32 v87, v127
    v_pk_fma_f32 v[84:85], v[84:85], v[96:97], 1.0 op_sel_hi:[1,1,0]
    v_rcp_f32 v83, v83
    v_cvt_pk_bf16_f32 v159, v124, v125
    v_pk_fma_f32 v[134:135], v[198:199], v[236:237], v[134:135] op_sel:[0,1,0] op_sel_hi:[1,1,1]
    v_exp_f32 v88, v128
    v_pk_fma_f32 v[98:99], v[86:87], 0.5, 1.0 op_sel_hi:[1,0,0]
    v_rcp_f32 v84, v84
    v_pk_fma_f32 v[130:131], v[130:131], v[82:83], v[130:131] neg_lo:[1,0,0] neg_hi:[1,0,0]
    v_pk_fma_f32 v[134:135], v[134:135], v[236:237], v[222:223] op_sel_hi:[1,0,1]
    v_exp_f32 v89, v129
    v_pk_fma_f32 v[86:87], v[86:87], v[98:99], 1.0 op_sel_hi:[1,1,0]
    v_rcp_f32 v85, v85
    v_cvt_pk_bf16_f32 v160, v130, v131
    s_mul_i32 s64, s44, 11264
    s_add_u32 s64, s64, s51
    s_add_u32 s65, s64, 4096
    s_add_u32 s66, s64, 8192
    buffer_load_dword v38, v30, s[40:43], s56 offen sc1
    v_pk_fma_f32 v[136:137], v[200:201], v[236:237], v[136:137] op_sel:[0,1,0] op_sel_hi:[1,1,1]
    v_exp_f32 v90, v134
    v_pk_fma_f32 v[100:101], v[88:89], 0.5, 1.0 op_sel_hi:[1,0,0]
    v_rcp_f32 v86, v86
    v_pk_fma_f32 v[132:133], v[132:133], v[84:85], v[132:133] neg_lo:[1,0,0] neg_hi:[1,0,0]
    v_pk_fma_f32 v[136:137], v[136:137], v[236:237], v[224:225] op_sel_hi:[1,0,1]
    v_exp_f32 v91, v135
    v_pk_fma_f32 v[88:89], v[88:89], v[100:101], 1.0 op_sel_hi:[1,1,0]
    v_rcp_f32 v87, v87
    v_cvt_pk_bf16_f32 v161, v132, v133
    s_cmp_lg_u32 s53, 0
    s_cbranch_scc1 L_slow_98
    buffer_store_dwordx4 v[158:161], v239, s[40:43], s72 offen offset:1024
L_st_99:
    v_exp_f32 v92, v136
    v_pk_fma_f32 v[102:103], v[90:91], 0.5, 1.0 op_sel_hi:[1,0,0]
    v_rcp_f32 v88, v88
    v_pk_fma_f32 v[126:127], v[126:127], v[86:87], v[126:127] neg_lo:[1,0,0] neg_hi:[1,0,0]
    v_exp_f32 v93, v137
    v_pk_fma_f32 v[90:91], v[90:91], v[102:103], 1.0 op_sel_hi:[1,1,0]
    v_rcp_f32 v89, v89
    v_cvt_pk_bf16_f32 v170, v126, v127
    v_pk_fma_f32 v[104:105], v[92:93], 0.5, 1.0 op_sel_hi:[1,0,0]
    v_rcp_f32 v90, v90
    v_pk_fma_f32 v[128:129], v[128:129], v[88:89], v[128:129] neg_lo:[1,0,0] neg_hi:[1,0,0]
    v_pk_fma_f32 v[92:93], v[92:93], v[104:105], 1.0 op_sel_hi:[1,1,0]
    v_rcp_f32 v91, v91
    v_cvt_pk_bf16_f32 v171, v128, v129
    v_rcp_f32 v92, v92
    v_pk_fma_f32 v[134:135], v[134:135], v[90:91], v[134:135] neg_lo:[1,0,0] neg_hi:[1,0,0]
    v_rcp_f32 v93, v93
    v_cvt_pk_bf16_f32 v172, v134, v135
    v_pk_fma_f32 v[136:137], v[136:137], v[92:93], v[136:137] neg_lo:[1,0,0] neg_hi:[1,0,0]
    v_cvt_pk_bf16_f32 v173, v136, v137
    s_cmp_lg_u32 s53, 0
    s_cbranch_scc1 L_slow_100
    buffer_store_dwordx4 v[170:173], v239, s[40:43], s73 offen offset:1024
L_st_101:
    s_waitcnt vmcnt(2)
    v_cmp_gt_u32 vcc, 13, v38
    s_cbranch_vccnz L_fb_103
L_ok_102:
    s_add_u32 s68, s8, s64
    buffer_load_dwordx4 v[42:45], v1, s[40:43], s68 offen offset:2048 sc1
    s_add_u32 s68, s8, s65
    buffer_load_dwordx4 v[46:49], v1, s[40:43], s68 offen offset:1024 sc1
    s_add_u32 s68, s8, s66
    buffer_load_dwordx4 v[50:53], v1, s[40:43], s68 offen offset:0 sc1
    buffer_load_dwordx4 v[54:57], v29, s[40:43], s68 offen offset:2048 sc1
    s_add_u32 s68, s9, s64
    buffer_load_dwordx4 v[58:61], v1, s[40:43], s68 offen offset:2048 sc1
    s_add_u32 s68, s9, s65
    buffer_load_dwordx4 v[62:65], v1, s[40:43], s68 offen offset:1024 sc1
    v_add_u32 v39, s12, v1
    v_add_u32 v40, s13, v1
    v_add_u32 v41, s14, v1
    v_permlane16_swap_b32 v20, v22
    v_permlane16_swap_b32 v21, v23
    v_permlane16_swap_b32 v24, v26
    v_permlane16_swap_b32 v25, v27
    v_lshlrev_b32 v224, 16, v20
    v_and_b32 v225, 0xffff0000, v20
    v_lshlrev_b32 v226, 16, v21
    v_and_b32 v227, 0xffff0000, v21
    v_lshlrev_b32 v228, 16, v22
    v_and_b32 v229, 0xffff0000, v22
    v_lshlrev_b32 v230, 16, v23
    v_and_b32 v231, 0xffff0000, v23
    v_lshlrev_b32 v232, 16, v24
    v_and_b32 v233, 0xffff0000, v24
    v_lshlrev_b32 v234, 16, v25
    v_and_b32 v235, 0xffff0000, v25
    v_lshlrev_b32 v236, 16, v26
    v_and_b32 v237, 0xffff0000, v26
    v_lshlrev_b32_e64 v238, 16, v27
    v_and_b32 v239, 0xffff0000, v27
    s_mov_b32 s50, s51
    s_add_u32 s51, s51, s52
    v_add_u32 v219, s61, v1
    s_lshl_b32 s69, s6, 15
    s_add_u32 s69, s69, s58
    s_lshl_b32 s70, s48, 7
    s_add_u32 s69, s69, s70
    s_add_u32 s70, s69, 16384
    s_add_u32 s71, s63, 147456
    v_mul_u32_u24 v220, 36, v15
    v_lshrrev_b32_e64 v221, 1, v32
    v_add3_u32 v220, v220, v221, s71
    v_lshrrev_b32_e64 v222, 3, v0
    v_and_b32 v223, 0x70, v1
    v_mul_u32_u24 v221, 144, v222
    v_add3_u32 v221, v221, v223, s71
    v_lshl_or_b32 v222, v222, 11, v223
    s_waitcnt vmcnt(5)
    v_mov_b32 v36, 14
    s_cmp_lg_u32 s53, 0
    s_cbranch_scc1 L_slow_104
    buffer_store_dword v36, v28, s[40:43], s54 offen
L_st_105:
    v_mfma_f32_16x16x32_bf16 v[106:109], a[96:99], v[42:45], 0
    s_add_u32 s68, s9, s66
    buffer_load_dwordx4 v[66:69], v1, s[40:43], s68 offen offset:0 sc1
    v_mfma_f32_16x16x32_bf16 v[110:113], a[100:103], v[42:45], 0
    v_mfma_f32_16x16x32_bf16 v[114:117], a[104:107], v[42:45], 0
    v_mfma_f32_16x16x32_bf16 v[118:121], a[108:111], v[42:45], 0
    s_waitcnt vmcnt(6)
    v_mfma_f32_16x16x32_bf16 v[106:109], a[144:147], v[46:49], v[106:109]
    buffer_load_dwordx4 v[70:73], v29, s[40:43], s68 offen offset:2048 sc1
    v_mfma_f32_16x16x32_bf16 v[110:113], a[148:151], v[46:49], v[110:113]
    v_mfma_f32_16x16x32_bf16 v[114:117], a[152:155], v[46:49], v[114:117]
    v_mfma_f32_16x16x32_bf16 v[118:121], a[156:159], v[46:49], v[118:121]
    s_waitcnt vmcnt(6)
    v_mfma_f32_16x16x32_bf16 v[106:109], a[192:195], v[50:53], v[106:109]
    s_add_u32 s68, s10, s64
    buffer_load_dwordx4 v[74:77], v1, s[40:43], s68 offen offset:2048 sc1
    v_mfma_f32_16x16x32_bf16 v[110:113], a[196:199], v[50:53], v[110:113]
    v_mfma_f32_16x16x32_bf16 v[114:117], a[200:203], v[50:53], v[114:117]
    v_mfma_f32_16x16x32_bf16 v[118:121], a[204:207], v[50:53], v[118:121]
    s_waitcnt vmcnt(6)
    v_mfma_f32_16x16x32_bf16 v[106:109], a[224:227], v[54:57], v[106:109]
    s_add_u32 s68, s10, s65
    buffer_load_dwordx4 v[78:81], v1, s[40:43], s68 offen offset:1024 sc1
    v_mfma_f32_16x16x32_bf16 v[110:113], a[228:231], v[54:57], v[110:113]
    v_mfma_f32_16x16x32_bf16 v[114:117], a[232:235], v[54:57], v[114:117]
    v_mfma_f32_16x16x32_bf16 v[118:121], a[236:239], v[54:57], v[118:121]
    s_waitcnt vmcnt(6)
    v_mfma_f32_16x16x32_bf16 v[122:125], a[96:99], v[58:61], 0
    s_add_u32 s68, s10, s66
    buffer_load_dwordx4 v[82:85], v1, s[40:43], s68 offen offset:0 sc1
    v_mfma_f32_16x16x32_bf16 v[126:129], a[100:103], v[58:61], 0
    v_mfma_f32_16x16x32_bf16 v[130:133], a[104:107], v[58:61], 0
    v_mfma_f32_16x16x32_bf16 v[134:137], a[108:111], v[58:61], 0
    s_waitcnt vmcnt(6)
    v_mfma_f32_16x16x32_bf16 v[122:125], a[144:147], v[62:65], v[122:125]
    buffer_load_dwordx4 v[86:89], v29, s[40:43], s68 offen offset:2048 sc1
    v_mfma_f32_16x16x32_bf16 v[126:129], a[148:151], v[62:65], v[126:129]
    buffer_load_dword v38, v30, s[40:43], s56 offen sc1
    v_mfma_f32_16x16x32_bf16 v[130:133], a[152:155], v[62:65], v[130:133]
    v_mfma_f32_16x16x32_bf16 v[134:137], a[156:159], v[62:65], v[134:137]
    s_waitcnt vmcnt(6)
    v_mfma_f32_16x16x32_bf16 v[122:125], a[192:195], v[66:69], v[122:125]
    s_add_u32 s68, s11, s64
    buffer_load_dwordx4 v[90:93], v1, s[40:43], s68 offen offset:2048 sc1
    v_mfma_f32_16x16x32_bf16 v[126:129], a[196:199], v[66:69], v[126:129]
    v_mfma_f32_16x16x32_bf16 v[130:133], a[200:203], v[66:69], v[130:133]
    v_mfma_f32_16x16x32_bf16 v[134:137], a[204:207], v[66:69], v[134:137]
    s_waitcnt vmcnt(6)
    v_mfma_f32_16x16x32_bf16 v[122:125], a[224:227], v[70:73], v[122:125]
    s_add_u32 s68, s11, s65
    buffer_load_dwordx4 v[94:97], v1, s[40:43], s68 offen offset:1024 sc1
    v_mfma_f32_16x16x32_bf16 v[126:129], a[228:231], v[70:73], v[126:129]
    v_mfma_f32_16x16x32_bf16 v[130:133], a[232:235], v[70:73], v[130:133]
    v_mfma_f32_16x16x32_bf16 v[134:137], a[236:239], v[70:73], v[134:137]
    s_waitcnt vmcnt(6)
    v_mfma_f32_16x16x32_bf16 v[138:141], a[96:99], v[74:77], 0
    s_add_u32 s68, s11, s66
    buffer_load_dwordx4 v[98:101], v1, s[40:43], s68 offen offset:0 sc1
    v_mfma_f32_16x16x32_bf16 v[142:145], a[100:103], v[74:77], 0
    v_mfma_f32_16x16x32_bf16 v[146:149], a[104:107], v[74:77], 0
    v_mfma_f32_16x16x32_bf16 v[150:153], a[108:111], v[74:77], 0
    s_waitcnt vmcnt(6)
    v_mfma_f32_16x16x32_bf16 v[138:141], a[144:147], v[78:81], v[138:141]
    buffer_load_dwordx4 v[102:105], v29, s[40:43], s68 offen offset:2048 sc1
    v_mfma_f32_16x16x32_bf16 v[142:145], a[148:151], v[78:81], v[142:145]
    v_mfma_f32_16x16x32_bf16 v[146:149], a[152:155], v[78:81], v[146:149]
    v_mfma_f32_16x16x32_bf16 v[150:153], a[156:159], v[78:81], v[150:153]
    s_waitcnt vmcnt(6)
    v_mfma_f32_16x16x32_bf16 v[138:141], a[192:195], v[82:85], v[138:141]
    s_waitcnt vmcnt(4)
    v_cmp_gt_u32 vcc, 14, v38
    s_cbranch_vccnz L_fb_107
L_ok_106:
    s_add_u32 s68, s8, s64
    buffer_load_dwordx4 v[42:45], v1, s[40:43], s68 offen offset:0 sc1
    v_mfma_f32_16x16x32_bf16 v[142:145], a[196:199], v[82:85], v[142:145]
    v_mfma_f32_16x16x32_bf16 v[146:149], a[200:203], v[82:85], v[146:149]
    v_mfma_f32_16x16x32_bf16 v[150:153], a[204:207], v[82:85], v[150:153]
    v_mfma_f32_16x16x32_bf16 v[138:141], a[224:227], v[86:89], v[138:141]
    buffer_load_dwordx4 v[46:49], v1, s[40:43], s68 offen offset:1024 sc1
    v_mfma_f32_16x16x32_bf16 v[142:145], a[228:231], v[86:89], v[142:145]
    v_mfma_f32_16x16x32_bf16 v[146:149], a[232:235], v[86:89], v[146:149]
    v_mfma_f32_16x16x32_bf16 v[150:153], a[236:239], v[86:89], v[150:153]
    s_waitcnt vmcnt(5)
    v_mfma_f32_16x16x32_bf16 v[154:157], a[96:99], v[90:93], 0
    buffer_load_dwordx4 v[50:53], v1, s[40:43], s68 offen offset:3072 sc1
    v_mfma_f32_16x16x32_bf16 v[158:161], a[100:103], v[90:93], 0
    v_mfma_f32_16x16x32_bf16 v[162:165], a[104:107], v[90:93], 0
    v_mfma_f32_16x16x32_bf16 v[166:169], a[108:111], v[90:93], 0
    s_waitcnt vmcnt(5)
    v_mfma_f32_16x16x32_bf16 v[154:157], a[144:147], v[94:97], v[154:157]
    s_add_u32 s68, s8, s65
    buffer_load_dwordx4 v[54:57], v1, s[40:43], s68 offen offset:0 sc1
    v_mfma_f32_16x16x32_bf16 v[158:161], a[148:151], v[94:97], v[158:161]
    v_mfma_f32_16x16x32_bf16 v[162:165], a[152:155], v[94:97], v[162:165]
    v_mfma_f32_16x16x32_bf16 v[166:169], a[156:159], v[94:97], v[166:169]
    s_waitcnt vmcnt(5)
    v_mfma_f32_16x16x32_bf16 v[154:157], a[192:195], v[98:101], v[154:157]
    buffer_load_dwordx4 v[58:61], v1, s[40:43], s68 offen offset:2048 sc1
    v_mfma_f32_16x16x32_bf16 v[158:161], a[196:199], v[98:101], v[158:161]
    v_mfma_f32_16x16x32_bf16 v[162:165], a[200:203], v[98:101], v[162:165]
    v_mfma_f32_16x16x32_bf16 v[166:169], a[204:207], v[98:101], v[166:169]
    s_waitcnt vmcnt(5)
    v_mfma_f32_16x16x32_bf16 v[154:157], a[224:227], v[102:105], v[154:157]
    buffer_load_dwordx4 v[62:65], v1, s[40:43], s68 offen offset:3072 sc1
    v_mfma_f32_16x16x32_bf16 v[158:161], a[228:231], v[102:105], v[158:161]
    v_mfma_f32_16x16x32_bf16 v[162:165], a[232:235], v[102:105], v[162:165]
    v_mfma_f32_16x16x32_bf16 v[166:169], a[236:239], v[102:105], v[166:169]
    s_waitcnt vmcnt(5)
    v_mfma_f32_16x16x32_bf16 v[106:109], a[64:67], v[42:45], v[106:109]
    s_add_u32 s68, s8, s66
    buffer_load_dwordx4 v[66:69], v1, s[40:43], s68 offen offset:1024 sc1
    v_mfma_f32_16x16x32_bf16 v[110:113], a[68:71], v[42:45], v[110:113]
    v_mfma_f32_16x16x32_bf16 v[114:117], a[72:75], v[42:45], v[114:117]
    v_mfma_f32_16x16x32_bf16 v[118:121], a[76:79], v[42:45], v[118:121]
    s_waitcnt vmcnt(5)
    v_mfma_f32_16x16x32_bf16 v[106:109], a[80:83], v[46:49], v[106:109]
    s_add_u32 s68, s9, s64
    buffer_load_dwordx4 v[70:73], v1, s[40:43], s68 offen offset:0 sc1
    v_mfma_f32_16x16x32_bf16 v[110:113], a[84:87], v[46:49], v[110:113]
    v_mfma_f32_16x16x32_bf16 v[114:117], a[88:91], v[46:49], v[114:117]
    v_mfma_f32_16x16x32_bf16 v[118:121], a[92:95], v[46:49], v[118:121]
    s_waitcnt vmcnt(5)
    v_mfma_f32_16x16x32_bf16 v[106:109], a[112:115], v[50:53], v[106:109]
    buffer_load_dwordx4 v[74:77], v1, s[40:43], s68 offen offset:1024 sc1
    v_mfma_f32_16x16x32_bf16 v[110:113], a[116:119], v[50:53], v[110:113]
    v_mfma_f32_16x16x32_bf16 v[114:117], a[120:123], v[50:53], v[114:117]
    v_mfma_f32_16x16x32_bf16 v[118:121], a[124:127], v[50:53], v[118:121]
    s_waitcnt vmcnt(5)
    v_mfma_f32_16x16x32_bf16 v[106:109], a[128:131], v[54:57], v[106:109]
    buffer_load_dwordx4 v[78:81], v1, s[40:43], s68 offen offset:3072 sc1
    v_mfma_f32_16x16x32_bf16 v[110:113], a[132:135], v[54:57], v[110:113]
    v_mfma_f32_16x16x32_bf16 v[114:117], a[136:139], v[54:57], v[114:117]
    v_mfma_f32_16x16x32_bf16 v[118:121], a[140:143], v[54:57], v[118:121]
    s_waitcnt vmcnt(5)
    v_mfma_f32_16x16x32_bf16 v[106:109], a[160:163], v[58:61], v[106:109]
    s_add_u32 s68, s9, s65
    buffer_load_dwordx4 v[82:85], v1, s[40:43], s68 offen offset:0 sc1
    v_mfma_f32_16x16x32_bf16 v[110:113], a[164:167], v[58:61], v[110:113]
    v_mfma_f32_16x16x32_bf16 v[114:117], a[168:171], v[58:61], v[114:117]
    v_mfma_f32_16x16x32_bf16 v[118:121], a[172:175], v[58:61], v[118:121]
    s_waitcnt vmcnt(5)
    v_mfma_f32_16x16x32_bf16 v[106:109], a[176:179], v[62:65], v[106:109]
    buffer_load_dwordx4 v[86:89], v1, s[40:43], s68 offen offset:2048 sc1
    v_mfma_f32_16x16x32_bf16 v[110:113], a[180:183], v[62:65], v[110:113]
    v_mfma_f32_16x16x32_bf16 v[114:117], a[184:187], v[62:65], v[114:117]
    v_mfma_f32_16x16x32_bf16 v[118:121], a[188:191], v[62:65], v[118:121]
    s_waitcnt vmcnt(5)
    v_mfma_f32_16x16x32_bf16 v[106:109], a[208:211], v[66:69], v[106:109]
    buffer_load_dwordx4 v[90:93], v1, s[40:43], s68 offen offset:3072 sc1
    v_mfma_f32_16x16x32_bf16 v[110:113], a[212:215], v[66:69], v[110:113]
    v_mfma_f32_16x16x32_bf16 v[114:117], a[216:219], v[66:69], v[114:117]
    v_mfma_f32_16x16x32_bf16 v[118:121], a[220:223], v[66:69], v[118:121]
    s_waitcnt vmcnt(5)
    v_mfma_f32_16x16x32_bf16 v[122:125], a[64:67], v[70:73], v[122:125]
    s_add_u32 s68, s9, s66
    buffer_load_dwordx4 v[94:97], v1, s[40:43], s68 offen offset:1024 sc1
    v_mfma_f32_16x16x32_bf16 v[126:129], a[68:71], v[70:73], v[126:129]
    v_mfma_f32_16x16x32_bf16 v[130:133], a[72:75], v[70:73], v[130:133]
    v_mfma_f32_16x16x32_bf16 v[134:137], a[76:79], v[70:73], v[134:137]
    ds_write_b128 v39, v[106:109] offset:0
    s_waitcnt vmcnt(5)
    v_mfma_f32_16x16x32_bf16 v[122:125], a[80:83], v[74:77], v[122:125]
    s_add_u32 s68, s10, s64
    buffer_load_dwordx4 v[98:101], v1, s[40:43], s68 offen offset:0 sc1
    v_mfma_f32_16x16x32_bf16 v[126:129], a[84:87], v[74:77], v[126:129]
    v_mfma_f32_16x16x32_bf16 v[130:133], a[88:91], v[74:77], v[130:133]
    v_mfma_f32_16x16x32_bf16 v[134:137], a[92:95], v[74:77], v[134:137]
    ds_write_b128 v39, v[110:113] offset:1024
    s_waitcnt vmcnt(5)
    v_mfma_f32_16x16x32_bf16 v[122:125], a[112:115], v[78:81], v[122:125]
    buffer_load_dwordx4 v[102:105], v1, s[40:43], s68 offen offset:1024 sc1
    v_mfma_f32_16x16x32_bf16 v[126:129], a[116:119], v[78:81], v[126:129]
    v_mfma_f32_16x16x32_bf16 v[130:133], a[120:123], v[78:81], v[130:133]
    v_mfma_f32_16x16x32_bf16 v[134:137], a[124:127], v[78:81], v[134:137]
    ds_write_b128 v39, v[114:117] offset:2048
    s_waitcnt vmcnt(5)
    v_mfma_f32_16x16x32_bf16 v[122:125], a[128:131], v[82:85], v[122:125]
    buffer_load_dwordx4 v[42:45], v1, s[40:43], s68 offen offset:3072 sc1
    v_mfma_f32_16x16x32_bf16 v[126:129], a[132:135], v[82:85], v[126:129]
    v_mfma_f32_16x16x32_bf16 v[130:133], a[136:139], v[82:85], v[130:133]
    v_mfma_f32_16x16x32_bf16 v[134:137], a[140:143], v[82:85], v[134:137]
    ds_write_b128 v39, v[118:121] offset:3072
    s_waitcnt vmcnt(5)
    v_mfma_f32_16x16x32_bf16 v[122:125], a[160:163], v[86:89], v[122:125]
    s_add_u32 s68, s10, s65
    buffer_load_dwordx4 v[46:49], v1, s[40:43], s68 offen offset:0 sc1
    v_mfma_f32_16x16x32_bf16 v[126:129], a[164:167], v[86:89], v[126:129]
    v_mfma_f32_16x16x32_bf16 v[130:133], a[168:171], v[86:89], v[130:133]
    v_mfma_f32_16x16x32_bf16 v[134:137], a[172:175], v[86:89], v[134:137]
    s_waitcnt vmcnt(5)
    v_mfma_f32_16x16x32_bf16 v[122:125], a[176:179], v[90:93], v[122:125]
    buffer_load_dwordx4 v[50:53], v1, s[40:43], s68 offen offset:2048 sc1
    v_mfma_f32_16x16x32_bf16 v[126:129], a[180:183], v[90:93], v[126:129]
    v_mfma_f32_16x16x32_bf16 v[130:133], a[184:187], v[90:93], v[130:133]
    v_mfma_f32_16x16x32_bf16 v[134:137], a[188:191], v[90:93], v[134:137]
    s_waitcnt vmcnt(5)
    v_mfma_f32_16x16x32_bf16 v[122:125], a[208:211], v[94:97], v[122:125]
    buffer_load_dwordx4 v[54:57], v1, s[40:43], s68 offen offset:3072 sc1
    v_mfma_f32_16x16x32_bf16 v[126:129], a[212:215], v[94:97], v[126:129]
    v_mfma_f32_16x16x32_bf16 v[130:133], a[216:219], v[94:97], v[130:133]
    v_mfma_f32_16x16x32_bf16 v[134:137], a[220:223], v[94:97], v[134:137]
    s_waitcnt vmcnt(5)
    v_mfma_f32_16x16x32_bf16 v[138:141], a[64:67], v[98:101], v[138:141]
L_pg9:
    s_cbranch_execz L_walked1
    s_add_u32 s68, s10, s66
    buffer_load_dwordx4 v[58:61], v1, s[40:43], s68 offen offset:1024 sc1
    v_mfma_f32_16x16x32_bf16 v[142:145], a[68:71], v[98:101], v[142:145]
    v_mfma_f32_16x16x32_bf16 v[146:149], a[72:75], v[98:101], v[146:149]
    v_mfma_f32_16x16x32_bf16 v[150:153], a[76:79], v[98:101], v[150:153]
    ds_write_b128 v40, v[122:125] offset:0
    s_waitcnt lgkmcnt(1)
    s_barrier
    s_waitcnt vmcnt(5)
    v_mfma_f32_16x16x32_bf16 v[138:141], a[80:83], v[102:105], v[138:141]
    s_add_u32 s68, s11, s64
    buffer_load_dwordx4 v[62:65], v1, s[40:43], s68 offen offset:0 sc1
    v_mfma_f32_16x16x32_bf16 v[142:145], a[84:87], v[102:105], v[142:145]
    ds_read_b128 v[170:173], v219 offset:0
    ds_read_b128 v[174:177], v219 offset:1024
    v_mfma_f32_16x16x32_bf16 v[146:149], a[88:91], v[102:105], v[146:149]
    ds_read_b128 v[178:181], v219 offset:2048
    ds_read_b128 v[182:185], v219 offset:3072
    v_mfma_f32_16x16x32_bf16 v[150:153], a[92:95], v[102:105], v[150:153]
    ds_write_b128 v40, v[126:129] offset:1024
    s_waitcnt vmcnt(5)
    v_mfma_f32_16x16x32_bf16 v[138:141], a[112:115], v[42:45], v[138:141]
    buffer_load_dwordx4 v[66:69], v1, s[40:43], s68 offen offset:1024 sc1
    v_mfma_f32_16x16x32_bf16 v[142:145], a[116:119], v[42:45], v[142:145]
    v_mfma_f32_16x16x32_bf16 v[146:149], a[120:123], v[42:45], v[146:149]
    v_mfma_f32_16x16x32_bf16 v[150:153], a[124:127], v[42:45], v[150:153]
    ds_write_b128 v40, v[130:133] offset:2048
    s_waitcnt vmcnt(5)
    v_mfma_f32_16x16x32_bf16 v[138:141], a[128:131], v[46:49], v[138:141]
    buffer_load_dwordx4 v[70:73], v1, s[40:43], s68 offen offset:3072 sc1
    v_mfma_f32_16x16x32_bf16 v[142:145], a[132:135], v[46:49], v[142:145]
    s_waitcnt lgkmcnt(2)
    v_fmac_f32 v224, s99, v170
    v_mfma_f32_16x16x32_bf16 v[146:149], a[136:139], v[46:49], v[146:149]
    v_fmac_f32 v225, s99, v171
    v_fmac_f32_e64 v226, s99, v172
    v_mfma_f32_16x16x32_bf16 v[150:153], a[140:143], v[46:49], v[150:153]
    ds_write_b128 v40, v[134:137] offset:3072
    s_waitcnt vmcnt(5)
    v_mfma_f32_16x16x32_bf16 v[138:141], a[160:163], v[50:53], v[138:141]
    s_add_u32 s68, s11, s65
    buffer_load_dwordx4 v[74:77], v1, s[40:43], s68 offen offset:0 sc1
    v_mfma_f32_16x16x32_bf16 v[142:145], a[164:167], v[50:53], v[142:145]
    v_fmac_f32 v227, s99, v173
    v_fmac_f32 v228, s99, v174
    v_mfma_f32_16x16x32_bf16 v[146:149], a[168:171], v[50:53], v[146:149]
    v_fmac_f32 v229, s99, v175
    v_fmac_f32 v230, s99, v176
    v_mfma_f32_16x16x32_bf16 v[150:153], a[172:175], v[50:53], v[150:153]
    v_fmac_f32 v231, s99, v177
    v_fmac_f32 v232, s99, v178
    s_waitcnt vmcnt(5)
    v_mfma_f32_16x16x32_bf16 v[138:141], a[176:179], v[54:57], v[138:141]
    buffer_load_dwordx4 v[78:81], v1, s[40:43], s68 offen offset:2048 sc1
    v_mfma_f32_16x16x32_bf16 v[142:145], a[180:183], v[54:57], v[142:145]
    v_fmac_f32 v233, s99, v179
    v_fmac_f32_e64 v234, s99, v180
    v_mfma_f32_16x16x32_bf16 v[146:149], a[184:187], v[54:57], v[146:149]
    v_fmac_f32 v235, s99, v181
    v_fmac_f32 v236, s99, v182
    v_mfma_f32_16x16x32_bf16 v[150:153], a[188:191], v[54:57], v[150:153]
    v_fmac_f32 v237, s99, v183
    v_fmac_f32 v238, s99, v184
    s_waitcnt vmcnt(5)
    v_mfma_f32_16x16x32_bf16 v[138:141], a[208:211], v[58:61], v[138:141]
    buffer_load_dwordx4 v[82:85], v1, s[40:43], s68 offen offset:3072 sc1
    v_mfma_f32_16x16x32_bf16 v[142:145], a[212:215], v[58:61], v[142:145]
    v_fmac_f32 v239, s99, v185
    v_mfma_f32_16x16x32_bf16 v[146:149], a[216:219], v[58:61], v[146:149]
    v_mfma_f32_16x16x32_bf16 v[150:153], a[220:223], v[58:61], v[150:153]
    s_waitcnt vmcnt(5)
    v_mfma_f32_16x16x32_bf16 v[154:157], a[64:67], v[62:65], v[154:157]
    s_add_u32 s68, s11, s66
    buffer_load_dwordx4 v[86:89], v1, s[40:43], s68 offen offset:1024 sc1
    v_mfma_f32_16x16x32_bf16 v[158:161], a[68:71], v[62:65], v[158:161]
    v_mfma_f32_16x16x32_bf16 v[162:165], a[72:75], v[62:65], v[162:165]
    ds_write_b128 v41, v[138:141] offset:0
    v_mfma_f32_16x16x32_bf16 v[166:169], a[76:79], v[62:65], v[166:169]
    s_waitcnt lgkmcnt(1)
    s_barrier
    s_waitcnt vmcnt(5)
    v_mfma_f32_16x16x32_bf16 v[154:157], a[80:83], v[66:69], v[154:157]
    ds_read_b128 v[186:189], v219 offset:4096
    ds_read_b128 v[190:193], v219 offset:5120
    v_mfma_f32_16x16x32_bf16 v[158:161], a[84:87], v[66:69], v[158:161]
    ds_write_b128 v41, v[142:145] offset:1024
    v_mfma_f32_16x16x32_bf16 v[162:165], a[88:91], v[66:69], v[162:165]
    ds_read_b128 v[194:197], v219 offset:6144
    ds_read_b128 v[198:201], v219 offset:7168
    v_mfma_f32_16x16x32_bf16 v[166:169], a[92:95], v[66:69], v[166:169]
    s_waitcnt vmcnt(4)
    v_mfma_f32_16x16x32_bf16 v[154:157], a[112:115], v[70:73], v[154:157]
    ds_write_b128 v41, v[146:149] offset:2048
    v_mfma_f32_16x16x32_bf16 v[158:161], a[116:119], v[70:73], v[158:161]
    v_mfma_f32_16x16x32_bf16 v[162:165], a[120:123], v[70:73], v[162:165]
    s_waitcnt lgkmcnt(1)
    v_fmac_f32 v224, s99, v186
    v_mfma_f32_16x16x32_bf16 v[166:169], a[124:127], v[70:73], v[166:169]
    ds_write_b128 v41, v[150:153] offset:3072
    s_waitcnt vmcnt(3)
    v_mfma_f32_16x16x32_bf16 v[154:157], a[128:131], v[74:77], v[154:157]
    v_fmac_f32 v225, s99, v187
    v_fmac_f32 v226, s99, v188
    v_mfma_f32_16x16x32_bf16 v[158:161], a[132:135], v[74:77], v[158:161]
    v_fmac_f32 v227, s99, v189
    v_fmac_f32_e64 v228, s99, v190
    v_mfma_f32_16x16x32_bf16 v[162:165], a[136:139], v[74:77], v[162:165]
    v_fmac_f32 v229, s99, v191
    v_fmac_f32 v230, s99, v192
    v_mfma_f32_16x16x32_bf16 v[166:169], a[140:143], v[74:77], v[166:169]
    v_fmac_f32 v231, s99, v193
    v_fmac_f32 v232, s99, v194
    s_waitcnt lgkmcnt(0)
    s_barrier
    s_waitcnt vmcnt(2)
    v_mfma_f32_16x16x32_bf16 v[154:157], a[160:163], v[78:81], v[154:157]
    ds_read_b128 v[202:205], v219 offset:8192
    ds_read_b128 v[206:209], v219 offset:9216
    v_mfma_f32_16x16x32_bf16 v[158:161], a[164:167], v[78:81], v[158:161]
    ds_read_b128 v[210:213], v219 offset:10240
    ds_read_b128 v[214:217], v219 offset:11264
    v_mfma_f32_16x16x32_bf16 v[162:165], a[168:171], v[78:81], v[162:165]
    v_fmac_f32 v233, s99, v195
    v_fmac_f32 v234, s99, v196
    v_mfma_f32_16x16x32_bf16 v[166:169], a[172:175], v[78:81], v[166:169]
    v_fmac_f32 v235, s99, v197
    v_fmac_f32 v236, s99, v198
    s_waitcnt vmcnt(1)
    v_mfma_f32_16x16x32_bf16 v[154:157], a[176:179], v[82:85], v[154:157]
    v_fmac_f32 v237, s99, v199
    v_fmac_f32 v238, s99, v200
    v_mfma_f32_16x16x32_bf16 v[158:161], a[180:183], v[82:85], v[158:161]
    v_fmac_f32 v239, s99, v201
    s_waitcnt lgkmcnt(0)
    v_mfma_f32_16x16x32_bf16 v[162:165], a[184:187], v[82:85], v[162:165]
    v_fmac_f32 v224, s99, v202
    v_fmac_f32 v225, s99, v203
    v_mfma_f32_16x16x32_bf16 v[166:169], a[188:191], v[82:85], v[166:169]
    v_fmac_f32 v226, s99, v204
    v_fmac_f32 v227, s99, v205
    s_waitcnt vmcnt(0)
    v_mfma_f32_16x16x32_bf16 v[154:157], a[208:211], v[86:89], v[154:157]
    v_fmac_f32 v228, s99, v206
    v_fmac_f32 v229, s99, v207
    v_mfma_f32_16x16x32_bf16 v[158:161], a[212:215], v[86:89], v[158:161]
    v_fmac_f32 v230, s99, v208
    v_fmac_f32 v231, s99, v209
    v_mfma_f32_16x16x32_bf16 v[162:165], a[216:219], v[86:89], v[162:165]
    v_fmac_f32 v232, s99, v210
    v_fmac_f32 v233, s99, v211
    v_mfma_f32_16x16x32_bf16 v[166:169], a[220:223], v[86:89], v[166:169]
    v_fmac_f32 v234, s99, v212
    v_fmac_f32 v235, s99, v213
    v_fmac_f32 v236, s99, v214
    v_fmac_f32 v237, s99, v215
    v_fmac_f32 v238, s99, v216
    v_fmac_f32_e64 v239, s99, v217
    v_pk_fma_f32 v[154:155], v[154:155], s[98:99], v[224:225] op_sel:[0,1,0]
    v_pk_fma_f32 v[156:157], v[156:157], s[98:99], v[226:227] op_sel:[0,1,0]
    v_pk_fma_f32 v[158:159], v[158:159], s[98:99], v[228:229] op_sel:[0,1,0]
    v_pk_fma_f32 v[160:161], v[160:161], s[98:99], v[230:231] op_sel:[0,1,0]
    v_cvt_pk_bf16_f32 v20, v154, v155
    v_cvt_pk_bf16_f32 v21, v156, v157
    v_cvt_pk_bf16_f32 v22, v158, v159
    v_cvt_pk_bf16_f32 v23, v160, v161
    ds_write_b64 v220, v[20:21] offset:0
    ds_write_b64 v220, v[22:23] offset:32
    v_pk_fma_f32 v[162:163], v[162:163], s[98:99], v[232:233] op_sel:[0,1,0]
    v_pk_fma_f32 v[164:165], v[164:165], s[98:99], v[234:235] op_sel:[0,1,0]
    v_pk_fma_f32 v[166:167], v[166:167], s[98:99], v[236:237] op_sel:[0,1,0]
    v_pk_fma_f32 v[168:169], v[168:169], s[98:99], v[238:239] op_sel:[0,1,0]
    v_cvt_pk_bf16_f32 v24, v162, v163
    v_cvt_pk_bf16_f32 v25, v164, v165
    v_cvt_pk_bf16_f32 v26, v166, v167
    v_cvt_pk_bf16_f32 v27, v168, v169
    ds_write_b64 v220, v[24:25] offset:64
    ds_write_b64 v220, v[26:27] offset:96
    ds_read_b128 v[106:109], v221 offset:0
    ds_read_b128 v[110:113], v221 offset:1152
    s_waitcnt lgkmcnt(1)
    buffer_store_dwordx4 v[106:109], v222, s[32:35], s69 offen sc1
    s_waitcnt lgkmcnt(0)
    buffer_store_dwordx4 v[110:113], v222, s[32:35], s70 offen sc1
L_end:
    s_endpgm
L_slow_8:
    s_nop 7
    buffer_store_dwordx4 v[78:81], v1, s[40:43], s68 offen sc1
    s_nop 1
    s_branch L_st_9
L_slow_10:
    s_nop 7
    buffer_store_dwordx4 v[74:77], v1, s[40:43], s67 offen sc1
    s_nop 1
    s_branch L_st_11
L_slow_12:
    s_nop 7
    buffer_store_dword v36, v28, s[40:43], s54 offen sc1
    s_nop 1
    s_branch L_st_13
L_slow_16:
    s_nop 7
    buffer_store_dwordx4 v[20:23], v220, s[40:43], s69 offen offset:0 sc1
    s_nop 1
    s_branch L_st_17
L_slow_18:
    s_nop 7
    buffer_store_dwordx4 v[24:27], v220, s[40:43], s69 offen offset:1024 sc1
    s_nop 1
    s_branch L_st_19
L_slow_20:
    s_nop 7
    buffer_store_dwordx2 v[106:107], v221, s[40:43], s70 offen sc1
    s_nop 1
    s_branch L_st_21
L_slow_22:
    s_nop 7
    buffer_store_dword v36, v28, s[40:43], s55 offen sc1
    s_nop 1
    s_branch L_st_23
L_slow_26:
    s_nop 7
    buffer_store_dword v36, v28, s[40:43], s55 offen sc1
    s_nop 1
    s_branch L_st_27
L_slow_30:
    s_nop 7
    buffer_store_dwordx4 v[162:165], v1, s[40:43], s72 offen offset:2048 sc1
    s_nop 1
    s_branch L_st_31
L_slow_32:
    s_nop 7
    buffer_store_dwordx4 v[174:177], v1, s[40:43], s73 offen offset:2048 sc1
    s_nop 1
    s_branch L_st_33
L_slow_34:
    s_nop 7
    buffer_store_dwordx4 v[154:157], v238, s[40:43], s72 offen offset:0 sc1
    s_nop 1
    s_branch L_st_35
L_slow_36:
    s_nop 7
    buffer_store_dword v36, v28, s[40:43], s54 offen sc1
    s_nop 1
    s_branch L_st_37
L_slow_38:
    s_nop 7
    buffer_store_dwordx4 v[166:169], v238, s[40:43], s73 offen offset:0 sc1
    s_nop 1
    s_branch L_st_39
L_slow_40:
    s_nop 7
    buffer_store_dwordx4 v[158:161], v239, s[40:43], s72 offen offset:1024 sc1
    s_nop 1
    s_branch L_st_41
L_slow_42:
    s_nop 7
    buffer_store_dwordx4 v[170:173], v239, s[40:43], s73 offen offset:1024 sc1
    s_nop 1
    s_branch L_st_43
L_slow_46:
    s_nop 7
    buffer_store_dword v36, v28, s[40:43], s54 offen sc1
    s_nop 1
    s_branch L_st_47
L_slow_50:
    s_nop 7
    buffer_store_dwordx4 v[20:23], v220, s[40:43], s69 offen offset:0 sc1
    s_nop 1
    s_branch L_st_51
L_slow_52:
    s_nop 7
    buffer_store_dwordx4 v[24:27], v220, s[40:43], s69 offen offset:1024 sc1
    s_nop 1
    s_branch L_st_53
L_slow_54:
    s_nop 7
    buffer_store_dwordx2 v[106:107], v221, s[40:43], s70 offen sc1
    s_nop 1
    s_branch L_st_55
L_slow_56:
    s_nop 7
    buffer_store_dword v36, v28, s[40:43], s55 offen sc1
    s_nop 1
    s_branch L_st_57
L_slow_60:
    s_nop 7
    buffer_store_dword v36, v28, s[40:43], s55 offen sc1
    s_nop 1
    s_branch L_st_61
L_slow_66:
    s_nop 7
    buffer_store_dwordx4 v[78:81], v1, s[40:43], s68 offen sc1
    s_nop 1
    s_branch L_st_67
L_slow_68:
    s_nop 7
    buffer_store_dwordx4 v[74:77], v1, s[40:43], s67 offen sc1
    s_nop 1
    s_branch L_st_69
L_slow_70:
    s_nop 7
    buffer_store_dword v36, v28, s[40:43], s54 offen sc1
    s_nop 1
    s_branch L_st_71
L_slow_74:
    s_nop 7
    buffer_store_dwordx4 v[20:23], v220, s[40:43], s69 offen offset:0 sc1
    s_nop 1
    s_branch L_st_75
L_slow_76:
    s_nop 7
    buffer_store_dwordx4 v[24:27], v220, s[40:43], s69 offen offset:1024 sc1
    s_nop 1
    s_branch L_st_77
L_slow_78:
    s_nop 7
    buffer_store_dwordx2 v[106:107], v221, s[40:43], s70 offen sc1
    s_nop 1
    s_branch L_st_79
L_slow_80:
    s_nop 7
    buffer_store_dword v36, v28, s[40:43], s55 offen sc1
    s_nop 1
    s_branch L_st_81
L_slow_84:
    s_nop 7
    buffer_store_dword v36, v28, s[40:43], s55 offen sc1
    s_nop 1
    s_branch L_st_85
L_slow_88:
    s_nop 7
    buffer_store_dwordx4 v[162:165], v1, s[40:43], s72 offen offset:2048 sc1
    s_nop 1
    s_branch L_st_89
L_slow_90:
    s_nop 7
    buffer_store_dwordx4 v[174:177], v1, s[40:43], s73 offen offset:2048 sc1
    s_nop 1
    s_branch L_st_91
L_slow_92:
    s_nop 7
    buffer_store_dwordx4 v[154:157], v238, s[40:43], s72 offen offset:0 sc1
    s_nop 1
    s_branch L_st_93
L_slow_94:
    s_nop 7
    buffer_store_dword v36, v28, s[40:43], s54 offen sc1
    s_nop 1
    s_branch L_st_95
L_slow_96:
    s_nop 7
    buffer_store_dwordx4 v[166:169], v238, s[40:43], s73 offen offset:0 sc1
    s_nop 1
    s_branch L_st_97
L_slow_98:
    s_nop 7
    buffer_store_dwordx4 v[158:161], v239, s[40:43], s72 offen offset:1024 sc1
    s_nop 1
    s_branch L_st_99
L_slow_100:
    s_nop 7
    buffer_store_dwordx4 v[170:173], v239, s[40:43], s73 offen offset:1024 sc1
    s_nop 1
    s_branch L_st_101
L_slow_104:
    s_nop 7
    buffer_store_dword v36, v28, s[40:43], s54 offen sc1
    s_nop 1
    s_branch L_st_105
L_fb_29:
    s_mov_b32 s85, 0
L_poll_108:
    buffer_load_dword v38, v15, s[40:43], s57 offen sc1
    s_add_u32 s85, s85, 1
    s_cmp_lt_u32 s85, 131072
    s_cbranch_scc0 L_got_109
    s_waitcnt vmcnt(0)
    v_cmp_gt_u32 vcc, 4, v38
    s_cbranch_vccnz L_poll_108
L_got_109:
    s_branch L_ok_28
L_fb_45:
    s_mov_b32 s85, 0
L_poll_110:
    buffer_load_dword v38, v30, s[40:43], s56 offen sc1
    s_add_u32 s85, s85, 1
    s_cmp_lt_u32 s85, 131072
    s_cbranch_scc0 L_got_111
    s_waitcnt vmcnt(0)
    v_cmp_gt_u32 vcc, 5, v38
    s_cbranch_vccnz L_poll_110
L_got_111:
    s_branch L_ok_44
L_fb_49:
    s_mov_b32 s85, 0
L_poll_112:
    buffer_load_dword v38, v30, s[40:43], s56 offen sc1
    s_add_u32 s85, s85, 1
    s_cmp_lt_u32 s85, 131072
    s_cbranch_scc0 L_got_113
    s_waitcnt vmcnt(0)
    v_cmp_gt_u32 vcc, 6, v38
    s_cbranch_vccnz L_poll_112
L_got_113:
    s_branch L_ok_48
L_fb_63:
    s_mov_b32 s85, 0
L_poll_114:
    buffer_load_dword v38, v15, s[40:43], s57 offen sc1
    s_add_u32 s85, s85, 1
    s_cmp_lt_u32 s85, 131072
    s_cbranch_scc0 L_got_115
    s_waitcnt vmcnt(0)
    v_cmp_gt_u32 vcc, 8, v38
    s_cbranch_vccnz L_poll_114
L_got_115:
    s_branch L_ok_62
L_fb_65:
    s_mov_b32 s85, 0
L_poll_116:
    buffer_load_dword v38, v39, s[40:43], s70 offen sc1
    s_add_u32 s85, s85, 1
    s_cmp_lt_u32 s85, 131072
    s_cbranch_scc0 L_got_117
    s_waitcnt vmcnt(0)
    v_cmp_gt_u32 vcc, s62, v38
    s_cbranch_vccnz L_poll_116
L_got_117:
    s_branch L_ok_64
L_fb_87:
    s_mov_b32 s85, 0
L_poll_118:
    buffer_load_dword v38, v15, s[40:43], s57 offen sc1
    s_add_u32 s85, s85, 1
    s_cmp_lt_u32 s85, 131072
    s_cbranch_scc0 L_got_119
    s_waitcnt vmcnt(0)
    v_cmp_gt_u32 vcc, 12, v38
    s_cbranch_vccnz L_poll_118
L_got_119:
    s_branch L_ok_86
L_fb_103:
    s_mov_b32 s85, 0
L_poll_120:
    buffer_load_dword v38, v30, s[40:43], s56 offen sc1
    s_add_u32 s85, s85, 1
    s_cmp_lt_u32 s85, 131072
    s_cbranch_scc0 L_got_121
    s_waitcnt vmcnt(0)
    v_cmp_gt_u32 vcc, 13, v38
    s_cbranch_vccnz L_poll_120
L_got_121:
    s_branch L_ok_102
L_fb_107:
    s_mov_b32 s85, 0
L_poll_122:
    buffer_load_dword v38, v30, s[40:43], s56 offen sc1
    s_add_u32 s85, s85, 1
    s_cmp_lt_u32 s85, 131072
    s_cbranch_scc0 L_got_123
    s_waitcnt vmcnt(0)
    v_cmp_gt_u32 vcc, 14, v38
    s_cbranch_vccnz L_poll_122
L_got_123:
    s_branch L_ok_106
L_code_end:
.section .rodata,"a"
.p2align 6
.amdhsa_kernel interleave_layers__sliding_local_dilated__dense_activation_mish__prompt_kernel
  .amdhsa_next_free_vgpr 512
  .amdhsa_next_free_sgpr 102
  .amdhsa_accum_offset 256
  .amdhsa_group_segment_fixed_size 0
  .amdhsa_kernarg_size 80
  .amdhsa_user_sgpr_count 2
  .amdhsa_user_sgpr_kernarg_segment_ptr 1
  .amdhsa_system_sgpr_workgroup_id_x 1
  .amdhsa_float_denorm_mode_32 3
.end_amdhsa_kernel
```
